```python
import torch

def _softmax(x, axis=-1):
    return torch.softmax(x, dim=axis)
def _gelu(x):
    return torch.nn.functional.gelu(x, approximate="tanh")
def _silu(x):
    return torch.nn.functional.silu(x)
def _sigmoid(x):
    return torch.sigmoid(x)
def _layernorm(x, axis=-1, eps=1e-5):
    m = x.mean(dim=axis, keepdim=True)
    v = x.var(dim=axis, keepdim=True, unbiased=False)
    return (x - m) / torch.sqrt(v + eps)
def _scatter_add(tgt, idx, src, axis=0):
    return tgt.clone().index_add_(axis, idx, src)
def _segment_sum(src, seg, n):
    out = torch.zeros((n,) + src.shape[1:], dtype=src.dtype)
    return out.index_add_(0, seg, src)
def _pad(x, pw):
    flat = tuple(v for pair in reversed(pw) for v in pair)
    return torch.nn.functional.pad(x, flat)

kernel_name = 'standalone__deep_cross_xdeepfm__recsys'

def setup_inputs():

    _w = (lambda a: (lambda t: t.to(torch.bfloat16) if t.is_floating_point() else t)(torch.as_tensor(a)))
    B, F, D, L = 1024, 26, 128, 3
    V = min(100000, 100000)
    Din = F * D
    return {
        "idx": _w((lambda lo, hi, *s: torch.randint(lo, hi, s))(0, V, B, F).to(torch.int64)),
        "table": _w((lambda *s: torch.randn(*s, dtype=torch.bfloat16) * 0.8)(V, D)),
        "ws_cin": _w((lambda *s: torch.randn(*s, dtype=torch.bfloat16) * 0.2)(L, F, F, F) * (1.0 / F)),
        "w_cin_out": _w((lambda *s: torch.randn(*s, dtype=torch.bfloat16) * 0.2)(L * F) * ((L * F) ** -0.5)),
        "w_dnn1": _w((lambda *s: torch.randn(*s, dtype=torch.bfloat16) * 0.8)(Din, Din) * (Din ** -0.5)),
        "b_dnn1": _w((lambda *s: torch.randn(*s, dtype=torch.bfloat16) * 3.2)(Din) * 0.1),
        "w_dnn2": _w((lambda *s: torch.randn(*s, dtype=torch.bfloat16) * 0.2)(Din) * (Din ** -0.5)),
        "b_out": _w((lambda *s: torch.randn(*s, dtype=torch.bfloat16) * 0.2)(1)),
    }

def reference(idx, table, ws_cin, w_cin_out, w_dnn1, b_dnn1, w_dnn2, b_out):
    x0 = table[idx]
    B = x0.shape[0]
    L = ws_cin.shape[0]
    xk = x0
    pooled = []
    for l in range(L):
        xk = torch.einsum('bid,bjd,hij->bhd', xk, x0, ws_cin[l])
        pooled.append(xk.sum(axis=-1))
    p_plus = torch.stack(pooled, axis=1).reshape(B, -1)
    logit_cin = p_plus @ w_cin_out
    h = x0.reshape(B, -1)
    h = _gelu(h @ w_dnn1 + b_dnn1)
    logit_dnn = h @ w_dnn2
    return logit_cin + logit_dnn + b_out
```

```asm
; @launch grid=(256,1,1) block=(256,1,1) lds=163840
.amdgcn_target "amdgcn-amd-amdhsa--gfx950"
.text
.globl standalone__deep_cross_xdeepfm__recsys_kernel
.p2align 8
.type standalone__deep_cross_xdeepfm__recsys_kernel,@function
standalone__deep_cross_xdeepfm__recsys_kernel:
    s_load_dwordx16 s[4:19], s[0:1], 0
    s_load_dwordx4 s[20:23], s[0:1], 64
    s_load_dwordx2 s[24:25], s[0:1], 80
    s_cmp_ge_u32 s2, 256
    s_cbranch_scc1 L_end
    s_getpc_b64 s[74:75]
    s_lshr_b32 s71, s2, 3
    s_mul_i32 s70, s71, 1792
    v_min_u32 v1, 13, v0
    v_lshlrev_b32 v1, 7, v1
    v_add_u32 v1, s70, v1
    global_load_dword v15, v1, s[74:75]
    s_mul_i32 s70, s71, 3328
    v_min_u32 v16, 25, v0
    v_lshlrev_b32 v16, 7, v16
    v_add_u32 v16, s70, v16
    v_min_u32 v16, 105452, v16
    v_lshrrev_b32 v1, 6, v0
    v_and_b32 v0, 63, v0
    v_readfirstlane_b32 s66, v1
    s_and_b32 s70, s2, 7
    s_cmp_lt_u32 s71, 6
    s_cbranch_scc1 L_cin
L_gemm:
    s_sub_u32 s71, s71, 6
    s_lshr_b32 s79, s70, 1
    s_mul_i32 s72, s79, 26
    s_add_u32 s72, s72, s71
    s_lshr_b32 s68, s72, 2
    s_and_b32 s72, s72, 3
    s_and_b32 s70, s70, 1
    s_lshl_b32 s70, s70, 2
    s_add_u32 s67, s70, s72
    v_lshlrev_b32 v1, 4, v0
    s_lshl_b32 s70, s66, 10
    s_mul_i32 s73, s67, 13312
    s_add_u32 s73, s73, s70
    s_add_u32 s78, s70, 131072
    s_mov_b32 s30, 106496
    s_mov_b32 s31, 0x00020000
    s_mov_b32 s38, 22151168
    s_mov_b32 s39, 0x00020000
    s_waitcnt lgkmcnt(0)
    s_mov_b32 s28, s4
    s_mov_b32 s29, s5
    s_add_u32 m0, s78, 0
    s_add_u32 s70, s73, 0
    buffer_load_dwordx4 v1, s[28:31], s70 offen lds
    s_add_u32 m0, s78, 4096
    s_add_u32 s70, s73, 4096
    buffer_load_dwordx4 v1, s[28:31], s70 offen lds
    s_add_u32 m0, s78, 8192
    s_add_u32 s70, s73, 8192
    buffer_load_dwordx4 v1, s[28:31], s70 offen lds
    s_cmp_lg_u32 s66, 0
    s_cbranch_scc1 L_noidx4
    s_add_u32 m0, s78, 12288
    s_add_u32 s70, s73, 12288
    buffer_load_dwordx4 v1, s[28:31], s70 offen lds
L_noidx4:
    s_mov_b32 s36, s12
    s_mov_b32 s37, s13
    global_load_dword v15, v16, s[8:9]
    s_add_u32 s70, s67, s68
    s_and_b32 s76, s70, 1
    s_xor_b32 s77, s76, 1
    s_mov_b32 s56, 0
    s_mov_b32 s57, 6656
    s_mov_b32 s58, 13312
    s_mov_b32 s59, 19968
    s_mov_b32 s60, 26624
    s_mov_b32 s61, 33280
    s_mov_b32 s62, 39936
    s_mov_b32 s63, 46592
    s_mov_b32 s64, 0x05040100
    s_mov_b32 s65, 0x07060302
    v_and_b32 v13, 15, v0
    v_lshrrev_b32 v14, 4, v0
    s_mul_i32 s70, s66, 425984
    s_lshl_b32 s71, s68, 8
    s_add_u32 s70, s70, s71
    v_mul_u32_u24 v6, 53248, v14
    v_lshl_add_u32 v6, v13, 4, v6
    v_add_u32 v6, s70, v6
    s_mov_b32 s40, s14
    s_mov_b32 s41, s15
    s_mov_b32 s42, 6656
    s_mov_b32 s43, 0x00020000
    v_lshlrev_b32 v2, 6, v14
    v_add_u32 v2, s71, v2
    s_and_b32 s73, s66, 1
    s_lshl_b32 s73, s73, 7
    v_and_b32 v1, 7, v0
    v_xor_b32 v1, v1, v14
    v_lshlrev_b32 v1, 4, v1
    v_add_u32 v10, s73, v1
    v_xor_b32 v11, 64, v10
    s_lshr_b32 s71, s66, 1
    s_lshl_b32 s71, s71, 2
    s_add_u32 s71, s71, 131072
    v_lshrrev_b32 v1, 3, v0
    v_mul_u32_u24 v1, 104, v1
    v_add_u32 v1, s71, v1
    s_add_u32 s70, s66, 0
    s_and_b32 s70, s70, 3
    s_mul_i32 s70, s70, 3328
    v_add_u32 v96, s70, v1
    s_add_u32 s70, s66, 1
    s_and_b32 s70, s70, 3
    s_mul_i32 s70, s70, 3328
    v_add_u32 v97, s70, v1
    s_add_u32 s70, s66, 2
    s_and_b32 s70, s70, 3
    s_mul_i32 s70, s70, 3328
    v_add_u32 v98, s70, v1
    s_add_u32 s70, s66, 3
    s_and_b32 s70, s70, 3
    s_mul_i32 s70, s70, 3328
    v_add_u32 v99, s70, v1
    s_lshl_b32 s78, s66, 15
    v_lshrrev_b32 v1, 1, v13
    v_xor_b32 v1, v1, v14
    v_lshlrev_b32 v1, 4, v1
    v_lshl_add_u32 v1, v13, 7, v1
    v_add_u32 v12, s78, v1
    v_xor_b32 v13, 64, v12
    s_mov_b32 s32, s6
    s_mov_b32 s33, s7
    s_mov_b32 s34, 25600000
    s_mov_b32 s35, 0x00020000
    s_mov_b32 s44, s16
    s_mov_b32 s45, s17
    s_mov_b32 s46, 6656
    s_mov_b32 s47, 0x00020000
    s_mov_b32 s48, s24
    s_mov_b32 s49, s25
    s_mov_b32 s50, 16777216
    s_mov_b32 s51, 0x00020000
    s_mul_i32 s72, s76, 1703936
    v_add_u32 v7, s72, v6
    buffer_load_dwordx4 v[32:35], v7, s[36:39], s56 offen
    buffer_load_dwordx4 v[36:39], v7, s[36:39], s57 offen
    buffer_load_dwordx4 v[40:43], v7, s[36:39], s58 offen
    buffer_load_dwordx4 v[44:47], v7, s[36:39], s59 offen
    buffer_load_dwordx4 v[48:51], v7, s[36:39], s60 offen
    buffer_load_dwordx4 v[52:55], v7, s[36:39], s61 offen
    buffer_load_dwordx4 v[56:59], v7, s[36:39], s62 offen
    buffer_load_dwordx4 v[60:63], v7, s[36:39], s63 offen
    s_waitcnt vmcnt(9)
    s_barrier
    s_lshl_b32 s72, s76, 3
    v_add_u32 v101, s72, v97
    ds_read_b32 v108, v101 offset:0
    ds_read_b32 v109, v101 offset:832
    ds_read_b32 v110, v101 offset:1664
    ds_read_b32 v111, v101 offset:2496
    s_lshl_b32 s72, s76, 3
    v_add_u32 v102, s72, v98
    ds_read_b32 v112, v102 offset:0
    ds_read_b32 v113, v102 offset:832
    ds_read_b32 v114, v102 offset:1664
    ds_read_b32 v115, v102 offset:2496
    s_lshl_b32 s72, s76, 3
    v_add_u32 v103, s72, v99
    ds_read_b32 v116, v103 offset:0
    ds_read_b32 v117, v103 offset:832
    ds_read_b32 v118, v103 offset:1664
    ds_read_b32 v119, v103 offset:2496
    s_waitcnt lgkmcnt(11)
    s_add_u32 m0, s78, 4096
    v_lshl_add_u32 v108, v108, 8, v10
    buffer_load_dwordx4 v108, s[32:35], 0 offen lds
    s_waitcnt lgkmcnt(10)
    s_add_u32 m0, s78, 5120
    v_lshl_add_u32 v109, v109, 8, v11
    buffer_load_dwordx4 v109, s[32:35], 0 offen lds
    s_waitcnt lgkmcnt(9)
    s_add_u32 m0, s78, 6144
    v_lshl_add_u32 v110, v110, 8, v10
    buffer_load_dwordx4 v110, s[32:35], 0 offen lds
    s_waitcnt lgkmcnt(8)
    s_add_u32 m0, s78, 7168
    v_lshl_add_u32 v111, v111, 8, v11
    buffer_load_dwordx4 v111, s[32:35], 0 offen lds
    s_lshl_b32 s72, s76, 3
    v_add_u32 v100, s72, v96
    ds_read_b32 v104, v100 offset:0
    ds_read_b32 v105, v100 offset:832
    ds_read_b32 v106, v100 offset:1664
    ds_read_b32 v107, v100 offset:2496
    v_add_u32 v7, 212992, v7
    buffer_load_dwordx4 v[64:67], v7, s[36:39], s56 offen
    buffer_load_dwordx4 v[68:71], v7, s[36:39], s57 offen
    buffer_load_dwordx4 v[72:75], v7, s[36:39], s58 offen
    buffer_load_dwordx4 v[76:79], v7, s[36:39], s59 offen
    buffer_load_dwordx4 v[80:83], v7, s[36:39], s60 offen
    buffer_load_dwordx4 v[84:87], v7, s[36:39], s61 offen
    buffer_load_dwordx4 v[88:91], v7, s[36:39], s62 offen
    buffer_load_dwordx4 v[92:95], v7, s[36:39], s63 offen
    s_waitcnt lgkmcnt(11)
    s_add_u32 m0, s78, 8192
    v_lshl_add_u32 v112, v112, 8, v10
    buffer_load_dwordx4 v112, s[32:35], 0 offen lds
    s_waitcnt lgkmcnt(10)
    s_add_u32 m0, s78, 9216
    v_lshl_add_u32 v113, v113, 8, v11
    buffer_load_dwordx4 v113, s[32:35], 0 offen lds
    s_waitcnt lgkmcnt(9)
    s_add_u32 m0, s78, 10240
    v_lshl_add_u32 v114, v114, 8, v10
    buffer_load_dwordx4 v114, s[32:35], 0 offen lds
    s_waitcnt lgkmcnt(8)
    s_add_u32 m0, s78, 11264
    v_lshl_add_u32 v115, v115, 8, v11
    buffer_load_dwordx4 v115, s[32:35], 0 offen lds
    s_waitcnt lgkmcnt(7)
    s_add_u32 m0, s78, 12288
    v_lshl_add_u32 v116, v116, 8, v10
    buffer_load_dwordx4 v116, s[32:35], 0 offen lds
    s_waitcnt lgkmcnt(6)
    s_add_u32 m0, s78, 13312
    v_lshl_add_u32 v117, v117, 8, v11
    buffer_load_dwordx4 v117, s[32:35], 0 offen lds
    s_waitcnt lgkmcnt(5)
    s_add_u32 m0, s78, 14336
    v_lshl_add_u32 v118, v118, 8, v10
    buffer_load_dwordx4 v118, s[32:35], 0 offen lds
    s_waitcnt lgkmcnt(4)
    s_add_u32 m0, s78, 15360
    v_lshl_add_u32 v119, v119, 8, v11
    buffer_load_dwordx4 v119, s[32:35], 0 offen lds
    buffer_load_dwordx4 v[16:19], v2, s[40:43], 0 offen offset:0
    buffer_load_dwordx4 v[20:23], v2, s[40:43], 0 offen offset:16
    buffer_load_dwordx4 v[24:27], v2, s[40:43], 0 offen offset:32
    buffer_load_dwordx4 v[28:31], v2, s[40:43], 0 offen offset:48
    s_waitcnt lgkmcnt(3)
    s_add_u32 m0, s78, 0
    v_lshl_add_u32 v104, v104, 8, v10
    buffer_load_dwordx4 v104, s[32:35], 0 offen lds
    s_waitcnt lgkmcnt(2)
    s_add_u32 m0, s78, 1024
    v_lshl_add_u32 v105, v105, 8, v11
    buffer_load_dwordx4 v105, s[32:35], 0 offen lds
    s_waitcnt lgkmcnt(1)
    s_add_u32 m0, s78, 2048
    v_lshl_add_u32 v106, v106, 8, v10
    buffer_load_dwordx4 v106, s[32:35], 0 offen lds
    s_waitcnt lgkmcnt(0)
    s_add_u32 m0, s78, 3072
    v_lshl_add_u32 v107, v107, 8, v11
    buffer_load_dwordx4 v107, s[32:35], 0 offen lds
    s_waitcnt vmcnt(28)
    v_perm_b32 v192, v36, v32, s64
    v_perm_b32 v193, v44, v40, s64
    v_perm_b32 v194, v52, v48, s64
    v_perm_b32 v195, v60, v56, s64
    v_perm_b32 v196, v36, v32, s65
    v_perm_b32 v197, v44, v40, s65
    v_perm_b32 v198, v52, v48, s65
    v_perm_b32 v199, v60, v56, s65
    v_perm_b32 v200, v37, v33, s64
    v_perm_b32 v201, v45, v41, s64
    v_perm_b32 v202, v53, v49, s64
    v_perm_b32 v203, v61, v57, s64
    v_perm_b32 v204, v37, v33, s65
    v_perm_b32 v205, v45, v41, s65
    v_perm_b32 v206, v53, v49, s65
    v_perm_b32 v207, v61, v57, s65
    v_perm_b32 v208, v38, v34, s64
    v_perm_b32 v209, v46, v42, s64
    v_perm_b32 v210, v54, v50, s64
    v_perm_b32 v211, v62, v58, s64
    v_perm_b32 v212, v38, v34, s65
    v_perm_b32 v213, v46, v42, s65
    v_perm_b32 v214, v54, v50, s65
    v_perm_b32 v215, v62, v58, s65
    v_perm_b32 v216, v39, v35, s64
    v_perm_b32 v217, v47, v43, s64
    v_perm_b32 v218, v55, v51, s64
    v_perm_b32 v219, v63, v59, s64
    v_perm_b32 v220, v39, v35, s65
    v_perm_b32 v221, v47, v43, s65
    v_perm_b32 v222, v55, v51, s65
    v_perm_b32 v223, v63, v59, s65
    s_waitcnt vmcnt(16)
    v_perm_b32 v224, v68, v64, s64
    v_perm_b32 v225, v76, v72, s64
    v_perm_b32 v226, v84, v80, s64
    v_perm_b32 v227, v92, v88, s64
    v_perm_b32 v228, v68, v64, s65
    v_perm_b32 v229, v76, v72, s65
    v_perm_b32 v230, v84, v80, s65
    v_perm_b32 v231, v92, v88, s65
    v_perm_b32 v232, v69, v65, s64
    v_perm_b32 v233, v77, v73, s64
    v_perm_b32 v234, v85, v81, s64
    v_perm_b32 v235, v93, v89, s64
    v_perm_b32 v236, v69, v65, s65
    v_perm_b32 v237, v77, v73, s65
    v_perm_b32 v238, v85, v81, s65
    v_perm_b32 v239, v93, v89, s65
    v_perm_b32 v240, v70, v66, s64
    v_perm_b32 v241, v78, v74, s64
    v_perm_b32 v242, v86, v82, s64
    v_perm_b32 v243, v94, v90, s64
    v_perm_b32 v244, v70, v66, s65
    v_perm_b32 v245, v78, v74, s65
    v_perm_b32 v246, v86, v82, s65
    v_perm_b32 v247, v94, v90, s65
    v_perm_b32 v248, v71, v67, s64
    v_perm_b32 v249, v79, v75, s64
    v_perm_b32 v250, v87, v83, s64
    v_perm_b32 v251, v95, v91, s64
    v_perm_b32 v252, v71, v67, s65
    v_perm_b32 v253, v79, v75, s65
    v_perm_b32 v254, v87, v83, s65
    v_perm_b32 v255, v95, v91, s65
    ds_read_b128 a[128:131], v12 offset:4096
    ds_read_b128 a[132:135], v13 offset:4096
    ds_read_b128 a[136:139], v12 offset:6144
    ds_read_b128 a[140:143], v13 offset:6144
    s_mov_b32 s73, 0xffff0000
    s_waitcnt lgkmcnt(3)
    v_mfma_f32_16x16x32_bf16 a[192:195], v[192:195], a[128:131], 0
    s_waitcnt lgkmcnt(2)
    v_mfma_f32_16x16x32_bf16 a[192:195], v[224:227], a[132:135], a[192:195]
    v_mfma_f32_16x16x32_bf16 a[196:199], v[228:231], a[132:135], 0
    v_mfma_f32_16x16x32_bf16 a[196:199], v[196:199], a[128:131], a[196:199]
    s_waitcnt vmcnt(14)
    ds_read_b128 a[144:147], v12 offset:8192
    v_mfma_f32_16x16x32_bf16 a[200:203], v[200:203], a[128:131], 0
    s_lshl_b32 s72, s77, 3
    v_add_u32 v100, s72, v96
    ds_read_b32 v104, v100 offset:0
    v_mfma_f32_16x16x32_bf16 a[200:203], v[232:235], a[132:135], a[200:203]
    v_mfma_f32_16x16x32_bf16 a[204:207], v[236:239], a[132:135], 0
    v_mfma_f32_16x16x32_bf16 a[204:207], v[204:207], a[128:131], a[204:207]
    v_mfma_f32_16x16x32_bf16 a[208:211], v[208:211], a[128:131], 0
    s_mul_i32 s72, s77, 1703936
    v_add_u32 v7, s72, v6
    buffer_load_dwordx4 v[32:35], v7, s[36:39], s56 offen
    v_mfma_f32_16x16x32_bf16 a[208:211], v[240:243], a[132:135], a[208:211]
    v_mfma_f32_16x16x32_bf16 a[212:215], v[244:247], a[132:135], 0
    s_waitcnt lgkmcnt(0)
    s_add_u32 m0, s78, 16384
    v_lshl_add_u32 v104, v104, 8, v10
    buffer_load_dwordx4 v104, s[32:35], 0 offen lds
    ds_read_b128 a[148:151], v13 offset:8192
    v_mfma_f32_16x16x32_bf16 a[212:215], v[212:215], a[128:131], a[212:215]
    v_mfma_f32_16x16x32_bf16 a[216:219], v[216:219], a[128:131], 0
    buffer_load_dwordx4 v[36:39], v7, s[36:39], s57 offen
    ds_read_b32 v105, v100 offset:832
    v_mfma_f32_16x16x32_bf16 a[216:219], v[248:251], a[132:135], a[216:219]
    v_mfma_f32_16x16x32_bf16 a[220:223], v[252:255], a[132:135], 0
    v_mfma_f32_16x16x32_bf16 a[220:223], v[220:223], a[128:131], a[220:223]
    v_mfma_f32_16x16x32_bf16 a[224:227], v[192:195], a[136:139], 0
    buffer_load_dwordx4 v[40:43], v7, s[36:39], s58 offen
    v_mfma_f32_16x16x32_bf16 a[224:227], v[224:227], a[140:143], a[224:227]
    v_mfma_f32_16x16x32_bf16 a[228:231], v[228:231], a[140:143], 0
    s_waitcnt lgkmcnt(0)
    s_add_u32 m0, s78, 17408
    v_lshl_add_u32 v105, v105, 8, v11
    buffer_load_dwordx4 v105, s[32:35], 0 offen lds
    v_mfma_f32_16x16x32_bf16 a[228:231], v[196:199], a[136:139], a[228:231]
    s_waitcnt vmcnt(17)
    ds_read_b128 a[152:155], v12 offset:10240
    v_mfma_f32_16x16x32_bf16 a[232:235], v[200:203], a[136:139], 0
    buffer_load_dwordx4 v[44:47], v7, s[36:39], s59 offen
    ds_read_b32 v106, v100 offset:1664
    s_waitcnt vmcnt(10)
    v_lshlrev_b32 v128, 16, v16
    v_mfma_f32_16x16x32_bf16 a[232:235], v[232:235], a[140:143], a[232:235]
    v_lshlrev_b32 v160, 16, v16
    v_mfma_f32_16x16x32_bf16 a[236:239], v[236:239], a[140:143], 0
    v_lshlrev_b32 v129, 16, v20
    v_mfma_f32_16x16x32_bf16 a[236:239], v[204:207], a[136:139], a[236:239]
    v_lshlrev_b32 v161, 16, v20
    v_mfma_f32_16x16x32_bf16 a[240:243], v[208:211], a[136:139], 0
    buffer_load_dwordx4 v[48:51], v7, s[36:39], s60 offen
    v_lshlrev_b32 v130, 16, v24
    v_mfma_f32_16x16x32_bf16 a[240:243], v[240:243], a[140:143], a[240:243]
    v_lshlrev_b32 v162, 16, v24
    v_mfma_f32_16x16x32_bf16 a[244:247], v[244:247], a[140:143], 0
    s_waitcnt lgkmcnt(0)
    s_add_u32 m0, s78, 18432
    v_lshl_add_u32 v106, v106, 8, v10
    buffer_load_dwordx4 v106, s[32:35], 0 offen lds
    ds_read_b128 a[156:159], v13 offset:10240
    v_lshlrev_b32 v131, 16, v28
    v_mfma_f32_16x16x32_bf16 a[244:247], v[212:215], a[136:139], a[244:247]
    v_lshlrev_b32 v163, 16, v28
    v_mfma_f32_16x16x32_bf16 a[248:251], v[216:219], a[136:139], 0
    buffer_load_dwordx4 v[52:55], v7, s[36:39], s61 offen
    ds_read_b32 v107, v100 offset:2496
    v_and_b32 v132, s73, v16
    v_mfma_f32_16x16x32_bf16 a[248:251], v[248:251], a[140:143], a[248:251]
    v_and_b32 v164, s73, v16
    v_mfma_f32_16x16x32_bf16 a[252:255], v[252:255], a[140:143], 0
    v_and_b32 v133, s73, v20
    v_mfma_f32_16x16x32_bf16 a[252:255], v[220:223], a[136:139], a[252:255]
    v_and_b32 v165, s73, v20
    v_mfma_f32_16x16x32_bf16 a[0:3], v[192:195], a[144:147], 0
    buffer_load_dwordx4 v[56:59], v7, s[36:39], s62 offen
    v_and_b32 v134, s73, v24
    v_mfma_f32_16x16x32_bf16 a[0:3], v[224:227], a[148:151], a[0:3]
    v_and_b32 v166, s73, v24
    v_mfma_f32_16x16x32_bf16 a[4:7], v[228:231], a[148:151], 0
    s_waitcnt lgkmcnt(0)
    s_add_u32 m0, s78, 19456
    v_lshl_add_u32 v107, v107, 8, v11
    buffer_load_dwordx4 v107, s[32:35], 0 offen lds
    v_and_b32 v135, s73, v28
    v_mfma_f32_16x16x32_bf16 a[4:7], v[196:199], a[144:147], a[4:7]
    ds_read_b128 a[160:163], v12 offset:12288
    v_and_b32 v167, s73, v28
    v_mfma_f32_16x16x32_bf16 a[8:11], v[200:203], a[144:147], 0
    buffer_load_dwordx4 v[60:63], v7, s[36:39], s63 offen
    s_lshl_b32 s72, s77, 3
    v_add_u32 v101, s72, v97
    ds_read_b32 v108, v101 offset:0
    v_lshlrev_b32 v136, 16, v17
    v_mfma_f32_16x16x32_bf16 a[8:11], v[232:235], a[148:151], a[8:11]
    v_lshlrev_b32 v168, 16, v17
    v_mfma_f32_16x16x32_bf16 a[12:15], v[236:239], a[148:151], 0
    v_lshlrev_b32 v137, 16, v21
    v_mfma_f32_16x16x32_bf16 a[12:15], v[204:207], a[144:147], a[12:15]
    v_lshlrev_b32 v169, 16, v21
    v_mfma_f32_16x16x32_bf16 a[16:19], v[208:211], a[144:147], 0
    v_add_u32 v7, 212992, v7
    buffer_load_dwordx4 v[64:67], v7, s[36:39], s56 offen
    v_lshlrev_b32 v138, 16, v25
    v_mfma_f32_16x16x32_bf16 a[16:19], v[240:243], a[148:151], a[16:19]
    v_lshlrev_b32 v170, 16, v25
    v_mfma_f32_16x16x32_bf16 a[20:23], v[244:247], a[148:151], 0
    s_waitcnt lgkmcnt(0)
    s_add_u32 m0, s78, 20480
    v_lshl_add_u32 v108, v108, 8, v10
    buffer_load_dwordx4 v108, s[32:35], 0 offen lds
    ds_read_b128 a[164:167], v13 offset:12288
    v_lshlrev_b32 v139, 16, v29
    v_mfma_f32_16x16x32_bf16 a[20:23], v[212:215], a[144:147], a[20:23]
    v_lshlrev_b32 v171, 16, v29
    v_mfma_f32_16x16x32_bf16 a[24:27], v[216:219], a[144:147], 0
    buffer_load_dwordx4 v[68:71], v7, s[36:39], s57 offen
    ds_read_b32 v109, v101 offset:832
    v_and_b32 v140, s73, v17
    v_mfma_f32_16x16x32_bf16 a[24:27], v[248:251], a[148:151], a[24:27]
    v_and_b32 v172, s73, v17
    v_mfma_f32_16x16x32_bf16 a[28:31], v[252:255], a[148:151], 0
    v_and_b32 v141, s73, v21
    v_mfma_f32_16x16x32_bf16 a[28:31], v[220:223], a[144:147], a[28:31]
    v_and_b32 v173, s73, v21
    v_mfma_f32_16x16x32_bf16 a[32:35], v[192:195], a[152:155], 0
    buffer_load_dwordx4 v[72:75], v7, s[36:39], s58 offen
    v_and_b32 v142, s73, v25
    v_mfma_f32_16x16x32_bf16 a[32:35], v[224:227], a[156:159], a[32:35]
    v_and_b32 v174, s73, v25
    v_mfma_f32_16x16x32_bf16 a[36:39], v[228:231], a[156:159], 0
    s_waitcnt lgkmcnt(0)
    s_add_u32 m0, s78, 21504
    v_lshl_add_u32 v109, v109, 8, v11
    buffer_load_dwordx4 v109, s[32:35], 0 offen lds
    v_and_b32 v143, s73, v29
    v_mfma_f32_16x16x32_bf16 a[36:39], v[196:199], a[152:155], a[36:39]
    ds_read_b128 a[168:171], v12 offset:14336
    v_and_b32 v175, s73, v29
    v_mfma_f32_16x16x32_bf16 a[40:43], v[200:203], a[152:155], 0
    buffer_load_dwordx4 v[76:79], v7, s[36:39], s59 offen
    v_lshlrev_b32 v144, 16, v18
    v_mfma_f32_16x16x32_bf16 a[40:43], v[232:235], a[156:159], a[40:43]
    v_lshlrev_b32 v176, 16, v18
    v_mfma_f32_16x16x32_bf16 a[44:47], v[236:239], a[156:159], 0
    v_lshlrev_b32 v145, 16, v22
    v_mfma_f32_16x16x32_bf16 a[44:47], v[204:207], a[152:155], a[44:47]
    v_lshlrev_b32 v177, 16, v22
    v_mfma_f32_16x16x32_bf16 a[48:51], v[208:211], a[152:155], 0
    buffer_load_dwordx4 v[80:83], v7, s[36:39], s60 offen
    v_lshlrev_b32 v146, 16, v26
    v_mfma_f32_16x16x32_bf16 a[48:51], v[240:243], a[156:159], a[48:51]
    v_lshlrev_b32 v178, 16, v26
    v_mfma_f32_16x16x32_bf16 a[52:55], v[244:247], a[156:159], 0
    ds_read_b128 a[172:175], v13 offset:14336
    v_lshlrev_b32 v147, 16, v30
    v_mfma_f32_16x16x32_bf16 a[52:55], v[212:215], a[152:155], a[52:55]
    v_lshlrev_b32 v179, 16, v30
    v_mfma_f32_16x16x32_bf16 a[56:59], v[216:219], a[152:155], 0
    buffer_load_dwordx4 v[84:87], v7, s[36:39], s61 offen
    v_and_b32 v148, s73, v18
    v_mfma_f32_16x16x32_bf16 a[56:59], v[248:251], a[156:159], a[56:59]
    v_and_b32 v180, s73, v18
    v_mfma_f32_16x16x32_bf16 a[60:63], v[252:255], a[156:159], 0
    v_and_b32 v149, s73, v22
    v_mfma_f32_16x16x32_bf16 a[60:63], v[220:223], a[152:155], a[60:63]
    v_and_b32 v181, s73, v22
    v_mfma_f32_16x16x32_bf16 a[64:67], v[192:195], a[160:163], 0
    buffer_load_dwordx4 v[88:91], v7, s[36:39], s62 offen
    v_and_b32 v150, s73, v26
    v_mfma_f32_16x16x32_bf16 a[64:67], v[224:227], a[164:167], a[64:67]
    v_and_b32 v182, s73, v26
    v_mfma_f32_16x16x32_bf16 a[68:71], v[228:231], a[164:167], 0
    ds_read_b32 v110, v101 offset:1664
    v_and_b32 v151, s73, v30
    v_mfma_f32_16x16x32_bf16 a[68:71], v[196:199], a[160:163], a[68:71]
    s_waitcnt vmcnt(23)
    ds_read_b128 a[176:179], v12 offset:0
    v_and_b32 v183, s73, v30
    v_mfma_f32_16x16x32_bf16 a[72:75], v[200:203], a[160:163], 0
    buffer_load_dwordx4 v[92:95], v7, s[36:39], s63 offen
    v_lshlrev_b32 v152, 16, v19
    v_mfma_f32_16x16x32_bf16 a[72:75], v[232:235], a[164:167], a[72:75]
    v_lshlrev_b32 v184, 16, v19
    v_mfma_f32_16x16x32_bf16 a[76:79], v[236:239], a[164:167], 0
    ds_read_b32 v111, v101 offset:2496
    v_lshlrev_b32 v153, 16, v23
    v_mfma_f32_16x16x32_bf16 a[76:79], v[204:207], a[160:163], a[76:79]
    v_lshlrev_b32 v185, 16, v23
    v_mfma_f32_16x16x32_bf16 a[80:83], v[208:211], a[160:163], 0
    s_waitcnt lgkmcnt(2)
    s_add_u32 m0, s78, 22528
    v_lshl_add_u32 v110, v110, 8, v10
    buffer_load_dwordx4 v110, s[32:35], 0 offen lds
    v_lshlrev_b32 v154, 16, v27
    v_mfma_f32_16x16x32_bf16 a[80:83], v[240:243], a[164:167], a[80:83]
    v_lshlrev_b32 v186, 16, v27
    v_mfma_f32_16x16x32_bf16 a[84:87], v[244:247], a[164:167], 0
    s_lshl_b32 s72, s77, 3
    v_add_u32 v102, s72, v98
    ds_read_b32 v112, v102 offset:0
    ds_read_b128 a[180:183], v13 offset:0
    v_lshlrev_b32 v155, 16, v31
    v_mfma_f32_16x16x32_bf16 a[84:87], v[212:215], a[160:163], a[84:87]
    v_lshlrev_b32 v187, 16, v31
    v_mfma_f32_16x16x32_bf16 a[88:91], v[216:219], a[160:163], 0
    s_waitcnt lgkmcnt(2)
    s_add_u32 m0, s78, 23552
    v_lshl_add_u32 v111, v111, 8, v11
    buffer_load_dwordx4 v111, s[32:35], 0 offen lds
    v_and_b32 v156, s73, v19
    v_mfma_f32_16x16x32_bf16 a[88:91], v[248:251], a[164:167], a[88:91]
    v_and_b32 v188, s73, v19
    v_mfma_f32_16x16x32_bf16 a[92:95], v[252:255], a[164:167], 0
    ds_read_b32 v113, v102 offset:832
    v_and_b32 v157, s73, v23
    v_mfma_f32_16x16x32_bf16 a[92:95], v[220:223], a[160:163], a[92:95]
    v_and_b32 v189, s73, v23
    v_mfma_f32_16x16x32_bf16 a[96:99], v[192:195], a[168:171], 0
    s_waitcnt lgkmcnt(2)
    s_add_u32 m0, s78, 24576
    v_lshl_add_u32 v112, v112, 8, v10
    buffer_load_dwordx4 v112, s[32:35], 0 offen lds
    v_and_b32 v158, s73, v27
    v_mfma_f32_16x16x32_bf16 a[96:99], v[224:227], a[172:175], a[96:99]
    v_and_b32 v190, s73, v27
    v_mfma_f32_16x16x32_bf16 a[100:103], v[228:231], a[172:175], 0
    ds_read_b32 v114, v102 offset:1664
    v_and_b32 v159, s73, v31
    v_mfma_f32_16x16x32_bf16 a[100:103], v[196:199], a[168:171], a[100:103]
    s_waitcnt vmcnt(25)
    ds_read_b128 a[184:187], v12 offset:2048
    v_and_b32 v191, s73, v31
    v_mfma_f32_16x16x32_bf16 a[104:107], v[200:203], a[168:171], 0
    s_waitcnt lgkmcnt(2)
    s_add_u32 m0, s78, 25600
    v_lshl_add_u32 v113, v113, 8, v11
    buffer_load_dwordx4 v113, s[32:35], 0 offen lds
    v_mfma_f32_16x16x32_bf16 a[104:107], v[232:235], a[172:175], a[104:107]
    v_mfma_f32_16x16x32_bf16 a[108:111], v[236:239], a[172:175], 0
    ds_read_b32 v115, v102 offset:2496
    v_mfma_f32_16x16x32_bf16 a[108:111], v[204:207], a[168:171], a[108:111]
    v_mfma_f32_16x16x32_bf16 a[112:115], v[208:211], a[168:171], 0
    s_waitcnt lgkmcnt(2)
    s_add_u32 m0, s78, 26624
    v_lshl_add_u32 v114, v114, 8, v10
    buffer_load_dwordx4 v114, s[32:35], 0 offen lds
    v_mfma_f32_16x16x32_bf16 a[112:115], v[240:243], a[172:175], a[112:115]
    v_mfma_f32_16x16x32_bf16 a[116:119], v[244:247], a[172:175], 0
    s_lshl_b32 s72, s77, 3
    v_add_u32 v103, s72, v99
    ds_read_b32 v116, v103 offset:0
    ds_read_b128 a[188:191], v13 offset:2048
    v_mfma_f32_16x16x32_bf16 a[116:119], v[212:215], a[168:171], a[116:119]
    v_mfma_f32_16x16x32_bf16 a[120:123], v[216:219], a[168:171], 0
    s_waitcnt lgkmcnt(2)
    s_add_u32 m0, s78, 27648
    v_lshl_add_u32 v115, v115, 8, v11
    buffer_load_dwordx4 v115, s[32:35], 0 offen lds
    v_mfma_f32_16x16x32_bf16 a[120:123], v[248:251], a[172:175], a[120:123]
    v_mfma_f32_16x16x32_bf16 a[124:127], v[252:255], a[172:175], 0
    ds_read_b32 v117, v103 offset:832
    v_mfma_f32_16x16x32_bf16 a[124:127], v[220:223], a[168:171], a[124:127]
    v_mfma_f32_16x16x32_bf16 v[128:131], v[192:195], a[176:179], v[128:131]
    s_waitcnt lgkmcnt(2)
    s_add_u32 m0, s78, 28672
    v_lshl_add_u32 v116, v116, 8, v10
    buffer_load_dwordx4 v116, s[32:35], 0 offen lds
    v_mfma_f32_16x16x32_bf16 v[128:131], v[224:227], a[180:183], v[128:131]
    v_mfma_f32_16x16x32_bf16 v[132:135], v[228:231], a[180:183], v[132:135]
    ds_read_b32 v118, v103 offset:1664
    v_mfma_f32_16x16x32_bf16 v[132:135], v[196:199], a[176:179], v[132:135]
    s_waitcnt vmcnt(24)
    ds_read_b128 a[128:131], v12 offset:16384
    v_mfma_f32_16x16x32_bf16 v[136:139], v[200:203], a[176:179], v[136:139]
    s_waitcnt lgkmcnt(2)
    s_add_u32 m0, s78, 29696
    v_lshl_add_u32 v117, v117, 8, v11
    buffer_load_dwordx4 v117, s[32:35], 0 offen lds
    v_mfma_f32_16x16x32_bf16 v[136:139], v[232:235], a[180:183], v[136:139]
    v_mfma_f32_16x16x32_bf16 v[140:143], v[236:239], a[180:183], v[140:143]
    ds_read_b32 v119, v103 offset:2496
    v_mfma_f32_16x16x32_bf16 v[140:143], v[204:207], a[176:179], v[140:143]
    v_mfma_f32_16x16x32_bf16 v[144:147], v[208:211], a[176:179], v[144:147]
    s_waitcnt lgkmcnt(2)
    s_add_u32 m0, s78, 30720
    v_lshl_add_u32 v118, v118, 8, v10
    buffer_load_dwordx4 v118, s[32:35], 0 offen lds
    v_mfma_f32_16x16x32_bf16 v[144:147], v[240:243], a[180:183], v[144:147]
    v_mfma_f32_16x16x32_bf16 v[148:151], v[244:247], a[180:183], v[148:151]
    ds_read_b32 v104, v96 offset:16
    ds_read_b128 a[132:135], v13 offset:16384
    v_mfma_f32_16x16x32_bf16 v[148:151], v[212:215], a[176:179], v[148:151]
    v_mfma_f32_16x16x32_bf16 v[152:155], v[216:219], a[176:179], v[152:155]
    s_waitcnt lgkmcnt(2)
    s_add_u32 m0, s78, 31744
    v_lshl_add_u32 v119, v119, 8, v11
    buffer_load_dwordx4 v119, s[32:35], 0 offen lds
    v_mfma_f32_16x16x32_bf16 v[152:155], v[248:251], a[180:183], v[152:155]
    v_mfma_f32_16x16x32_bf16 v[156:159], v[252:255], a[180:183], v[156:159]
    ds_read_b32 v105, v96 offset:848
    v_mfma_f32_16x16x32_bf16 v[156:159], v[220:223], a[176:179], v[156:159]
    v_mfma_f32_16x16x32_bf16 v[160:163], v[192:195], a[184:187], v[160:163]
    s_waitcnt lgkmcnt(2)
    s_add_u32 m0, s78, 0
    v_lshl_add_u32 v104, v104, 8, v10
    buffer_load_dwordx4 v104, s[32:35], 0 offen lds
    v_mfma_f32_16x16x32_bf16 v[160:163], v[224:227], a[188:191], v[160:163]
    s_waitcnt vmcnt(21)
    v_perm_b32 v192, v36, v32, s64
    v_perm_b32 v193, v44, v40, s64
    v_perm_b32 v194, v52, v48, s64
    v_mfma_f32_16x16x32_bf16 v[164:167], v[228:231], a[188:191], v[164:167]
    v_perm_b32 v195, v60, v56, s64
    s_waitcnt vmcnt(11)
    v_perm_b32 v224, v68, v64, s64
    v_perm_b32 v225, v76, v72, s64
    ds_read_b32 v106, v96 offset:1680
    v_mfma_f32_16x16x32_bf16 v[164:167], v[196:199], a[184:187], v[164:167]
    v_perm_b32 v226, v84, v80, s64
    v_perm_b32 v227, v92, v88, s64
    v_perm_b32 v228, v68, v64, s65
    ds_read_b128 a[136:139], v12 offset:18432
    v_mfma_f32_16x16x32_bf16 v[168:171], v[200:203], a[184:187], v[168:171]
    v_perm_b32 v229, v76, v72, s65
    v_perm_b32 v230, v84, v80, s65
    v_perm_b32 v231, v92, v88, s65
    s_waitcnt lgkmcnt(2)
    s_add_u32 m0, s78, 1024
    v_lshl_add_u32 v105, v105, 8, v11
    buffer_load_dwordx4 v105, s[32:35], 0 offen lds
    v_mfma_f32_16x16x32_bf16 v[168:171], v[232:235], a[188:191], v[168:171]
    v_perm_b32 v196, v36, v32, s65
    v_perm_b32 v197, v44, v40, s65
    v_perm_b32 v198, v52, v48, s65
    v_mfma_f32_16x16x32_bf16 v[172:175], v[236:239], a[188:191], v[172:175]
    v_perm_b32 v199, v60, v56, s65
    v_perm_b32 v200, v37, v33, s64
    v_perm_b32 v201, v45, v41, s64
    ds_read_b32 v107, v96 offset:2512
    v_mfma_f32_16x16x32_bf16 v[172:175], v[204:207], a[184:187], v[172:175]
    v_perm_b32 v202, v53, v49, s64
    v_perm_b32 v203, v61, v57, s64
    v_perm_b32 v232, v69, v65, s64
    v_mfma_f32_16x16x32_bf16 v[176:179], v[208:211], a[184:187], v[176:179]
    v_perm_b32 v233, v77, v73, s64
    v_perm_b32 v234, v85, v81, s64
    v_perm_b32 v235, v93, v89, s64
    s_waitcnt lgkmcnt(2)
    s_add_u32 m0, s78, 2048
    v_lshl_add_u32 v106, v106, 8, v10
    buffer_load_dwordx4 v106, s[32:35], 0 offen lds
    v_mfma_f32_16x16x32_bf16 v[176:179], v[240:243], a[188:191], v[176:179]
    v_perm_b32 v236, v69, v65, s65
    v_perm_b32 v237, v77, v73, s65
    v_perm_b32 v238, v85, v81, s65
    v_mfma_f32_16x16x32_bf16 v[180:183], v[244:247], a[188:191], v[180:183]
    v_perm_b32 v239, v93, v89, s65
    v_perm_b32 v204, v37, v33, s65
    v_perm_b32 v205, v45, v41, s65
    ds_read_b32 v108, v97 offset:16
    ds_read_b128 a[140:143], v13 offset:18432
    v_mfma_f32_16x16x32_bf16 v[180:183], v[212:215], a[184:187], v[180:183]
    v_perm_b32 v206, v53, v49, s65
    v_perm_b32 v207, v61, v57, s65
    v_perm_b32 v208, v38, v34, s64
    v_mfma_f32_16x16x32_bf16 v[184:187], v[216:219], a[184:187], v[184:187]
    v_perm_b32 v209, v46, v42, s64
    v_perm_b32 v210, v54, v50, s64
    v_perm_b32 v211, v62, v58, s64
    s_waitcnt lgkmcnt(2)
    s_add_u32 m0, s78, 3072
    v_lshl_add_u32 v107, v107, 8, v11
    buffer_load_dwordx4 v107, s[32:35], 0 offen lds
    v_mfma_f32_16x16x32_bf16 v[184:187], v[248:251], a[188:191], v[184:187]
    v_perm_b32 v240, v70, v66, s64
    v_perm_b32 v241, v78, v74, s64
    v_perm_b32 v242, v86, v82, s64
    v_mfma_f32_16x16x32_bf16 v[188:191], v[252:255], a[188:191], v[188:191]
    v_perm_b32 v243, v94, v90, s64
    v_perm_b32 v244, v70, v66, s65
    v_perm_b32 v245, v78, v74, s65
    ds_read_b32 v109, v97 offset:848
    v_mfma_f32_16x16x32_bf16 v[188:191], v[220:223], a[184:187], v[188:191]
    v_perm_b32 v246, v86, v82, s65
    v_perm_b32 v247, v94, v90, s65
    v_perm_b32 v212, v38, v34, s65
    v_mfma_f32_16x16x32_bf16 v[128:131], v[192:195], a[128:131], v[128:131]
    v_perm_b32 v213, v46, v42, s65
    v_perm_b32 v214, v54, v50, s65
    v_perm_b32 v215, v62, v58, s65
    s_waitcnt lgkmcnt(2)
    s_add_u32 m0, s78, 4096
    v_lshl_add_u32 v108, v108, 8, v10
    buffer_load_dwordx4 v108, s[32:35], 0 offen lds
    v_mfma_f32_16x16x32_bf16 v[128:131], v[224:227], a[132:135], v[128:131]
    v_perm_b32 v216, v39, v35, s64
    v_perm_b32 v217, v47, v43, s64
    v_perm_b32 v218, v55, v51, s64
    v_mfma_f32_16x16x32_bf16 v[132:135], v[228:231], a[132:135], v[132:135]
    v_perm_b32 v219, v63, v59, s64
    v_perm_b32 v248, v71, v67, s64
    v_perm_b32 v249, v79, v75, s64
    v_mfma_f32_16x16x32_bf16 v[132:135], v[196:199], a[128:131], v[132:135]
    v_perm_b32 v250, v87, v83, s64
    v_perm_b32 v251, v95, v91, s64
    v_perm_b32 v252, v71, v67, s65
    ds_read_b128 a[144:147], v12 offset:20480
    v_mfma_f32_16x16x32_bf16 v[136:139], v[200:203], a[128:131], v[136:139]
    v_perm_b32 v253, v79, v75, s65
    v_perm_b32 v254, v87, v83, s65
    v_perm_b32 v255, v95, v91, s65
    s_waitcnt lgkmcnt(1)
    s_add_u32 m0, s78, 5120
    v_lshl_add_u32 v109, v109, 8, v11
    buffer_load_dwordx4 v109, s[32:35], 0 offen lds
    v_mfma_f32_16x16x32_bf16 v[136:139], v[232:235], a[132:135], v[136:139]
    v_perm_b32 v220, v39, v35, s65
    v_perm_b32 v221, v47, v43, s65
    v_perm_b32 v222, v55, v51, s65
    v_mfma_f32_16x16x32_bf16 v[140:143], v[236:239], a[132:135], v[140:143]
    v_perm_b32 v223, v63, v59, s65
    v_mfma_f32_16x16x32_bf16 v[140:143], v[204:207], a[128:131], v[140:143]
    v_mfma_f32_16x16x32_bf16 v[144:147], v[208:211], a[128:131], v[144:147]
    v_add_u32 v7, 3407872, v6
    buffer_load_dwordx4 v[32:35], v7, s[36:39], s56 offen
    v_mfma_f32_16x16x32_bf16 v[144:147], v[240:243], a[132:135], v[144:147]
    v_mfma_f32_16x16x32_bf16 v[148:151], v[244:247], a[132:135], v[148:151]
    ds_read_b128 a[148:151], v13 offset:20480
    v_mfma_f32_16x16x32_bf16 v[148:151], v[212:215], a[128:131], v[148:151]
    v_mfma_f32_16x16x32_bf16 v[152:155], v[216:219], a[128:131], v[152:155]
    buffer_load_dwordx4 v[36:39], v7, s[36:39], s57 offen
    v_mfma_f32_16x16x32_bf16 v[152:155], v[248:251], a[132:135], v[152:155]
    v_mfma_f32_16x16x32_bf16 v[156:159], v[252:255], a[132:135], v[156:159]
    v_mfma_f32_16x16x32_bf16 v[156:159], v[220:223], a[128:131], v[156:159]
    v_mfma_f32_16x16x32_bf16 v[160:163], v[192:195], a[136:139], v[160:163]
    buffer_load_dwordx4 v[40:43], v7, s[36:39], s58 offen
    v_mfma_f32_16x16x32_bf16 v[160:163], v[224:227], a[140:143], v[160:163]
    v_mfma_f32_16x16x32_bf16 v[164:167], v[228:231], a[140:143], v[164:167]
    v_mfma_f32_16x16x32_bf16 v[164:167], v[196:199], a[136:139], v[164:167]
    s_waitcnt vmcnt(17)
    ds_read_b128 a[152:155], v12 offset:22528
    v_mfma_f32_16x16x32_bf16 v[168:171], v[200:203], a[136:139], v[168:171]
    buffer_load_dwordx4 v[44:47], v7, s[36:39], s59 offen
    v_mfma_f32_16x16x32_bf16 v[168:171], v[232:235], a[140:143], v[168:171]
    v_mfma_f32_16x16x32_bf16 v[172:175], v[236:239], a[140:143], v[172:175]
    v_mfma_f32_16x16x32_bf16 v[172:175], v[204:207], a[136:139], v[172:175]
    v_mfma_f32_16x16x32_bf16 v[176:179], v[208:211], a[136:139], v[176:179]
    buffer_load_dwordx4 v[48:51], v7, s[36:39], s60 offen
    v_mfma_f32_16x16x32_bf16 v[176:179], v[240:243], a[140:143], v[176:179]
    v_mfma_f32_16x16x32_bf16 v[180:183], v[244:247], a[140:143], v[180:183]
    ds_read_b128 a[156:159], v13 offset:22528
    v_mfma_f32_16x16x32_bf16 v[180:183], v[212:215], a[136:139], v[180:183]
    v_mfma_f32_16x16x32_bf16 v[184:187], v[216:219], a[136:139], v[184:187]
    buffer_load_dwordx4 v[52:55], v7, s[36:39], s61 offen
    v_mfma_f32_16x16x32_bf16 v[184:187], v[248:251], a[140:143], v[184:187]
    v_mfma_f32_16x16x32_bf16 v[188:191], v[252:255], a[140:143], v[188:191]
    v_mfma_f32_16x16x32_bf16 v[188:191], v[220:223], a[136:139], v[188:191]
    s_waitcnt lgkmcnt(3)
    v_mfma_f32_16x16x32_bf16 a[192:195], v[192:195], a[144:147], a[192:195]
    buffer_load_dwordx4 v[56:59], v7, s[36:39], s62 offen
    s_waitcnt lgkmcnt(2)
    v_mfma_f32_16x16x32_bf16 a[192:195], v[224:227], a[148:151], a[192:195]
    v_mfma_f32_16x16x32_bf16 a[196:199], v[228:231], a[148:151], a[196:199]
    v_mfma_f32_16x16x32_bf16 a[196:199], v[196:199], a[144:147], a[196:199]
    s_waitcnt vmcnt(19)
    ds_read_b128 a[160:163], v12 offset:24576
    v_mfma_f32_16x16x32_bf16 a[200:203], v[200:203], a[144:147], a[200:203]
    buffer_load_dwordx4 v[60:63], v7, s[36:39], s63 offen
    v_mfma_f32_16x16x32_bf16 a[200:203], v[232:235], a[148:151], a[200:203]
    v_mfma_f32_16x16x32_bf16 a[204:207], v[236:239], a[148:151], a[204:207]
    v_mfma_f32_16x16x32_bf16 a[204:207], v[204:207], a[144:147], a[204:207]
    v_mfma_f32_16x16x32_bf16 a[208:211], v[208:211], a[144:147], a[208:211]
    v_add_u32 v7, 212992, v7
    buffer_load_dwordx4 v[64:67], v7, s[36:39], s56 offen
    v_mfma_f32_16x16x32_bf16 a[208:211], v[240:243], a[148:151], a[208:211]
    v_mfma_f32_16x16x32_bf16 a[212:215], v[244:247], a[148:151], a[212:215]
    ds_read_b128 a[164:167], v13 offset:24576
    v_mfma_f32_16x16x32_bf16 a[212:215], v[212:215], a[144:147], a[212:215]
    v_mfma_f32_16x16x32_bf16 a[216:219], v[216:219], a[144:147], a[216:219]
    buffer_load_dwordx4 v[68:71], v7, s[36:39], s57 offen
    v_mfma_f32_16x16x32_bf16 a[216:219], v[248:251], a[148:151], a[216:219]
    v_mfma_f32_16x16x32_bf16 a[220:223], v[252:255], a[148:151], a[220:223]
    v_mfma_f32_16x16x32_bf16 a[220:223], v[220:223], a[144:147], a[220:223]
    s_waitcnt lgkmcnt(3)
    v_mfma_f32_16x16x32_bf16 a[224:227], v[192:195], a[152:155], a[224:227]
    buffer_load_dwordx4 v[72:75], v7, s[36:39], s58 offen
    s_waitcnt lgkmcnt(2)
    v_mfma_f32_16x16x32_bf16 a[224:227], v[224:227], a[156:159], a[224:227]
    v_mfma_f32_16x16x32_bf16 a[228:231], v[228:231], a[156:159], a[228:231]
    v_mfma_f32_16x16x32_bf16 a[228:231], v[196:199], a[152:155], a[228:231]
    s_waitcnt vmcnt(21)
    ds_read_b128 a[168:171], v12 offset:26624
    v_mfma_f32_16x16x32_bf16 a[232:235], v[200:203], a[152:155], a[232:235]
    buffer_load_dwordx4 v[76:79], v7, s[36:39], s59 offen
    v_mfma_f32_16x16x32_bf16 a[232:235], v[232:235], a[156:159], a[232:235]
    v_mfma_f32_16x16x32_bf16 a[236:239], v[236:239], a[156:159], a[236:239]
    v_mfma_f32_16x16x32_bf16 a[236:239], v[204:207], a[152:155], a[236:239]
    v_mfma_f32_16x16x32_bf16 a[240:243], v[208:211], a[152:155], a[240:243]
    buffer_load_dwordx4 v[80:83], v7, s[36:39], s60 offen
    v_mfma_f32_16x16x32_bf16 a[240:243], v[240:243], a[156:159], a[240:243]
    v_mfma_f32_16x16x32_bf16 a[244:247], v[244:247], a[156:159], a[244:247]
    ds_read_b128 a[172:175], v13 offset:26624
    v_mfma_f32_16x16x32_bf16 a[244:247], v[212:215], a[152:155], a[244:247]
    v_mfma_f32_16x16x32_bf16 a[248:251], v[216:219], a[152:155], a[248:251]
    buffer_load_dwordx4 v[84:87], v7, s[36:39], s61 offen
    v_mfma_f32_16x16x32_bf16 a[248:251], v[248:251], a[156:159], a[248:251]
    v_mfma_f32_16x16x32_bf16 a[252:255], v[252:255], a[156:159], a[252:255]
    v_mfma_f32_16x16x32_bf16 a[252:255], v[220:223], a[152:155], a[252:255]
    s_waitcnt lgkmcnt(3)
    v_mfma_f32_16x16x32_bf16 a[0:3], v[192:195], a[160:163], a[0:3]
    buffer_load_dwordx4 v[88:91], v7, s[36:39], s62 offen
    s_waitcnt lgkmcnt(2)
    v_mfma_f32_16x16x32_bf16 a[0:3], v[224:227], a[164:167], a[0:3]
    v_mfma_f32_16x16x32_bf16 a[4:7], v[228:231], a[164:167], a[4:7]
    ds_read_b32 v110, v97 offset:1680
    v_mfma_f32_16x16x32_bf16 a[4:7], v[196:199], a[160:163], a[4:7]
    s_waitcnt vmcnt(23)
    ds_read_b128 a[176:179], v12 offset:28672
    v_mfma_f32_16x16x32_bf16 a[8:11], v[200:203], a[160:163], a[8:11]
    buffer_load_dwordx4 v[92:95], v7, s[36:39], s63 offen
    v_mfma_f32_16x16x32_bf16 a[8:11], v[232:235], a[164:167], a[8:11]
    v_mfma_f32_16x16x32_bf16 a[12:15], v[236:239], a[164:167], a[12:15]
    ds_read_b32 v111, v97 offset:2512
    v_mfma_f32_16x16x32_bf16 a[12:15], v[204:207], a[160:163], a[12:15]
    v_mfma_f32_16x16x32_bf16 a[16:19], v[208:211], a[160:163], a[16:19]
    s_waitcnt lgkmcnt(2)
    s_add_u32 m0, s78, 6144
    v_lshl_add_u32 v110, v110, 8, v10
    buffer_load_dwordx4 v110, s[32:35], 0 offen lds
    v_mfma_f32_16x16x32_bf16 a[16:19], v[240:243], a[164:167], a[16:19]
    v_mfma_f32_16x16x32_bf16 a[20:23], v[244:247], a[164:167], a[20:23]
    ds_read_b32 v112, v98 offset:16
    ds_read_b128 a[180:183], v13 offset:28672
    v_mfma_f32_16x16x32_bf16 a[20:23], v[212:215], a[160:163], a[20:23]
    v_mfma_f32_16x16x32_bf16 a[24:27], v[216:219], a[160:163], a[24:27]
    s_waitcnt lgkmcnt(2)
    s_add_u32 m0, s78, 7168
    v_lshl_add_u32 v111, v111, 8, v11
    buffer_load_dwordx4 v111, s[32:35], 0 offen lds
    v_mfma_f32_16x16x32_bf16 a[24:27], v[248:251], a[164:167], a[24:27]
    v_mfma_f32_16x16x32_bf16 a[28:31], v[252:255], a[164:167], a[28:31]
    ds_read_b32 v113, v98 offset:848
    v_mfma_f32_16x16x32_bf16 a[28:31], v[220:223], a[160:163], a[28:31]
    v_mfma_f32_16x16x32_bf16 a[32:35], v[192:195], a[168:171], a[32:35]
    s_waitcnt lgkmcnt(2)
    s_add_u32 m0, s78, 8192
    v_lshl_add_u32 v112, v112, 8, v10
    buffer_load_dwordx4 v112, s[32:35], 0 offen lds
    v_mfma_f32_16x16x32_bf16 a[32:35], v[224:227], a[172:175], a[32:35]
    v_mfma_f32_16x16x32_bf16 a[36:39], v[228:231], a[172:175], a[36:39]
    ds_read_b32 v114, v98 offset:1680
    v_mfma_f32_16x16x32_bf16 a[36:39], v[196:199], a[168:171], a[36:39]
    s_waitcnt vmcnt(25)
    ds_read_b128 a[184:187], v12 offset:30720
    v_mfma_f32_16x16x32_bf16 a[40:43], v[200:203], a[168:171], a[40:43]
    s_waitcnt lgkmcnt(2)
    s_add_u32 m0, s78, 9216
    v_lshl_add_u32 v113, v113, 8, v11
    buffer_load_dwordx4 v113, s[32:35], 0 offen lds
    v_mfma_f32_16x16x32_bf16 a[40:43], v[232:235], a[172:175], a[40:43]
    v_mfma_f32_16x16x32_bf16 a[44:47], v[236:239], a[172:175], a[44:47]
    ds_read_b32 v115, v98 offset:2512
    v_mfma_f32_16x16x32_bf16 a[44:47], v[204:207], a[168:171], a[44:47]
    v_mfma_f32_16x16x32_bf16 a[48:51], v[208:211], a[168:171], a[48:51]
    s_waitcnt lgkmcnt(2)
    s_add_u32 m0, s78, 10240
    v_lshl_add_u32 v114, v114, 8, v10
    buffer_load_dwordx4 v114, s[32:35], 0 offen lds
    v_mfma_f32_16x16x32_bf16 a[48:51], v[240:243], a[172:175], a[48:51]
    v_mfma_f32_16x16x32_bf16 a[52:55], v[244:247], a[172:175], a[52:55]
    ds_read_b32 v116, v99 offset:16
    ds_read_b128 a[188:191], v13 offset:30720
    v_mfma_f32_16x16x32_bf16 a[52:55], v[212:215], a[168:171], a[52:55]
    v_mfma_f32_16x16x32_bf16 a[56:59], v[216:219], a[168:171], a[56:59]
    s_waitcnt lgkmcnt(2)
    s_add_u32 m0, s78, 11264
    v_lshl_add_u32 v115, v115, 8, v11
    buffer_load_dwordx4 v115, s[32:35], 0 offen lds
    v_mfma_f32_16x16x32_bf16 a[56:59], v[248:251], a[172:175], a[56:59]
    v_mfma_f32_16x16x32_bf16 a[60:63], v[252:255], a[172:175], a[60:63]
    ds_read_b32 v117, v99 offset:848
    v_mfma_f32_16x16x32_bf16 a[60:63], v[220:223], a[168:171], a[60:63]
    v_mfma_f32_16x16x32_bf16 a[64:67], v[192:195], a[176:179], a[64:67]
    s_waitcnt lgkmcnt(2)
    s_add_u32 m0, s78, 12288
    v_lshl_add_u32 v116, v116, 8, v10
    buffer_load_dwordx4 v116, s[32:35], 0 offen lds
    v_mfma_f32_16x16x32_bf16 a[64:67], v[224:227], a[180:183], a[64:67]
    v_mfma_f32_16x16x32_bf16 a[68:71], v[228:231], a[180:183], a[68:71]
    ds_read_b32 v118, v99 offset:1680
    v_mfma_f32_16x16x32_bf16 a[68:71], v[196:199], a[176:179], a[68:71]
    s_waitcnt vmcnt(27)
    ds_read_b128 a[128:131], v12 offset:0
    v_mfma_f32_16x16x32_bf16 a[72:75], v[200:203], a[176:179], a[72:75]
    s_waitcnt lgkmcnt(2)
    s_add_u32 m0, s78, 13312
    v_lshl_add_u32 v117, v117, 8, v11
    buffer_load_dwordx4 v117, s[32:35], 0 offen lds
    v_mfma_f32_16x16x32_bf16 a[72:75], v[232:235], a[180:183], a[72:75]
    v_mfma_f32_16x16x32_bf16 a[76:79], v[236:239], a[180:183], a[76:79]
    ds_read_b32 v119, v99 offset:2512
    v_mfma_f32_16x16x32_bf16 a[76:79], v[204:207], a[176:179], a[76:79]
    v_mfma_f32_16x16x32_bf16 a[80:83], v[208:211], a[176:179], a[80:83]
    s_waitcnt lgkmcnt(2)
    s_add_u32 m0, s78, 14336
    v_lshl_add_u32 v118, v118, 8, v10
    buffer_load_dwordx4 v118, s[32:35], 0 offen lds
    v_mfma_f32_16x16x32_bf16 a[80:83], v[240:243], a[180:183], a[80:83]
    v_mfma_f32_16x16x32_bf16 a[84:87], v[244:247], a[180:183], a[84:87]
    ds_read_b32 v104, v96 offset:24
    ds_read_b128 a[132:135], v13 offset:0
    v_mfma_f32_16x16x32_bf16 a[84:87], v[212:215], a[176:179], a[84:87]
    v_mfma_f32_16x16x32_bf16 a[88:91], v[216:219], a[176:179], a[88:91]
    s_waitcnt lgkmcnt(2)
    s_add_u32 m0, s78, 15360
    v_lshl_add_u32 v119, v119, 8, v11
    buffer_load_dwordx4 v119, s[32:35], 0 offen lds
    v_mfma_f32_16x16x32_bf16 a[88:91], v[248:251], a[180:183], a[88:91]
    v_mfma_f32_16x16x32_bf16 a[92:95], v[252:255], a[180:183], a[92:95]
    ds_read_b32 v105, v96 offset:856
    v_mfma_f32_16x16x32_bf16 a[92:95], v[220:223], a[176:179], a[92:95]
    v_mfma_f32_16x16x32_bf16 a[96:99], v[192:195], a[184:187], a[96:99]
    s_waitcnt lgkmcnt(2)
    s_add_u32 m0, s78, 16384
    v_lshl_add_u32 v104, v104, 8, v10
    buffer_load_dwordx4 v104, s[32:35], 0 offen lds
    v_mfma_f32_16x16x32_bf16 a[96:99], v[224:227], a[188:191], a[96:99]
    s_waitcnt vmcnt(19)
    v_perm_b32 v192, v36, v32, s64
    v_perm_b32 v193, v44, v40, s64
    v_perm_b32 v194, v52, v48, s64
    v_mfma_f32_16x16x32_bf16 a[100:103], v[228:231], a[188:191], a[100:103]
    v_perm_b32 v195, v60, v56, s64
    s_waitcnt vmcnt(11)
    v_perm_b32 v224, v68, v64, s64
    v_perm_b32 v225, v76, v72, s64
    ds_read_b32 v106, v96 offset:1688
    v_mfma_f32_16x16x32_bf16 a[100:103], v[196:199], a[184:187], a[100:103]
    v_perm_b32 v226, v84, v80, s64
    v_perm_b32 v227, v92, v88, s64
    v_perm_b32 v228, v68, v64, s65
    ds_read_b128 a[136:139], v12 offset:2048
    v_mfma_f32_16x16x32_bf16 a[104:107], v[200:203], a[184:187], a[104:107]
    v_perm_b32 v229, v76, v72, s65
    v_perm_b32 v230, v84, v80, s65
    v_perm_b32 v231, v92, v88, s65
    s_waitcnt lgkmcnt(2)
    s_add_u32 m0, s78, 17408
    v_lshl_add_u32 v105, v105, 8, v11
    buffer_load_dwordx4 v105, s[32:35], 0 offen lds
    v_mfma_f32_16x16x32_bf16 a[104:107], v[232:235], a[188:191], a[104:107]
    v_perm_b32 v196, v36, v32, s65
    v_perm_b32 v197, v44, v40, s65
    v_perm_b32 v198, v52, v48, s65
    v_mfma_f32_16x16x32_bf16 a[108:111], v[236:239], a[188:191], a[108:111]
    v_perm_b32 v199, v60, v56, s65
    v_perm_b32 v200, v37, v33, s64
    v_perm_b32 v201, v45, v41, s64
    ds_read_b32 v107, v96 offset:2520
    v_mfma_f32_16x16x32_bf16 a[108:111], v[204:207], a[184:187], a[108:111]
    v_perm_b32 v202, v53, v49, s64
    v_perm_b32 v203, v61, v57, s64
    v_perm_b32 v232, v69, v65, s64
    v_mfma_f32_16x16x32_bf16 a[112:115], v[208:211], a[184:187], a[112:115]
    v_perm_b32 v233, v77, v73, s64
    v_perm_b32 v234, v85, v81, s64
    v_perm_b32 v235, v93, v89, s64
    s_waitcnt lgkmcnt(2)
    s_add_u32 m0, s78, 18432
    v_lshl_add_u32 v106, v106, 8, v10
    buffer_load_dwordx4 v106, s[32:35], 0 offen lds
    v_mfma_f32_16x16x32_bf16 a[112:115], v[240:243], a[188:191], a[112:115]
    v_perm_b32 v236, v69, v65, s65
    v_perm_b32 v237, v77, v73, s65
    v_perm_b32 v238, v85, v81, s65
    v_mfma_f32_16x16x32_bf16 a[116:119], v[244:247], a[188:191], a[116:119]
    v_perm_b32 v239, v93, v89, s65
    v_perm_b32 v204, v37, v33, s65
    v_perm_b32 v205, v45, v41, s65
    ds_read_b32 v108, v97 offset:24
    ds_read_b128 a[140:143], v13 offset:2048
    v_mfma_f32_16x16x32_bf16 a[116:119], v[212:215], a[184:187], a[116:119]
    v_perm_b32 v206, v53, v49, s65
    v_perm_b32 v207, v61, v57, s65
    v_perm_b32 v208, v38, v34, s64
    v_mfma_f32_16x16x32_bf16 a[120:123], v[216:219], a[184:187], a[120:123]
    v_perm_b32 v209, v46, v42, s64
    v_perm_b32 v210, v54, v50, s64
    v_perm_b32 v211, v62, v58, s64
    s_waitcnt lgkmcnt(2)
    s_add_u32 m0, s78, 19456
    v_lshl_add_u32 v107, v107, 8, v11
    buffer_load_dwordx4 v107, s[32:35], 0 offen lds
    v_mfma_f32_16x16x32_bf16 a[120:123], v[248:251], a[188:191], a[120:123]
    v_perm_b32 v240, v70, v66, s64
    v_perm_b32 v241, v78, v74, s64
    v_perm_b32 v242, v86, v82, s64
    v_mfma_f32_16x16x32_bf16 a[124:127], v[252:255], a[188:191], a[124:127]
    v_perm_b32 v243, v94, v90, s64
    v_perm_b32 v244, v70, v66, s65
    v_perm_b32 v245, v78, v74, s65
    ds_read_b32 v109, v97 offset:856
    v_mfma_f32_16x16x32_bf16 a[124:127], v[220:223], a[184:187], a[124:127]
    v_perm_b32 v246, v86, v82, s65
    v_perm_b32 v247, v94, v90, s65
    v_perm_b32 v212, v38, v34, s65
    v_mfma_f32_16x16x32_bf16 v[128:131], v[192:195], a[128:131], v[128:131]
    v_perm_b32 v213, v46, v42, s65
    v_perm_b32 v214, v54, v50, s65
    v_perm_b32 v215, v62, v58, s65
    s_waitcnt lgkmcnt(2)
    s_add_u32 m0, s78, 20480
    v_lshl_add_u32 v108, v108, 8, v10
    buffer_load_dwordx4 v108, s[32:35], 0 offen lds
    v_mfma_f32_16x16x32_bf16 v[128:131], v[224:227], a[132:135], v[128:131]
    v_perm_b32 v216, v39, v35, s64
    v_perm_b32 v217, v47, v43, s64
    v_perm_b32 v218, v55, v51, s64
    v_mfma_f32_16x16x32_bf16 v[132:135], v[228:231], a[132:135], v[132:135]
    v_perm_b32 v219, v63, v59, s64
    v_perm_b32 v248, v71, v67, s64
    v_perm_b32 v249, v79, v75, s64
    v_mfma_f32_16x16x32_bf16 v[132:135], v[196:199], a[128:131], v[132:135]
    v_perm_b32 v250, v87, v83, s64
    v_perm_b32 v251, v95, v91, s64
    v_perm_b32 v252, v71, v67, s65
    ds_read_b128 a[144:147], v12 offset:4096
    v_mfma_f32_16x16x32_bf16 v[136:139], v[200:203], a[128:131], v[136:139]
    v_perm_b32 v253, v79, v75, s65
    v_perm_b32 v254, v87, v83, s65
    v_perm_b32 v255, v95, v91, s65
    s_waitcnt lgkmcnt(1)
    s_add_u32 m0, s78, 21504
    v_lshl_add_u32 v109, v109, 8, v11
    buffer_load_dwordx4 v109, s[32:35], 0 offen lds
    v_mfma_f32_16x16x32_bf16 v[136:139], v[232:235], a[132:135], v[136:139]
    v_perm_b32 v220, v39, v35, s65
    v_perm_b32 v221, v47, v43, s65
    v_perm_b32 v222, v55, v51, s65
    v_mfma_f32_16x16x32_bf16 v[140:143], v[236:239], a[132:135], v[140:143]
    v_perm_b32 v223, v63, v59, s65
    v_mfma_f32_16x16x32_bf16 v[140:143], v[204:207], a[128:131], v[140:143]
    v_mfma_f32_16x16x32_bf16 v[144:147], v[208:211], a[128:131], v[144:147]
    v_add_u32 v7, 1490944, v7
    buffer_load_dwordx4 v[32:35], v7, s[36:39], s56 offen
    v_mfma_f32_16x16x32_bf16 v[144:147], v[240:243], a[132:135], v[144:147]
    v_mfma_f32_16x16x32_bf16 v[148:151], v[244:247], a[132:135], v[148:151]
    ds_read_b128 a[148:151], v13 offset:4096
    v_mfma_f32_16x16x32_bf16 v[148:151], v[212:215], a[128:131], v[148:151]
    v_mfma_f32_16x16x32_bf16 v[152:155], v[216:219], a[128:131], v[152:155]
    buffer_load_dwordx4 v[36:39], v7, s[36:39], s57 offen
    v_mfma_f32_16x16x32_bf16 v[152:155], v[248:251], a[132:135], v[152:155]
    v_mfma_f32_16x16x32_bf16 v[156:159], v[252:255], a[132:135], v[156:159]
    v_mfma_f32_16x16x32_bf16 v[156:159], v[220:223], a[128:131], v[156:159]
    v_mfma_f32_16x16x32_bf16 v[160:163], v[192:195], a[136:139], v[160:163]
    buffer_load_dwordx4 v[40:43], v7, s[36:39], s58 offen
    v_mfma_f32_16x16x32_bf16 v[160:163], v[224:227], a[140:143], v[160:163]
    v_mfma_f32_16x16x32_bf16 v[164:167], v[228:231], a[140:143], v[164:167]
    v_mfma_f32_16x16x32_bf16 v[164:167], v[196:199], a[136:139], v[164:167]
    s_waitcnt vmcnt(17)
    ds_read_b128 a[152:155], v12 offset:6144
    v_mfma_f32_16x16x32_bf16 v[168:171], v[200:203], a[136:139], v[168:171]
    buffer_load_dwordx4 v[44:47], v7, s[36:39], s59 offen
    v_mfma_f32_16x16x32_bf16 v[168:171], v[232:235], a[140:143], v[168:171]
    v_mfma_f32_16x16x32_bf16 v[172:175], v[236:239], a[140:143], v[172:175]
    v_mfma_f32_16x16x32_bf16 v[172:175], v[204:207], a[136:139], v[172:175]
    v_mfma_f32_16x16x32_bf16 v[176:179], v[208:211], a[136:139], v[176:179]
    buffer_load_dwordx4 v[48:51], v7, s[36:39], s60 offen
    v_mfma_f32_16x16x32_bf16 v[176:179], v[240:243], a[140:143], v[176:179]
    v_mfma_f32_16x16x32_bf16 v[180:183], v[244:247], a[140:143], v[180:183]
    ds_read_b128 a[156:159], v13 offset:6144
    v_mfma_f32_16x16x32_bf16 v[180:183], v[212:215], a[136:139], v[180:183]
    v_mfma_f32_16x16x32_bf16 v[184:187], v[216:219], a[136:139], v[184:187]
    buffer_load_dwordx4 v[52:55], v7, s[36:39], s61 offen
    v_mfma_f32_16x16x32_bf16 v[184:187], v[248:251], a[140:143], v[184:187]
    v_mfma_f32_16x16x32_bf16 v[188:191], v[252:255], a[140:143], v[188:191]
    v_mfma_f32_16x16x32_bf16 v[188:191], v[220:223], a[136:139], v[188:191]
    s_waitcnt lgkmcnt(3)
    v_mfma_f32_16x16x32_bf16 a[192:195], v[192:195], a[144:147], a[192:195]
    buffer_load_dwordx4 v[56:59], v7, s[36:39], s62 offen
    s_waitcnt lgkmcnt(2)
    v_mfma_f32_16x16x32_bf16 a[192:195], v[224:227], a[148:151], a[192:195]
    v_mfma_f32_16x16x32_bf16 a[196:199], v[228:231], a[148:151], a[196:199]
    v_mfma_f32_16x16x32_bf16 a[196:199], v[196:199], a[144:147], a[196:199]
    s_waitcnt vmcnt(19)
    ds_read_b128 a[160:163], v12 offset:8192
    v_mfma_f32_16x16x32_bf16 a[200:203], v[200:203], a[144:147], a[200:203]
    buffer_load_dwordx4 v[60:63], v7, s[36:39], s63 offen
    v_mfma_f32_16x16x32_bf16 a[200:203], v[232:235], a[148:151], a[200:203]
    v_mfma_f32_16x16x32_bf16 a[204:207], v[236:239], a[148:151], a[204:207]
    v_mfma_f32_16x16x32_bf16 a[204:207], v[204:207], a[144:147], a[204:207]
    v_mfma_f32_16x16x32_bf16 a[208:211], v[208:211], a[144:147], a[208:211]
    v_add_u32 v7, 212992, v7
    buffer_load_dwordx4 v[64:67], v7, s[36:39], s56 offen
    v_mfma_f32_16x16x32_bf16 a[208:211], v[240:243], a[148:151], a[208:211]
    v_mfma_f32_16x16x32_bf16 a[212:215], v[244:247], a[148:151], a[212:215]
    ds_read_b128 a[164:167], v13 offset:8192
    v_mfma_f32_16x16x32_bf16 a[212:215], v[212:215], a[144:147], a[212:215]
    v_mfma_f32_16x16x32_bf16 a[216:219], v[216:219], a[144:147], a[216:219]
    buffer_load_dwordx4 v[68:71], v7, s[36:39], s57 offen
    v_mfma_f32_16x16x32_bf16 a[216:219], v[248:251], a[148:151], a[216:219]
    v_mfma_f32_16x16x32_bf16 a[220:223], v[252:255], a[148:151], a[220:223]
    v_mfma_f32_16x16x32_bf16 a[220:223], v[220:223], a[144:147], a[220:223]
    s_waitcnt lgkmcnt(3)
    v_mfma_f32_16x16x32_bf16 a[224:227], v[192:195], a[152:155], a[224:227]
    buffer_load_dwordx4 v[72:75], v7, s[36:39], s58 offen
    s_waitcnt lgkmcnt(2)
    v_mfma_f32_16x16x32_bf16 a[224:227], v[224:227], a[156:159], a[224:227]
    v_mfma_f32_16x16x32_bf16 a[228:231], v[228:231], a[156:159], a[228:231]
    v_mfma_f32_16x16x32_bf16 a[228:231], v[196:199], a[152:155], a[228:231]
    s_waitcnt vmcnt(21)
    ds_read_b128 a[168:171], v12 offset:10240
    v_mfma_f32_16x16x32_bf16 a[232:235], v[200:203], a[152:155], a[232:235]
    buffer_load_dwordx4 v[76:79], v7, s[36:39], s59 offen
    v_mfma_f32_16x16x32_bf16 a[232:235], v[232:235], a[156:159], a[232:235]
    v_mfma_f32_16x16x32_bf16 a[236:239], v[236:239], a[156:159], a[236:239]
    v_mfma_f32_16x16x32_bf16 a[236:239], v[204:207], a[152:155], a[236:239]
    v_mfma_f32_16x16x32_bf16 a[240:243], v[208:211], a[152:155], a[240:243]
    buffer_load_dwordx4 v[80:83], v7, s[36:39], s60 offen
    v_mfma_f32_16x16x32_bf16 a[240:243], v[240:243], a[156:159], a[240:243]
    v_mfma_f32_16x16x32_bf16 a[244:247], v[244:247], a[156:159], a[244:247]
    ds_read_b128 a[172:175], v13 offset:10240
    v_mfma_f32_16x16x32_bf16 a[244:247], v[212:215], a[152:155], a[244:247]
    v_mfma_f32_16x16x32_bf16 a[248:251], v[216:219], a[152:155], a[248:251]
    buffer_load_dwordx4 v[84:87], v7, s[36:39], s61 offen
    v_mfma_f32_16x16x32_bf16 a[248:251], v[248:251], a[156:159], a[248:251]
    v_mfma_f32_16x16x32_bf16 a[252:255], v[252:255], a[156:159], a[252:255]
    v_mfma_f32_16x16x32_bf16 a[252:255], v[220:223], a[152:155], a[252:255]
    s_waitcnt lgkmcnt(3)
    v_mfma_f32_16x16x32_bf16 a[0:3], v[192:195], a[160:163], a[0:3]
    buffer_load_dwordx4 v[88:91], v7, s[36:39], s62 offen
    s_waitcnt lgkmcnt(2)
    v_mfma_f32_16x16x32_bf16 a[0:3], v[224:227], a[164:167], a[0:3]
    v_mfma_f32_16x16x32_bf16 a[4:7], v[228:231], a[164:167], a[4:7]
    ds_read_b32 v110, v97 offset:1688
    v_mfma_f32_16x16x32_bf16 a[4:7], v[196:199], a[160:163], a[4:7]
    s_waitcnt vmcnt(23)
    ds_read_b128 a[176:179], v12 offset:12288
    v_mfma_f32_16x16x32_bf16 a[8:11], v[200:203], a[160:163], a[8:11]
    buffer_load_dwordx4 v[92:95], v7, s[36:39], s63 offen
    v_mfma_f32_16x16x32_bf16 a[8:11], v[232:235], a[164:167], a[8:11]
    v_mfma_f32_16x16x32_bf16 a[12:15], v[236:239], a[164:167], a[12:15]
    ds_read_b32 v111, v97 offset:2520
    v_mfma_f32_16x16x32_bf16 a[12:15], v[204:207], a[160:163], a[12:15]
    v_mfma_f32_16x16x32_bf16 a[16:19], v[208:211], a[160:163], a[16:19]
    s_waitcnt lgkmcnt(2)
    s_add_u32 m0, s78, 22528
    v_lshl_add_u32 v110, v110, 8, v10
    buffer_load_dwordx4 v110, s[32:35], 0 offen lds
    v_mfma_f32_16x16x32_bf16 a[16:19], v[240:243], a[164:167], a[16:19]
    v_mfma_f32_16x16x32_bf16 a[20:23], v[244:247], a[164:167], a[20:23]
    ds_read_b32 v112, v98 offset:24
    ds_read_b128 a[180:183], v13 offset:12288
    v_mfma_f32_16x16x32_bf16 a[20:23], v[212:215], a[160:163], a[20:23]
    v_mfma_f32_16x16x32_bf16 a[24:27], v[216:219], a[160:163], a[24:27]
    s_waitcnt lgkmcnt(2)
    s_add_u32 m0, s78, 23552
    v_lshl_add_u32 v111, v111, 8, v11
    buffer_load_dwordx4 v111, s[32:35], 0 offen lds
    v_mfma_f32_16x16x32_bf16 a[24:27], v[248:251], a[164:167], a[24:27]
    v_mfma_f32_16x16x32_bf16 a[28:31], v[252:255], a[164:167], a[28:31]
    ds_read_b32 v113, v98 offset:856
    v_mfma_f32_16x16x32_bf16 a[28:31], v[220:223], a[160:163], a[28:31]
    v_mfma_f32_16x16x32_bf16 a[32:35], v[192:195], a[168:171], a[32:35]
    s_waitcnt lgkmcnt(2)
    s_add_u32 m0, s78, 24576
    v_lshl_add_u32 v112, v112, 8, v10
    buffer_load_dwordx4 v112, s[32:35], 0 offen lds
    v_mfma_f32_16x16x32_bf16 a[32:35], v[224:227], a[172:175], a[32:35]
    v_mfma_f32_16x16x32_bf16 a[36:39], v[228:231], a[172:175], a[36:39]
    ds_read_b32 v114, v98 offset:1688
    v_mfma_f32_16x16x32_bf16 a[36:39], v[196:199], a[168:171], a[36:39]
    s_waitcnt vmcnt(25)
    ds_read_b128 a[184:187], v12 offset:14336
    v_mfma_f32_16x16x32_bf16 a[40:43], v[200:203], a[168:171], a[40:43]
    s_waitcnt lgkmcnt(2)
    s_add_u32 m0, s78, 25600
    v_lshl_add_u32 v113, v113, 8, v11
    buffer_load_dwordx4 v113, s[32:35], 0 offen lds
    v_mfma_f32_16x16x32_bf16 a[40:43], v[232:235], a[172:175], a[40:43]
    v_mfma_f32_16x16x32_bf16 a[44:47], v[236:239], a[172:175], a[44:47]
    ds_read_b32 v115, v98 offset:2520
    v_mfma_f32_16x16x32_bf16 a[44:47], v[204:207], a[168:171], a[44:47]
    v_mfma_f32_16x16x32_bf16 a[48:51], v[208:211], a[168:171], a[48:51]
    s_waitcnt lgkmcnt(2)
    s_add_u32 m0, s78, 26624
    v_lshl_add_u32 v114, v114, 8, v10
    buffer_load_dwordx4 v114, s[32:35], 0 offen lds
    v_mfma_f32_16x16x32_bf16 a[48:51], v[240:243], a[172:175], a[48:51]
    v_mfma_f32_16x16x32_bf16 a[52:55], v[244:247], a[172:175], a[52:55]
    ds_read_b32 v116, v99 offset:24
    ds_read_b128 a[188:191], v13 offset:14336
    v_mfma_f32_16x16x32_bf16 a[52:55], v[212:215], a[168:171], a[52:55]
    v_mfma_f32_16x16x32_bf16 a[56:59], v[216:219], a[168:171], a[56:59]
    s_waitcnt lgkmcnt(2)
    s_add_u32 m0, s78, 27648
    v_lshl_add_u32 v115, v115, 8, v11
    buffer_load_dwordx4 v115, s[32:35], 0 offen lds
    v_mfma_f32_16x16x32_bf16 a[56:59], v[248:251], a[172:175], a[56:59]
    v_mfma_f32_16x16x32_bf16 a[60:63], v[252:255], a[172:175], a[60:63]
    ds_read_b32 v117, v99 offset:856
    v_mfma_f32_16x16x32_bf16 a[60:63], v[220:223], a[168:171], a[60:63]
    v_mfma_f32_16x16x32_bf16 a[64:67], v[192:195], a[176:179], a[64:67]
    s_waitcnt lgkmcnt(2)
    s_add_u32 m0, s78, 28672
    v_lshl_add_u32 v116, v116, 8, v10
    buffer_load_dwordx4 v116, s[32:35], 0 offen lds
    v_mfma_f32_16x16x32_bf16 a[64:67], v[224:227], a[180:183], a[64:67]
    v_mfma_f32_16x16x32_bf16 a[68:71], v[228:231], a[180:183], a[68:71]
    ds_read_b32 v118, v99 offset:1688
    v_mfma_f32_16x16x32_bf16 a[68:71], v[196:199], a[176:179], a[68:71]
    s_waitcnt vmcnt(27)
    ds_read_b128 a[128:131], v12 offset:16384
    v_mfma_f32_16x16x32_bf16 a[72:75], v[200:203], a[176:179], a[72:75]
    s_waitcnt lgkmcnt(2)
    s_add_u32 m0, s78, 29696
    v_lshl_add_u32 v117, v117, 8, v11
    buffer_load_dwordx4 v117, s[32:35], 0 offen lds
    v_mfma_f32_16x16x32_bf16 a[72:75], v[232:235], a[180:183], a[72:75]
    v_mfma_f32_16x16x32_bf16 a[76:79], v[236:239], a[180:183], a[76:79]
    ds_read_b32 v119, v99 offset:2520
    v_mfma_f32_16x16x32_bf16 a[76:79], v[204:207], a[176:179], a[76:79]
    v_mfma_f32_16x16x32_bf16 a[80:83], v[208:211], a[176:179], a[80:83]
    s_waitcnt lgkmcnt(2)
    s_add_u32 m0, s78, 30720
    v_lshl_add_u32 v118, v118, 8, v10
    buffer_load_dwordx4 v118, s[32:35], 0 offen lds
    v_mfma_f32_16x16x32_bf16 a[80:83], v[240:243], a[180:183], a[80:83]
    v_mfma_f32_16x16x32_bf16 a[84:87], v[244:247], a[180:183], a[84:87]
    ds_read_b32 v104, v96 offset:32
    ds_read_b128 a[132:135], v13 offset:16384
    v_mfma_f32_16x16x32_bf16 a[84:87], v[212:215], a[176:179], a[84:87]
    v_mfma_f32_16x16x32_bf16 a[88:91], v[216:219], a[176:179], a[88:91]
    s_waitcnt lgkmcnt(2)
    s_add_u32 m0, s78, 31744
    v_lshl_add_u32 v119, v119, 8, v11
    buffer_load_dwordx4 v119, s[32:35], 0 offen lds
    v_mfma_f32_16x16x32_bf16 a[88:91], v[248:251], a[180:183], a[88:91]
    v_mfma_f32_16x16x32_bf16 a[92:95], v[252:255], a[180:183], a[92:95]
    ds_read_b32 v105, v96 offset:864
    v_mfma_f32_16x16x32_bf16 a[92:95], v[220:223], a[176:179], a[92:95]
    v_mfma_f32_16x16x32_bf16 a[96:99], v[192:195], a[184:187], a[96:99]
    s_waitcnt lgkmcnt(2)
    s_add_u32 m0, s78, 0
    v_lshl_add_u32 v104, v104, 8, v10
    buffer_load_dwordx4 v104, s[32:35], 0 offen lds
    v_mfma_f32_16x16x32_bf16 a[96:99], v[224:227], a[188:191], a[96:99]
    s_waitcnt vmcnt(19)
    v_perm_b32 v192, v36, v32, s64
    v_perm_b32 v193, v44, v40, s64
    v_perm_b32 v194, v52, v48, s64
    v_mfma_f32_16x16x32_bf16 a[100:103], v[228:231], a[188:191], a[100:103]
    v_perm_b32 v195, v60, v56, s64
    s_waitcnt vmcnt(11)
    v_perm_b32 v224, v68, v64, s64
    v_perm_b32 v225, v76, v72, s64
    ds_read_b32 v106, v96 offset:1696
    v_mfma_f32_16x16x32_bf16 a[100:103], v[196:199], a[184:187], a[100:103]
    v_perm_b32 v226, v84, v80, s64
    v_perm_b32 v227, v92, v88, s64
    v_perm_b32 v228, v68, v64, s65
    ds_read_b128 a[136:139], v12 offset:18432
    v_mfma_f32_16x16x32_bf16 a[104:107], v[200:203], a[184:187], a[104:107]
    v_perm_b32 v229, v76, v72, s65
    v_perm_b32 v230, v84, v80, s65
    v_perm_b32 v231, v92, v88, s65
    s_waitcnt lgkmcnt(2)
    s_add_u32 m0, s78, 1024
    v_lshl_add_u32 v105, v105, 8, v11
    buffer_load_dwordx4 v105, s[32:35], 0 offen lds
    v_mfma_f32_16x16x32_bf16 a[104:107], v[232:235], a[188:191], a[104:107]
    v_perm_b32 v196, v36, v32, s65
    v_perm_b32 v197, v44, v40, s65
    v_perm_b32 v198, v52, v48, s65
    v_mfma_f32_16x16x32_bf16 a[108:111], v[236:239], a[188:191], a[108:111]
    v_perm_b32 v199, v60, v56, s65
    v_perm_b32 v200, v37, v33, s64
    v_perm_b32 v201, v45, v41, s64
    ds_read_b32 v107, v96 offset:2528
    v_mfma_f32_16x16x32_bf16 a[108:111], v[204:207], a[184:187], a[108:111]
    v_perm_b32 v202, v53, v49, s64
    v_perm_b32 v203, v61, v57, s64
    v_perm_b32 v232, v69, v65, s64
    v_mfma_f32_16x16x32_bf16 a[112:115], v[208:211], a[184:187], a[112:115]
    v_perm_b32 v233, v77, v73, s64
    v_perm_b32 v234, v85, v81, s64
    v_perm_b32 v235, v93, v89, s64
    s_waitcnt lgkmcnt(2)
    s_add_u32 m0, s78, 2048
    v_lshl_add_u32 v106, v106, 8, v10
    buffer_load_dwordx4 v106, s[32:35], 0 offen lds
    v_mfma_f32_16x16x32_bf16 a[112:115], v[240:243], a[188:191], a[112:115]
    v_perm_b32 v236, v69, v65, s65
    v_perm_b32 v237, v77, v73, s65
    v_perm_b32 v238, v85, v81, s65
    v_mfma_f32_16x16x32_bf16 a[116:119], v[244:247], a[188:191], a[116:119]
    v_perm_b32 v239, v93, v89, s65
    v_perm_b32 v204, v37, v33, s65
    v_perm_b32 v205, v45, v41, s65
    ds_read_b32 v108, v97 offset:32
    ds_read_b128 a[140:143], v13 offset:18432
    v_mfma_f32_16x16x32_bf16 a[116:119], v[212:215], a[184:187], a[116:119]
    v_perm_b32 v206, v53, v49, s65
    v_perm_b32 v207, v61, v57, s65
    v_perm_b32 v208, v38, v34, s64
    v_mfma_f32_16x16x32_bf16 a[120:123], v[216:219], a[184:187], a[120:123]
    v_perm_b32 v209, v46, v42, s64
    v_perm_b32 v210, v54, v50, s64
    v_perm_b32 v211, v62, v58, s64
    s_waitcnt lgkmcnt(2)
    s_add_u32 m0, s78, 3072
    v_lshl_add_u32 v107, v107, 8, v11
    buffer_load_dwordx4 v107, s[32:35], 0 offen lds
    v_mfma_f32_16x16x32_bf16 a[120:123], v[248:251], a[188:191], a[120:123]
    v_perm_b32 v240, v70, v66, s64
    v_perm_b32 v241, v78, v74, s64
    v_perm_b32 v242, v86, v82, s64
    v_mfma_f32_16x16x32_bf16 a[124:127], v[252:255], a[188:191], a[124:127]
    v_perm_b32 v243, v94, v90, s64
    v_perm_b32 v244, v70, v66, s65
    v_perm_b32 v245, v78, v74, s65
    ds_read_b32 v109, v97 offset:864
    v_mfma_f32_16x16x32_bf16 a[124:127], v[220:223], a[184:187], a[124:127]
    v_perm_b32 v246, v86, v82, s65
    v_perm_b32 v247, v94, v90, s65
    v_perm_b32 v212, v38, v34, s65
    v_mfma_f32_16x16x32_bf16 v[128:131], v[192:195], a[128:131], v[128:131]
    v_perm_b32 v213, v46, v42, s65
    v_perm_b32 v214, v54, v50, s65
    v_perm_b32 v215, v62, v58, s65
    s_waitcnt lgkmcnt(2)
    s_add_u32 m0, s78, 4096
    v_lshl_add_u32 v108, v108, 8, v10
    buffer_load_dwordx4 v108, s[32:35], 0 offen lds
    v_mfma_f32_16x16x32_bf16 v[128:131], v[224:227], a[132:135], v[128:131]
    v_perm_b32 v216, v39, v35, s64
    v_perm_b32 v217, v47, v43, s64
    v_perm_b32 v218, v55, v51, s64
    v_mfma_f32_16x16x32_bf16 v[132:135], v[228:231], a[132:135], v[132:135]
    v_perm_b32 v219, v63, v59, s64
    v_perm_b32 v248, v71, v67, s64
    v_perm_b32 v249, v79, v75, s64
    v_mfma_f32_16x16x32_bf16 v[132:135], v[196:199], a[128:131], v[132:135]
    v_perm_b32 v250, v87, v83, s64
    v_perm_b32 v251, v95, v91, s64
    v_perm_b32 v252, v71, v67, s65
    ds_read_b128 a[144:147], v12 offset:20480
    v_mfma_f32_16x16x32_bf16 v[136:139], v[200:203], a[128:131], v[136:139]
    v_perm_b32 v253, v79, v75, s65
    v_perm_b32 v254, v87, v83, s65
    v_perm_b32 v255, v95, v91, s65
    s_waitcnt lgkmcnt(1)
    s_add_u32 m0, s78, 5120
    v_lshl_add_u32 v109, v109, 8, v11
    buffer_load_dwordx4 v109, s[32:35], 0 offen lds
    v_mfma_f32_16x16x32_bf16 v[136:139], v[232:235], a[132:135], v[136:139]
    v_perm_b32 v220, v39, v35, s65
    v_perm_b32 v221, v47, v43, s65
    v_perm_b32 v222, v55, v51, s65
    v_mfma_f32_16x16x32_bf16 v[140:143], v[236:239], a[132:135], v[140:143]
    v_perm_b32 v223, v63, v59, s65
    v_mfma_f32_16x16x32_bf16 v[140:143], v[204:207], a[128:131], v[140:143]
    v_mfma_f32_16x16x32_bf16 v[144:147], v[208:211], a[128:131], v[144:147]
    v_add_u32 v7, 1490944, v7
    buffer_load_dwordx4 v[32:35], v7, s[36:39], s56 offen
    v_mfma_f32_16x16x32_bf16 v[144:147], v[240:243], a[132:135], v[144:147]
    v_mfma_f32_16x16x32_bf16 v[148:151], v[244:247], a[132:135], v[148:151]
    ds_read_b128 a[148:151], v13 offset:20480
    v_mfma_f32_16x16x32_bf16 v[148:151], v[212:215], a[128:131], v[148:151]
    v_mfma_f32_16x16x32_bf16 v[152:155], v[216:219], a[128:131], v[152:155]
    buffer_load_dwordx4 v[36:39], v7, s[36:39], s57 offen
    v_mfma_f32_16x16x32_bf16 v[152:155], v[248:251], a[132:135], v[152:155]
    v_mfma_f32_16x16x32_bf16 v[156:159], v[252:255], a[132:135], v[156:159]
    v_mfma_f32_16x16x32_bf16 v[156:159], v[220:223], a[128:131], v[156:159]
    v_mfma_f32_16x16x32_bf16 v[160:163], v[192:195], a[136:139], v[160:163]
    buffer_load_dwordx4 v[40:43], v7, s[36:39], s58 offen
    v_mfma_f32_16x16x32_bf16 v[160:163], v[224:227], a[140:143], v[160:163]
    v_mfma_f32_16x16x32_bf16 v[164:167], v[228:231], a[140:143], v[164:167]
    v_mfma_f32_16x16x32_bf16 v[164:167], v[196:199], a[136:139], v[164:167]
    s_waitcnt vmcnt(17)
    ds_read_b128 a[152:155], v12 offset:22528
    v_mfma_f32_16x16x32_bf16 v[168:171], v[200:203], a[136:139], v[168:171]
    buffer_load_dwordx4 v[44:47], v7, s[36:39], s59 offen
    v_mfma_f32_16x16x32_bf16 v[168:171], v[232:235], a[140:143], v[168:171]
    v_mfma_f32_16x16x32_bf16 v[172:175], v[236:239], a[140:143], v[172:175]
    v_mfma_f32_16x16x32_bf16 v[172:175], v[204:207], a[136:139], v[172:175]
    v_mfma_f32_16x16x32_bf16 v[176:179], v[208:211], a[136:139], v[176:179]
    buffer_load_dwordx4 v[48:51], v7, s[36:39], s60 offen
    v_mfma_f32_16x16x32_bf16 v[176:179], v[240:243], a[140:143], v[176:179]
    v_mfma_f32_16x16x32_bf16 v[180:183], v[244:247], a[140:143], v[180:183]
    ds_read_b128 a[156:159], v13 offset:22528
    v_mfma_f32_16x16x32_bf16 v[180:183], v[212:215], a[136:139], v[180:183]
    v_mfma_f32_16x16x32_bf16 v[184:187], v[216:219], a[136:139], v[184:187]
    buffer_load_dwordx4 v[52:55], v7, s[36:39], s61 offen
    v_mfma_f32_16x16x32_bf16 v[184:187], v[248:251], a[140:143], v[184:187]
    v_mfma_f32_16x16x32_bf16 v[188:191], v[252:255], a[140:143], v[188:191]
    v_mfma_f32_16x16x32_bf16 v[188:191], v[220:223], a[136:139], v[188:191]
    s_waitcnt lgkmcnt(3)
    v_mfma_f32_16x16x32_bf16 a[192:195], v[192:195], a[144:147], a[192:195]
    buffer_load_dwordx4 v[56:59], v7, s[36:39], s62 offen
    s_waitcnt lgkmcnt(2)
    v_mfma_f32_16x16x32_bf16 a[192:195], v[224:227], a[148:151], a[192:195]
    v_mfma_f32_16x16x32_bf16 a[196:199], v[228:231], a[148:151], a[196:199]
    v_mfma_f32_16x16x32_bf16 a[196:199], v[196:199], a[144:147], a[196:199]
    s_waitcnt vmcnt(19)
    ds_read_b128 a[160:163], v12 offset:24576
    v_mfma_f32_16x16x32_bf16 a[200:203], v[200:203], a[144:147], a[200:203]
    buffer_load_dwordx4 v[60:63], v7, s[36:39], s63 offen
    v_mfma_f32_16x16x32_bf16 a[200:203], v[232:235], a[148:151], a[200:203]
    v_mfma_f32_16x16x32_bf16 a[204:207], v[236:239], a[148:151], a[204:207]
    v_mfma_f32_16x16x32_bf16 a[204:207], v[204:207], a[144:147], a[204:207]
    v_mfma_f32_16x16x32_bf16 a[208:211], v[208:211], a[144:147], a[208:211]
    v_add_u32 v7, 212992, v7
    buffer_load_dwordx4 v[64:67], v7, s[36:39], s56 offen
    v_mfma_f32_16x16x32_bf16 a[208:211], v[240:243], a[148:151], a[208:211]
    v_mfma_f32_16x16x32_bf16 a[212:215], v[244:247], a[148:151], a[212:215]
    ds_read_b128 a[164:167], v13 offset:24576
    v_mfma_f32_16x16x32_bf16 a[212:215], v[212:215], a[144:147], a[212:215]
    v_mfma_f32_16x16x32_bf16 a[216:219], v[216:219], a[144:147], a[216:219]
    buffer_load_dwordx4 v[68:71], v7, s[36:39], s57 offen
    v_mfma_f32_16x16x32_bf16 a[216:219], v[248:251], a[148:151], a[216:219]
    v_mfma_f32_16x16x32_bf16 a[220:223], v[252:255], a[148:151], a[220:223]
    v_mfma_f32_16x16x32_bf16 a[220:223], v[220:223], a[144:147], a[220:223]
    s_waitcnt lgkmcnt(3)
    v_mfma_f32_16x16x32_bf16 a[224:227], v[192:195], a[152:155], a[224:227]
    buffer_load_dwordx4 v[72:75], v7, s[36:39], s58 offen
    s_waitcnt lgkmcnt(2)
    v_mfma_f32_16x16x32_bf16 a[224:227], v[224:227], a[156:159], a[224:227]
    v_mfma_f32_16x16x32_bf16 a[228:231], v[228:231], a[156:159], a[228:231]
    v_mfma_f32_16x16x32_bf16 a[228:231], v[196:199], a[152:155], a[228:231]
    s_waitcnt vmcnt(21)
    ds_read_b128 a[168:171], v12 offset:26624
    v_mfma_f32_16x16x32_bf16 a[232:235], v[200:203], a[152:155], a[232:235]
    buffer_load_dwordx4 v[76:79], v7, s[36:39], s59 offen
    v_mfma_f32_16x16x32_bf16 a[232:235], v[232:235], a[156:159], a[232:235]
    v_mfma_f32_16x16x32_bf16 a[236:239], v[236:239], a[156:159], a[236:239]
    v_mfma_f32_16x16x32_bf16 a[236:239], v[204:207], a[152:155], a[236:239]
    v_mfma_f32_16x16x32_bf16 a[240:243], v[208:211], a[152:155], a[240:243]
    buffer_load_dwordx4 v[80:83], v7, s[36:39], s60 offen
    v_mfma_f32_16x16x32_bf16 a[240:243], v[240:243], a[156:159], a[240:243]
    v_mfma_f32_16x16x32_bf16 a[244:247], v[244:247], a[156:159], a[244:247]
    ds_read_b128 a[172:175], v13 offset:26624
    v_mfma_f32_16x16x32_bf16 a[244:247], v[212:215], a[152:155], a[244:247]
    v_mfma_f32_16x16x32_bf16 a[248:251], v[216:219], a[152:155], a[248:251]
    buffer_load_dwordx4 v[84:87], v7, s[36:39], s61 offen
    v_mfma_f32_16x16x32_bf16 a[248:251], v[248:251], a[156:159], a[248:251]
    v_mfma_f32_16x16x32_bf16 a[252:255], v[252:255], a[156:159], a[252:255]
    v_mfma_f32_16x16x32_bf16 a[252:255], v[220:223], a[152:155], a[252:255]
    s_waitcnt lgkmcnt(3)
    v_mfma_f32_16x16x32_bf16 a[0:3], v[192:195], a[160:163], a[0:3]
    buffer_load_dwordx4 v[88:91], v7, s[36:39], s62 offen
    s_waitcnt lgkmcnt(2)
    v_mfma_f32_16x16x32_bf16 a[0:3], v[224:227], a[164:167], a[0:3]
    v_mfma_f32_16x16x32_bf16 a[4:7], v[228:231], a[164:167], a[4:7]
    ds_read_b32 v110, v97 offset:1696
    v_mfma_f32_16x16x32_bf16 a[4:7], v[196:199], a[160:163], a[4:7]
    s_waitcnt vmcnt(23)
    ds_read_b128 a[176:179], v12 offset:28672
    v_mfma_f32_16x16x32_bf16 a[8:11], v[200:203], a[160:163], a[8:11]
    buffer_load_dwordx4 v[92:95], v7, s[36:39], s63 offen
    v_mfma_f32_16x16x32_bf16 a[8:11], v[232:235], a[164:167], a[8:11]
    v_mfma_f32_16x16x32_bf16 a[12:15], v[236:239], a[164:167], a[12:15]
    ds_read_b32 v111, v97 offset:2528
    v_mfma_f32_16x16x32_bf16 a[12:15], v[204:207], a[160:163], a[12:15]
    v_mfma_f32_16x16x32_bf16 a[16:19], v[208:211], a[160:163], a[16:19]
    s_waitcnt lgkmcnt(2)
    s_add_u32 m0, s78, 6144
    v_lshl_add_u32 v110, v110, 8, v10
    buffer_load_dwordx4 v110, s[32:35], 0 offen lds
    v_mfma_f32_16x16x32_bf16 a[16:19], v[240:243], a[164:167], a[16:19]
    v_mfma_f32_16x16x32_bf16 a[20:23], v[244:247], a[164:167], a[20:23]
    ds_read_b32 v112, v98 offset:32
    ds_read_b128 a[180:183], v13 offset:28672
    v_mfma_f32_16x16x32_bf16 a[20:23], v[212:215], a[160:163], a[20:23]
    v_mfma_f32_16x16x32_bf16 a[24:27], v[216:219], a[160:163], a[24:27]
    s_waitcnt lgkmcnt(2)
    s_add_u32 m0, s78, 7168
    v_lshl_add_u32 v111, v111, 8, v11
    buffer_load_dwordx4 v111, s[32:35], 0 offen lds
    v_mfma_f32_16x16x32_bf16 a[24:27], v[248:251], a[164:167], a[24:27]
    v_mfma_f32_16x16x32_bf16 a[28:31], v[252:255], a[164:167], a[28:31]
    ds_read_b32 v113, v98 offset:864
    v_mfma_f32_16x16x32_bf16 a[28:31], v[220:223], a[160:163], a[28:31]
    v_mfma_f32_16x16x32_bf16 a[32:35], v[192:195], a[168:171], a[32:35]
    s_waitcnt lgkmcnt(2)
    s_add_u32 m0, s78, 8192
    v_lshl_add_u32 v112, v112, 8, v10
    buffer_load_dwordx4 v112, s[32:35], 0 offen lds
    v_mfma_f32_16x16x32_bf16 a[32:35], v[224:227], a[172:175], a[32:35]
    v_mfma_f32_16x16x32_bf16 a[36:39], v[228:231], a[172:175], a[36:39]
    ds_read_b32 v114, v98 offset:1696
    v_mfma_f32_16x16x32_bf16 a[36:39], v[196:199], a[168:171], a[36:39]
    s_waitcnt vmcnt(25)
    ds_read_b128 a[184:187], v12 offset:30720
    v_mfma_f32_16x16x32_bf16 a[40:43], v[200:203], a[168:171], a[40:43]
    s_waitcnt lgkmcnt(2)
    s_add_u32 m0, s78, 9216
    v_lshl_add_u32 v113, v113, 8, v11
    buffer_load_dwordx4 v113, s[32:35], 0 offen lds
    v_mfma_f32_16x16x32_bf16 a[40:43], v[232:235], a[172:175], a[40:43]
    v_mfma_f32_16x16x32_bf16 a[44:47], v[236:239], a[172:175], a[44:47]
    ds_read_b32 v115, v98 offset:2528
    v_mfma_f32_16x16x32_bf16 a[44:47], v[204:207], a[168:171], a[44:47]
    v_mfma_f32_16x16x32_bf16 a[48:51], v[208:211], a[168:171], a[48:51]
    s_waitcnt lgkmcnt(2)
    s_add_u32 m0, s78, 10240
    v_lshl_add_u32 v114, v114, 8, v10
    buffer_load_dwordx4 v114, s[32:35], 0 offen lds
    v_mfma_f32_16x16x32_bf16 a[48:51], v[240:243], a[172:175], a[48:51]
    v_mfma_f32_16x16x32_bf16 a[52:55], v[244:247], a[172:175], a[52:55]
    ds_read_b32 v116, v99 offset:32
    ds_read_b128 a[188:191], v13 offset:30720
    v_mfma_f32_16x16x32_bf16 a[52:55], v[212:215], a[168:171], a[52:55]
    v_mfma_f32_16x16x32_bf16 a[56:59], v[216:219], a[168:171], a[56:59]
    s_waitcnt lgkmcnt(2)
    s_add_u32 m0, s78, 11264
    v_lshl_add_u32 v115, v115, 8, v11
    buffer_load_dwordx4 v115, s[32:35], 0 offen lds
    v_mfma_f32_16x16x32_bf16 a[56:59], v[248:251], a[172:175], a[56:59]
    v_mfma_f32_16x16x32_bf16 a[60:63], v[252:255], a[172:175], a[60:63]
    ds_read_b32 v117, v99 offset:864
    v_mfma_f32_16x16x32_bf16 a[60:63], v[220:223], a[168:171], a[60:63]
    v_mfma_f32_16x16x32_bf16 a[64:67], v[192:195], a[176:179], a[64:67]
    s_waitcnt lgkmcnt(2)
    s_add_u32 m0, s78, 12288
    v_lshl_add_u32 v116, v116, 8, v10
    buffer_load_dwordx4 v116, s[32:35], 0 offen lds
    v_mfma_f32_16x16x32_bf16 a[64:67], v[224:227], a[180:183], a[64:67]
    v_mfma_f32_16x16x32_bf16 a[68:71], v[228:231], a[180:183], a[68:71]
    ds_read_b32 v118, v99 offset:1696
    v_mfma_f32_16x16x32_bf16 a[68:71], v[196:199], a[176:179], a[68:71]
    s_waitcnt vmcnt(27)
    ds_read_b128 a[128:131], v12 offset:0
    v_mfma_f32_16x16x32_bf16 a[72:75], v[200:203], a[176:179], a[72:75]
    s_waitcnt lgkmcnt(2)
    s_add_u32 m0, s78, 13312
    v_lshl_add_u32 v117, v117, 8, v11
    buffer_load_dwordx4 v117, s[32:35], 0 offen lds
    v_mfma_f32_16x16x32_bf16 a[72:75], v[232:235], a[180:183], a[72:75]
    v_mfma_f32_16x16x32_bf16 a[76:79], v[236:239], a[180:183], a[76:79]
    ds_read_b32 v119, v99 offset:2528
    v_mfma_f32_16x16x32_bf16 a[76:79], v[204:207], a[176:179], a[76:79]
    v_mfma_f32_16x16x32_bf16 a[80:83], v[208:211], a[176:179], a[80:83]
    s_waitcnt lgkmcnt(2)
    s_add_u32 m0, s78, 14336
    v_lshl_add_u32 v118, v118, 8, v10
    buffer_load_dwordx4 v118, s[32:35], 0 offen lds
    v_mfma_f32_16x16x32_bf16 a[80:83], v[240:243], a[180:183], a[80:83]
    v_mfma_f32_16x16x32_bf16 a[84:87], v[244:247], a[180:183], a[84:87]
    ds_read_b32 v104, v96 offset:40
    ds_read_b128 a[132:135], v13 offset:0
    v_mfma_f32_16x16x32_bf16 a[84:87], v[212:215], a[176:179], a[84:87]
    v_mfma_f32_16x16x32_bf16 a[88:91], v[216:219], a[176:179], a[88:91]
    s_waitcnt lgkmcnt(2)
    s_add_u32 m0, s78, 15360
    v_lshl_add_u32 v119, v119, 8, v11
    buffer_load_dwordx4 v119, s[32:35], 0 offen lds
    v_mfma_f32_16x16x32_bf16 a[88:91], v[248:251], a[180:183], a[88:91]
    v_mfma_f32_16x16x32_bf16 a[92:95], v[252:255], a[180:183], a[92:95]
    ds_read_b32 v105, v96 offset:872
    v_mfma_f32_16x16x32_bf16 a[92:95], v[220:223], a[176:179], a[92:95]
    v_mfma_f32_16x16x32_bf16 a[96:99], v[192:195], a[184:187], a[96:99]
    s_waitcnt lgkmcnt(2)
    s_add_u32 m0, s78, 16384
    v_lshl_add_u32 v104, v104, 8, v10
    buffer_load_dwordx4 v104, s[32:35], 0 offen lds
    v_mfma_f32_16x16x32_bf16 a[96:99], v[224:227], a[188:191], a[96:99]
    s_waitcnt vmcnt(19)
    v_perm_b32 v192, v36, v32, s64
    v_perm_b32 v193, v44, v40, s64
    v_perm_b32 v194, v52, v48, s64
    v_mfma_f32_16x16x32_bf16 a[100:103], v[228:231], a[188:191], a[100:103]
    v_perm_b32 v195, v60, v56, s64
    s_waitcnt vmcnt(11)
    v_perm_b32 v224, v68, v64, s64
    v_perm_b32 v225, v76, v72, s64
    ds_read_b32 v106, v96 offset:1704
    v_mfma_f32_16x16x32_bf16 a[100:103], v[196:199], a[184:187], a[100:103]
    v_perm_b32 v226, v84, v80, s64
    v_perm_b32 v227, v92, v88, s64
    v_perm_b32 v228, v68, v64, s65
    ds_read_b128 a[136:139], v12 offset:2048
    v_mfma_f32_16x16x32_bf16 a[104:107], v[200:203], a[184:187], a[104:107]
    v_perm_b32 v229, v76, v72, s65
    v_perm_b32 v230, v84, v80, s65
    v_perm_b32 v231, v92, v88, s65
    s_waitcnt lgkmcnt(2)
    s_add_u32 m0, s78, 17408
    v_lshl_add_u32 v105, v105, 8, v11
    buffer_load_dwordx4 v105, s[32:35], 0 offen lds
    v_mfma_f32_16x16x32_bf16 a[104:107], v[232:235], a[188:191], a[104:107]
    v_perm_b32 v196, v36, v32, s65
    v_perm_b32 v197, v44, v40, s65
    v_perm_b32 v198, v52, v48, s65
    v_mfma_f32_16x16x32_bf16 a[108:111], v[236:239], a[188:191], a[108:111]
    v_perm_b32 v199, v60, v56, s65
    v_perm_b32 v200, v37, v33, s64
    v_perm_b32 v201, v45, v41, s64
    ds_read_b32 v107, v96 offset:2536
    v_mfma_f32_16x16x32_bf16 a[108:111], v[204:207], a[184:187], a[108:111]
    v_perm_b32 v202, v53, v49, s64
    v_perm_b32 v203, v61, v57, s64
    v_perm_b32 v232, v69, v65, s64
    v_mfma_f32_16x16x32_bf16 a[112:115], v[208:211], a[184:187], a[112:115]
    v_perm_b32 v233, v77, v73, s64
    v_perm_b32 v234, v85, v81, s64
    v_perm_b32 v235, v93, v89, s64
    s_waitcnt lgkmcnt(2)
    s_add_u32 m0, s78, 18432
    v_lshl_add_u32 v106, v106, 8, v10
    buffer_load_dwordx4 v106, s[32:35], 0 offen lds
    v_mfma_f32_16x16x32_bf16 a[112:115], v[240:243], a[188:191], a[112:115]
    v_perm_b32 v236, v69, v65, s65
    v_perm_b32 v237, v77, v73, s65
    v_perm_b32 v238, v85, v81, s65
    v_mfma_f32_16x16x32_bf16 a[116:119], v[244:247], a[188:191], a[116:119]
    v_perm_b32 v239, v93, v89, s65
    v_perm_b32 v204, v37, v33, s65
    v_perm_b32 v205, v45, v41, s65
    ds_read_b32 v108, v97 offset:40
    ds_read_b128 a[140:143], v13 offset:2048
    v_mfma_f32_16x16x32_bf16 a[116:119], v[212:215], a[184:187], a[116:119]
    v_perm_b32 v206, v53, v49, s65
    v_perm_b32 v207, v61, v57, s65
    v_perm_b32 v208, v38, v34, s64
    v_mfma_f32_16x16x32_bf16 a[120:123], v[216:219], a[184:187], a[120:123]
    v_perm_b32 v209, v46, v42, s64
    v_perm_b32 v210, v54, v50, s64
    v_perm_b32 v211, v62, v58, s64
    s_waitcnt lgkmcnt(2)
    s_add_u32 m0, s78, 19456
    v_lshl_add_u32 v107, v107, 8, v11
    buffer_load_dwordx4 v107, s[32:35], 0 offen lds
    v_mfma_f32_16x16x32_bf16 a[120:123], v[248:251], a[188:191], a[120:123]
    v_perm_b32 v240, v70, v66, s64
    v_perm_b32 v241, v78, v74, s64
    v_perm_b32 v242, v86, v82, s64
    v_mfma_f32_16x16x32_bf16 a[124:127], v[252:255], a[188:191], a[124:127]
    v_perm_b32 v243, v94, v90, s64
    v_perm_b32 v244, v70, v66, s65
    v_perm_b32 v245, v78, v74, s65
    ds_read_b32 v109, v97 offset:872
    v_mfma_f32_16x16x32_bf16 a[124:127], v[220:223], a[184:187], a[124:127]
    v_perm_b32 v246, v86, v82, s65
    v_perm_b32 v247, v94, v90, s65
    v_perm_b32 v212, v38, v34, s65
    v_mfma_f32_16x16x32_bf16 v[128:131], v[192:195], a[128:131], v[128:131]
    v_perm_b32 v213, v46, v42, s65
    v_perm_b32 v214, v54, v50, s65
    v_perm_b32 v215, v62, v58, s65
    s_waitcnt lgkmcnt(2)
    s_add_u32 m0, s78, 20480
    v_lshl_add_u32 v108, v108, 8, v10
    buffer_load_dwordx4 v108, s[32:35], 0 offen lds
    v_mfma_f32_16x16x32_bf16 v[128:131], v[224:227], a[132:135], v[128:131]
    v_perm_b32 v216, v39, v35, s64
    v_perm_b32 v217, v47, v43, s64
    v_perm_b32 v218, v55, v51, s64
    v_mfma_f32_16x16x32_bf16 v[132:135], v[228:231], a[132:135], v[132:135]
    v_perm_b32 v219, v63, v59, s64
    v_perm_b32 v248, v71, v67, s64
    v_perm_b32 v249, v79, v75, s64
    v_mfma_f32_16x16x32_bf16 v[132:135], v[196:199], a[128:131], v[132:135]
    v_perm_b32 v250, v87, v83, s64
    v_perm_b32 v251, v95, v91, s64
    v_perm_b32 v252, v71, v67, s65
    ds_read_b128 a[144:147], v12 offset:4096
    v_mfma_f32_16x16x32_bf16 v[136:139], v[200:203], a[128:131], v[136:139]
    v_perm_b32 v253, v79, v75, s65
    v_perm_b32 v254, v87, v83, s65
    v_perm_b32 v255, v95, v91, s65
    s_waitcnt lgkmcnt(1)
    s_add_u32 m0, s78, 21504
    v_lshl_add_u32 v109, v109, 8, v11
    buffer_load_dwordx4 v109, s[32:35], 0 offen lds
    v_mfma_f32_16x16x32_bf16 v[136:139], v[232:235], a[132:135], v[136:139]
    v_perm_b32 v220, v39, v35, s65
    v_perm_b32 v221, v47, v43, s65
    v_perm_b32 v222, v55, v51, s65
    v_mfma_f32_16x16x32_bf16 v[140:143], v[236:239], a[132:135], v[140:143]
    v_perm_b32 v223, v63, v59, s65
    v_mfma_f32_16x16x32_bf16 v[140:143], v[204:207], a[128:131], v[140:143]
    v_mfma_f32_16x16x32_bf16 v[144:147], v[208:211], a[128:131], v[144:147]
    v_add_u32 v7, 1490944, v7
    buffer_load_dwordx4 v[32:35], v7, s[36:39], s56 offen
    v_mfma_f32_16x16x32_bf16 v[144:147], v[240:243], a[132:135], v[144:147]
    v_mfma_f32_16x16x32_bf16 v[148:151], v[244:247], a[132:135], v[148:151]
    ds_read_b128 a[148:151], v13 offset:4096
    v_mfma_f32_16x16x32_bf16 v[148:151], v[212:215], a[128:131], v[148:151]
    v_mfma_f32_16x16x32_bf16 v[152:155], v[216:219], a[128:131], v[152:155]
    buffer_load_dwordx4 v[36:39], v7, s[36:39], s57 offen
    v_mfma_f32_16x16x32_bf16 v[152:155], v[248:251], a[132:135], v[152:155]
    v_mfma_f32_16x16x32_bf16 v[156:159], v[252:255], a[132:135], v[156:159]
    v_mfma_f32_16x16x32_bf16 v[156:159], v[220:223], a[128:131], v[156:159]
    v_mfma_f32_16x16x32_bf16 v[160:163], v[192:195], a[136:139], v[160:163]
    buffer_load_dwordx4 v[40:43], v7, s[36:39], s58 offen
    v_mfma_f32_16x16x32_bf16 v[160:163], v[224:227], a[140:143], v[160:163]
    v_mfma_f32_16x16x32_bf16 v[164:167], v[228:231], a[140:143], v[164:167]
    v_mfma_f32_16x16x32_bf16 v[164:167], v[196:199], a[136:139], v[164:167]
    s_waitcnt vmcnt(17)
    ds_read_b128 a[152:155], v12 offset:6144
    v_mfma_f32_16x16x32_bf16 v[168:171], v[200:203], a[136:139], v[168:171]
    buffer_load_dwordx4 v[44:47], v7, s[36:39], s59 offen
    v_mfma_f32_16x16x32_bf16 v[168:171], v[232:235], a[140:143], v[168:171]
    v_mfma_f32_16x16x32_bf16 v[172:175], v[236:239], a[140:143], v[172:175]
    v_mfma_f32_16x16x32_bf16 v[172:175], v[204:207], a[136:139], v[172:175]
    v_mfma_f32_16x16x32_bf16 v[176:179], v[208:211], a[136:139], v[176:179]
    buffer_load_dwordx4 v[48:51], v7, s[36:39], s60 offen
    v_mfma_f32_16x16x32_bf16 v[176:179], v[240:243], a[140:143], v[176:179]
    v_mfma_f32_16x16x32_bf16 v[180:183], v[244:247], a[140:143], v[180:183]
    ds_read_b128 a[156:159], v13 offset:6144
    v_mfma_f32_16x16x32_bf16 v[180:183], v[212:215], a[136:139], v[180:183]
    v_mfma_f32_16x16x32_bf16 v[184:187], v[216:219], a[136:139], v[184:187]
    buffer_load_dwordx4 v[52:55], v7, s[36:39], s61 offen
    v_mfma_f32_16x16x32_bf16 v[184:187], v[248:251], a[140:143], v[184:187]
    v_mfma_f32_16x16x32_bf16 v[188:191], v[252:255], a[140:143], v[188:191]
    v_mfma_f32_16x16x32_bf16 v[188:191], v[220:223], a[136:139], v[188:191]
    s_waitcnt lgkmcnt(3)
    v_mfma_f32_16x16x32_bf16 a[192:195], v[192:195], a[144:147], a[192:195]
    buffer_load_dwordx4 v[56:59], v7, s[36:39], s62 offen
    s_waitcnt lgkmcnt(2)
    v_mfma_f32_16x16x32_bf16 a[192:195], v[224:227], a[148:151], a[192:195]
    v_mfma_f32_16x16x32_bf16 a[196:199], v[228:231], a[148:151], a[196:199]
    v_mfma_f32_16x16x32_bf16 a[196:199], v[196:199], a[144:147], a[196:199]
    s_waitcnt vmcnt(19)
    ds_read_b128 a[160:163], v12 offset:8192
    v_mfma_f32_16x16x32_bf16 a[200:203], v[200:203], a[144:147], a[200:203]
    buffer_load_dwordx4 v[60:63], v7, s[36:39], s63 offen
    v_mfma_f32_16x16x32_bf16 a[200:203], v[232:235], a[148:151], a[200:203]
    v_mfma_f32_16x16x32_bf16 a[204:207], v[236:239], a[148:151], a[204:207]
    v_mfma_f32_16x16x32_bf16 a[204:207], v[204:207], a[144:147], a[204:207]
    v_mfma_f32_16x16x32_bf16 a[208:211], v[208:211], a[144:147], a[208:211]
    v_add_u32 v7, 212992, v7
    buffer_load_dwordx4 v[64:67], v7, s[36:39], s56 offen
    v_mfma_f32_16x16x32_bf16 a[208:211], v[240:243], a[148:151], a[208:211]
    v_mfma_f32_16x16x32_bf16 a[212:215], v[244:247], a[148:151], a[212:215]
    ds_read_b128 a[164:167], v13 offset:8192
    v_mfma_f32_16x16x32_bf16 a[212:215], v[212:215], a[144:147], a[212:215]
    v_mfma_f32_16x16x32_bf16 a[216:219], v[216:219], a[144:147], a[216:219]
    buffer_load_dwordx4 v[68:71], v7, s[36:39], s57 offen
    v_mfma_f32_16x16x32_bf16 a[216:219], v[248:251], a[148:151], a[216:219]
    v_mfma_f32_16x16x32_bf16 a[220:223], v[252:255], a[148:151], a[220:223]
    v_mfma_f32_16x16x32_bf16 a[220:223], v[220:223], a[144:147], a[220:223]
    s_waitcnt lgkmcnt(3)
    v_mfma_f32_16x16x32_bf16 a[224:227], v[192:195], a[152:155], a[224:227]
    buffer_load_dwordx4 v[72:75], v7, s[36:39], s58 offen
    s_waitcnt lgkmcnt(2)
    v_mfma_f32_16x16x32_bf16 a[224:227], v[224:227], a[156:159], a[224:227]
    v_mfma_f32_16x16x32_bf16 a[228:231], v[228:231], a[156:159], a[228:231]
    v_mfma_f32_16x16x32_bf16 a[228:231], v[196:199], a[152:155], a[228:231]
    s_waitcnt vmcnt(21)
    ds_read_b128 a[168:171], v12 offset:10240
    v_mfma_f32_16x16x32_bf16 a[232:235], v[200:203], a[152:155], a[232:235]
    buffer_load_dwordx4 v[76:79], v7, s[36:39], s59 offen
    v_mfma_f32_16x16x32_bf16 a[232:235], v[232:235], a[156:159], a[232:235]
    v_mfma_f32_16x16x32_bf16 a[236:239], v[236:239], a[156:159], a[236:239]
    v_mfma_f32_16x16x32_bf16 a[236:239], v[204:207], a[152:155], a[236:239]
    v_mfma_f32_16x16x32_bf16 a[240:243], v[208:211], a[152:155], a[240:243]
    buffer_load_dwordx4 v[80:83], v7, s[36:39], s60 offen
    v_mfma_f32_16x16x32_bf16 a[240:243], v[240:243], a[156:159], a[240:243]
    v_mfma_f32_16x16x32_bf16 a[244:247], v[244:247], a[156:159], a[244:247]
    ds_read_b128 a[172:175], v13 offset:10240
    v_mfma_f32_16x16x32_bf16 a[244:247], v[212:215], a[152:155], a[244:247]
    v_mfma_f32_16x16x32_bf16 a[248:251], v[216:219], a[152:155], a[248:251]
    buffer_load_dwordx4 v[84:87], v7, s[36:39], s61 offen
    v_mfma_f32_16x16x32_bf16 a[248:251], v[248:251], a[156:159], a[248:251]
    v_mfma_f32_16x16x32_bf16 a[252:255], v[252:255], a[156:159], a[252:255]
    v_mfma_f32_16x16x32_bf16 a[252:255], v[220:223], a[152:155], a[252:255]
    s_waitcnt lgkmcnt(3)
    v_mfma_f32_16x16x32_bf16 a[0:3], v[192:195], a[160:163], a[0:3]
    buffer_load_dwordx4 v[88:91], v7, s[36:39], s62 offen
    s_waitcnt lgkmcnt(2)
    v_mfma_f32_16x16x32_bf16 a[0:3], v[224:227], a[164:167], a[0:3]
    v_mfma_f32_16x16x32_bf16 a[4:7], v[228:231], a[164:167], a[4:7]
    ds_read_b32 v110, v97 offset:1704
    v_mfma_f32_16x16x32_bf16 a[4:7], v[196:199], a[160:163], a[4:7]
    s_waitcnt vmcnt(23)
    ds_read_b128 a[176:179], v12 offset:12288
    v_mfma_f32_16x16x32_bf16 a[8:11], v[200:203], a[160:163], a[8:11]
    buffer_load_dwordx4 v[92:95], v7, s[36:39], s63 offen
    v_mfma_f32_16x16x32_bf16 a[8:11], v[232:235], a[164:167], a[8:11]
    v_mfma_f32_16x16x32_bf16 a[12:15], v[236:239], a[164:167], a[12:15]
    ds_read_b32 v111, v97 offset:2536
    v_mfma_f32_16x16x32_bf16 a[12:15], v[204:207], a[160:163], a[12:15]
    v_mfma_f32_16x16x32_bf16 a[16:19], v[208:211], a[160:163], a[16:19]
    s_waitcnt lgkmcnt(2)
    s_add_u32 m0, s78, 22528
    v_lshl_add_u32 v110, v110, 8, v10
    buffer_load_dwordx4 v110, s[32:35], 0 offen lds
    v_mfma_f32_16x16x32_bf16 a[16:19], v[240:243], a[164:167], a[16:19]
    v_mfma_f32_16x16x32_bf16 a[20:23], v[244:247], a[164:167], a[20:23]
    ds_read_b32 v112, v98 offset:40
    ds_read_b128 a[180:183], v13 offset:12288
    v_mfma_f32_16x16x32_bf16 a[20:23], v[212:215], a[160:163], a[20:23]
    v_mfma_f32_16x16x32_bf16 a[24:27], v[216:219], a[160:163], a[24:27]
    s_waitcnt lgkmcnt(2)
    s_add_u32 m0, s78, 23552
    v_lshl_add_u32 v111, v111, 8, v11
    buffer_load_dwordx4 v111, s[32:35], 0 offen lds
    v_mfma_f32_16x16x32_bf16 a[24:27], v[248:251], a[164:167], a[24:27]
    v_mfma_f32_16x16x32_bf16 a[28:31], v[252:255], a[164:167], a[28:31]
    ds_read_b32 v113, v98 offset:872
    v_mfma_f32_16x16x32_bf16 a[28:31], v[220:223], a[160:163], a[28:31]
    v_mfma_f32_16x16x32_bf16 a[32:35], v[192:195], a[168:171], a[32:35]
    s_waitcnt lgkmcnt(2)
    s_add_u32 m0, s78, 24576
    v_lshl_add_u32 v112, v112, 8, v10
    buffer_load_dwordx4 v112, s[32:35], 0 offen lds
    v_mfma_f32_16x16x32_bf16 a[32:35], v[224:227], a[172:175], a[32:35]
    v_mfma_f32_16x16x32_bf16 a[36:39], v[228:231], a[172:175], a[36:39]
    ds_read_b32 v114, v98 offset:1704
    v_mfma_f32_16x16x32_bf16 a[36:39], v[196:199], a[168:171], a[36:39]
    s_waitcnt vmcnt(25)
    ds_read_b128 a[184:187], v12 offset:14336
    v_mfma_f32_16x16x32_bf16 a[40:43], v[200:203], a[168:171], a[40:43]
    s_waitcnt lgkmcnt(2)
    s_add_u32 m0, s78, 25600
    v_lshl_add_u32 v113, v113, 8, v11
    buffer_load_dwordx4 v113, s[32:35], 0 offen lds
    v_mfma_f32_16x16x32_bf16 a[40:43], v[232:235], a[172:175], a[40:43]
    v_mfma_f32_16x16x32_bf16 a[44:47], v[236:239], a[172:175], a[44:47]
    ds_read_b32 v115, v98 offset:2536
    v_mfma_f32_16x16x32_bf16 a[44:47], v[204:207], a[168:171], a[44:47]
    v_mfma_f32_16x16x32_bf16 a[48:51], v[208:211], a[168:171], a[48:51]
    s_waitcnt lgkmcnt(2)
    s_add_u32 m0, s78, 26624
    v_lshl_add_u32 v114, v114, 8, v10
    buffer_load_dwordx4 v114, s[32:35], 0 offen lds
    v_mfma_f32_16x16x32_bf16 a[48:51], v[240:243], a[172:175], a[48:51]
    v_mfma_f32_16x16x32_bf16 a[52:55], v[244:247], a[172:175], a[52:55]
    ds_read_b32 v116, v99 offset:40
    ds_read_b128 a[188:191], v13 offset:14336
    v_mfma_f32_16x16x32_bf16 a[52:55], v[212:215], a[168:171], a[52:55]
    v_mfma_f32_16x16x32_bf16 a[56:59], v[216:219], a[168:171], a[56:59]
    s_waitcnt lgkmcnt(2)
    s_add_u32 m0, s78, 27648
    v_lshl_add_u32 v115, v115, 8, v11
    buffer_load_dwordx4 v115, s[32:35], 0 offen lds
    v_mfma_f32_16x16x32_bf16 a[56:59], v[248:251], a[172:175], a[56:59]
    v_mfma_f32_16x16x32_bf16 a[60:63], v[252:255], a[172:175], a[60:63]
    ds_read_b32 v117, v99 offset:872
    v_mfma_f32_16x16x32_bf16 a[60:63], v[220:223], a[168:171], a[60:63]
    v_mfma_f32_16x16x32_bf16 a[64:67], v[192:195], a[176:179], a[64:67]
    s_waitcnt lgkmcnt(2)
    s_add_u32 m0, s78, 28672
    v_lshl_add_u32 v116, v116, 8, v10
    buffer_load_dwordx4 v116, s[32:35], 0 offen lds
    v_mfma_f32_16x16x32_bf16 a[64:67], v[224:227], a[180:183], a[64:67]
    v_mfma_f32_16x16x32_bf16 a[68:71], v[228:231], a[180:183], a[68:71]
    ds_read_b32 v118, v99 offset:1704
    v_mfma_f32_16x16x32_bf16 a[68:71], v[196:199], a[176:179], a[68:71]
    s_waitcnt vmcnt(27)
    ds_read_b128 a[128:131], v12 offset:16384
    v_mfma_f32_16x16x32_bf16 a[72:75], v[200:203], a[176:179], a[72:75]
    s_waitcnt lgkmcnt(2)
    s_add_u32 m0, s78, 29696
    v_lshl_add_u32 v117, v117, 8, v11
    buffer_load_dwordx4 v117, s[32:35], 0 offen lds
    v_mfma_f32_16x16x32_bf16 a[72:75], v[232:235], a[180:183], a[72:75]
    v_mfma_f32_16x16x32_bf16 a[76:79], v[236:239], a[180:183], a[76:79]
    ds_read_b32 v119, v99 offset:2536
    v_mfma_f32_16x16x32_bf16 a[76:79], v[204:207], a[176:179], a[76:79]
    v_mfma_f32_16x16x32_bf16 a[80:83], v[208:211], a[176:179], a[80:83]
    s_waitcnt lgkmcnt(2)
    s_add_u32 m0, s78, 30720
    v_lshl_add_u32 v118, v118, 8, v10
    buffer_load_dwordx4 v118, s[32:35], 0 offen lds
    v_mfma_f32_16x16x32_bf16 a[80:83], v[240:243], a[180:183], a[80:83]
    v_mfma_f32_16x16x32_bf16 a[84:87], v[244:247], a[180:183], a[84:87]
    ds_read_b32 v104, v96 offset:48
    ds_read_b128 a[132:135], v13 offset:16384
    v_mfma_f32_16x16x32_bf16 a[84:87], v[212:215], a[176:179], a[84:87]
    v_mfma_f32_16x16x32_bf16 a[88:91], v[216:219], a[176:179], a[88:91]
    s_waitcnt lgkmcnt(2)
    s_add_u32 m0, s78, 31744
    v_lshl_add_u32 v119, v119, 8, v11
    buffer_load_dwordx4 v119, s[32:35], 0 offen lds
    v_mfma_f32_16x16x32_bf16 a[88:91], v[248:251], a[180:183], a[88:91]
    v_mfma_f32_16x16x32_bf16 a[92:95], v[252:255], a[180:183], a[92:95]
    ds_read_b32 v105, v96 offset:880
    v_mfma_f32_16x16x32_bf16 a[92:95], v[220:223], a[176:179], a[92:95]
    v_mfma_f32_16x16x32_bf16 a[96:99], v[192:195], a[184:187], a[96:99]
    s_waitcnt lgkmcnt(2)
    s_add_u32 m0, s78, 0
    v_lshl_add_u32 v104, v104, 8, v10
    buffer_load_dwordx4 v104, s[32:35], 0 offen lds
    v_mfma_f32_16x16x32_bf16 a[96:99], v[224:227], a[188:191], a[96:99]
    s_waitcnt vmcnt(19)
    v_perm_b32 v192, v36, v32, s64
    v_perm_b32 v193, v44, v40, s64
    v_perm_b32 v194, v52, v48, s64
    v_mfma_f32_16x16x32_bf16 a[100:103], v[228:231], a[188:191], a[100:103]
    v_perm_b32 v195, v60, v56, s64
    s_waitcnt vmcnt(11)
    v_perm_b32 v224, v68, v64, s64
    v_perm_b32 v225, v76, v72, s64
    ds_read_b32 v106, v96 offset:1712
    v_mfma_f32_16x16x32_bf16 a[100:103], v[196:199], a[184:187], a[100:103]
    v_perm_b32 v226, v84, v80, s64
    v_perm_b32 v227, v92, v88, s64
    v_perm_b32 v228, v68, v64, s65
    ds_read_b128 a[136:139], v12 offset:18432
    v_mfma_f32_16x16x32_bf16 a[104:107], v[200:203], a[184:187], a[104:107]
    v_perm_b32 v229, v76, v72, s65
    v_perm_b32 v230, v84, v80, s65
    v_perm_b32 v231, v92, v88, s65
    s_waitcnt lgkmcnt(2)
    s_add_u32 m0, s78, 1024
    v_lshl_add_u32 v105, v105, 8, v11
    buffer_load_dwordx4 v105, s[32:35], 0 offen lds
    v_mfma_f32_16x16x32_bf16 a[104:107], v[232:235], a[188:191], a[104:107]
    v_perm_b32 v196, v36, v32, s65
    v_perm_b32 v197, v44, v40, s65
    v_perm_b32 v198, v52, v48, s65
    v_mfma_f32_16x16x32_bf16 a[108:111], v[236:239], a[188:191], a[108:111]
    v_perm_b32 v199, v60, v56, s65
    v_perm_b32 v200, v37, v33, s64
    v_perm_b32 v201, v45, v41, s64
    ds_read_b32 v107, v96 offset:2544
    v_mfma_f32_16x16x32_bf16 a[108:111], v[204:207], a[184:187], a[108:111]
    v_perm_b32 v202, v53, v49, s64
    v_perm_b32 v203, v61, v57, s64
    v_perm_b32 v232, v69, v65, s64
    v_mfma_f32_16x16x32_bf16 a[112:115], v[208:211], a[184:187], a[112:115]
    v_perm_b32 v233, v77, v73, s64
    v_perm_b32 v234, v85, v81, s64
    v_perm_b32 v235, v93, v89, s64
    s_waitcnt lgkmcnt(2)
    s_add_u32 m0, s78, 2048
    v_lshl_add_u32 v106, v106, 8, v10
    buffer_load_dwordx4 v106, s[32:35], 0 offen lds
    v_mfma_f32_16x16x32_bf16 a[112:115], v[240:243], a[188:191], a[112:115]
    v_perm_b32 v236, v69, v65, s65
    v_perm_b32 v237, v77, v73, s65
    v_perm_b32 v238, v85, v81, s65
    v_mfma_f32_16x16x32_bf16 a[116:119], v[244:247], a[188:191], a[116:119]
    v_perm_b32 v239, v93, v89, s65
    v_perm_b32 v204, v37, v33, s65
    v_perm_b32 v205, v45, v41, s65
    ds_read_b32 v108, v97 offset:48
    ds_read_b128 a[140:143], v13 offset:18432
    v_mfma_f32_16x16x32_bf16 a[116:119], v[212:215], a[184:187], a[116:119]
    v_perm_b32 v206, v53, v49, s65
    v_perm_b32 v207, v61, v57, s65
    v_perm_b32 v208, v38, v34, s64
    v_mfma_f32_16x16x32_bf16 a[120:123], v[216:219], a[184:187], a[120:123]
    v_perm_b32 v209, v46, v42, s64
    v_perm_b32 v210, v54, v50, s64
    v_perm_b32 v211, v62, v58, s64
    s_waitcnt lgkmcnt(2)
    s_add_u32 m0, s78, 3072
    v_lshl_add_u32 v107, v107, 8, v11
    buffer_load_dwordx4 v107, s[32:35], 0 offen lds
    v_mfma_f32_16x16x32_bf16 a[120:123], v[248:251], a[188:191], a[120:123]
    v_perm_b32 v240, v70, v66, s64
    v_perm_b32 v241, v78, v74, s64
    v_perm_b32 v242, v86, v82, s64
    v_mfma_f32_16x16x32_bf16 a[124:127], v[252:255], a[188:191], a[124:127]
    v_perm_b32 v243, v94, v90, s64
    v_perm_b32 v244, v70, v66, s65
    v_perm_b32 v245, v78, v74, s65
    ds_read_b32 v109, v97 offset:880
    v_mfma_f32_16x16x32_bf16 a[124:127], v[220:223], a[184:187], a[124:127]
    v_perm_b32 v246, v86, v82, s65
    v_perm_b32 v247, v94, v90, s65
    v_perm_b32 v212, v38, v34, s65
    v_mfma_f32_16x16x32_bf16 v[128:131], v[192:195], a[128:131], v[128:131]
    v_perm_b32 v213, v46, v42, s65
    v_perm_b32 v214, v54, v50, s65
    v_perm_b32 v215, v62, v58, s65
    s_waitcnt lgkmcnt(2)
    s_add_u32 m0, s78, 4096
    v_lshl_add_u32 v108, v108, 8, v10
    buffer_load_dwordx4 v108, s[32:35], 0 offen lds
    v_mfma_f32_16x16x32_bf16 v[128:131], v[224:227], a[132:135], v[128:131]
    v_perm_b32 v216, v39, v35, s64
    v_perm_b32 v217, v47, v43, s64
    v_perm_b32 v218, v55, v51, s64
    v_mfma_f32_16x16x32_bf16 v[132:135], v[228:231], a[132:135], v[132:135]
    v_perm_b32 v219, v63, v59, s64
    v_perm_b32 v248, v71, v67, s64
    v_perm_b32 v249, v79, v75, s64
    v_mfma_f32_16x16x32_bf16 v[132:135], v[196:199], a[128:131], v[132:135]
    v_perm_b32 v250, v87, v83, s64
    v_perm_b32 v251, v95, v91, s64
    v_perm_b32 v252, v71, v67, s65
    ds_read_b128 a[144:147], v12 offset:20480
    v_mfma_f32_16x16x32_bf16 v[136:139], v[200:203], a[128:131], v[136:139]
    v_perm_b32 v253, v79, v75, s65
    v_perm_b32 v254, v87, v83, s65
    v_perm_b32 v255, v95, v91, s65
    s_waitcnt lgkmcnt(1)
    s_add_u32 m0, s78, 5120
    v_lshl_add_u32 v109, v109, 8, v11
    buffer_load_dwordx4 v109, s[32:35], 0 offen lds
    v_mfma_f32_16x16x32_bf16 v[136:139], v[232:235], a[132:135], v[136:139]
    v_perm_b32 v220, v39, v35, s65
    v_perm_b32 v221, v47, v43, s65
    v_perm_b32 v222, v55, v51, s65
    v_mfma_f32_16x16x32_bf16 v[140:143], v[236:239], a[132:135], v[140:143]
    v_perm_b32 v223, v63, v59, s65
    v_mfma_f32_16x16x32_bf16 v[140:143], v[204:207], a[128:131], v[140:143]
    v_mfma_f32_16x16x32_bf16 v[144:147], v[208:211], a[128:131], v[144:147]
    v_add_u32 v7, 1490944, v7
    buffer_load_dwordx4 v[32:35], v7, s[36:39], s56 offen
    v_mfma_f32_16x16x32_bf16 v[144:147], v[240:243], a[132:135], v[144:147]
    v_mfma_f32_16x16x32_bf16 v[148:151], v[244:247], a[132:135], v[148:151]
    ds_read_b128 a[148:151], v13 offset:20480
    v_mfma_f32_16x16x32_bf16 v[148:151], v[212:215], a[128:131], v[148:151]
    v_mfma_f32_16x16x32_bf16 v[152:155], v[216:219], a[128:131], v[152:155]
    buffer_load_dwordx4 v[36:39], v7, s[36:39], s57 offen
    v_mfma_f32_16x16x32_bf16 v[152:155], v[248:251], a[132:135], v[152:155]
    v_mfma_f32_16x16x32_bf16 v[156:159], v[252:255], a[132:135], v[156:159]
    v_mfma_f32_16x16x32_bf16 v[156:159], v[220:223], a[128:131], v[156:159]
    v_mfma_f32_16x16x32_bf16 v[160:163], v[192:195], a[136:139], v[160:163]
    buffer_load_dwordx4 v[40:43], v7, s[36:39], s58 offen
    v_mfma_f32_16x16x32_bf16 v[160:163], v[224:227], a[140:143], v[160:163]
    v_mfma_f32_16x16x32_bf16 v[164:167], v[228:231], a[140:143], v[164:167]
    v_mfma_f32_16x16x32_bf16 v[164:167], v[196:199], a[136:139], v[164:167]
    s_waitcnt vmcnt(17)
    ds_read_b128 a[152:155], v12 offset:22528
    v_mfma_f32_16x16x32_bf16 v[168:171], v[200:203], a[136:139], v[168:171]
    buffer_load_dwordx4 v[44:47], v7, s[36:39], s59 offen
    v_mfma_f32_16x16x32_bf16 v[168:171], v[232:235], a[140:143], v[168:171]
    v_mfma_f32_16x16x32_bf16 v[172:175], v[236:239], a[140:143], v[172:175]
    v_mfma_f32_16x16x32_bf16 v[172:175], v[204:207], a[136:139], v[172:175]
    v_mfma_f32_16x16x32_bf16 v[176:179], v[208:211], a[136:139], v[176:179]
    buffer_load_dwordx4 v[48:51], v7, s[36:39], s60 offen
    v_mfma_f32_16x16x32_bf16 v[176:179], v[240:243], a[140:143], v[176:179]
    v_mfma_f32_16x16x32_bf16 v[180:183], v[244:247], a[140:143], v[180:183]
    ds_read_b128 a[156:159], v13 offset:22528
    v_mfma_f32_16x16x32_bf16 v[180:183], v[212:215], a[136:139], v[180:183]
    v_mfma_f32_16x16x32_bf16 v[184:187], v[216:219], a[136:139], v[184:187]
    buffer_load_dwordx4 v[52:55], v7, s[36:39], s61 offen
    v_mfma_f32_16x16x32_bf16 v[184:187], v[248:251], a[140:143], v[184:187]
    v_mfma_f32_16x16x32_bf16 v[188:191], v[252:255], a[140:143], v[188:191]
    v_mfma_f32_16x16x32_bf16 v[188:191], v[220:223], a[136:139], v[188:191]
    s_waitcnt lgkmcnt(3)
    v_mfma_f32_16x16x32_bf16 a[192:195], v[192:195], a[144:147], a[192:195]
    buffer_load_dwordx4 v[56:59], v7, s[36:39], s62 offen
    s_waitcnt lgkmcnt(2)
    v_mfma_f32_16x16x32_bf16 a[192:195], v[224:227], a[148:151], a[192:195]
    v_mfma_f32_16x16x32_bf16 a[196:199], v[228:231], a[148:151], a[196:199]
    v_mfma_f32_16x16x32_bf16 a[196:199], v[196:199], a[144:147], a[196:199]
    s_waitcnt vmcnt(19)
    ds_read_b128 a[160:163], v12 offset:24576
    v_mfma_f32_16x16x32_bf16 a[200:203], v[200:203], a[144:147], a[200:203]
    buffer_load_dwordx4 v[60:63], v7, s[36:39], s63 offen
    v_mfma_f32_16x16x32_bf16 a[200:203], v[232:235], a[148:151], a[200:203]
    v_mfma_f32_16x16x32_bf16 a[204:207], v[236:239], a[148:151], a[204:207]
    v_mfma_f32_16x16x32_bf16 a[204:207], v[204:207], a[144:147], a[204:207]
    v_mfma_f32_16x16x32_bf16 a[208:211], v[208:211], a[144:147], a[208:211]
    v_add_u32 v7, 212992, v7
    buffer_load_dwordx4 v[64:67], v7, s[36:39], s56 offen
    v_mfma_f32_16x16x32_bf16 a[208:211], v[240:243], a[148:151], a[208:211]
    v_mfma_f32_16x16x32_bf16 a[212:215], v[244:247], a[148:151], a[212:215]
    ds_read_b128 a[164:167], v13 offset:24576
    v_mfma_f32_16x16x32_bf16 a[212:215], v[212:215], a[144:147], a[212:215]
    v_mfma_f32_16x16x32_bf16 a[216:219], v[216:219], a[144:147], a[216:219]
    buffer_load_dwordx4 v[68:71], v7, s[36:39], s57 offen
    v_mfma_f32_16x16x32_bf16 a[216:219], v[248:251], a[148:151], a[216:219]
    v_mfma_f32_16x16x32_bf16 a[220:223], v[252:255], a[148:151], a[220:223]
    v_mfma_f32_16x16x32_bf16 a[220:223], v[220:223], a[144:147], a[220:223]
    s_waitcnt lgkmcnt(3)
    v_mfma_f32_16x16x32_bf16 a[224:227], v[192:195], a[152:155], a[224:227]
    buffer_load_dwordx4 v[72:75], v7, s[36:39], s58 offen
    s_waitcnt lgkmcnt(2)
    v_mfma_f32_16x16x32_bf16 a[224:227], v[224:227], a[156:159], a[224:227]
    v_mfma_f32_16x16x32_bf16 a[228:231], v[228:231], a[156:159], a[228:231]
    v_mfma_f32_16x16x32_bf16 a[228:231], v[196:199], a[152:155], a[228:231]
    s_waitcnt vmcnt(21)
    ds_read_b128 a[168:171], v12 offset:26624
    v_mfma_f32_16x16x32_bf16 a[232:235], v[200:203], a[152:155], a[232:235]
    buffer_load_dwordx4 v[76:79], v7, s[36:39], s59 offen
    v_mfma_f32_16x16x32_bf16 a[232:235], v[232:235], a[156:159], a[232:235]
    v_mfma_f32_16x16x32_bf16 a[236:239], v[236:239], a[156:159], a[236:239]
    v_mfma_f32_16x16x32_bf16 a[236:239], v[204:207], a[152:155], a[236:239]
    v_mfma_f32_16x16x32_bf16 a[240:243], v[208:211], a[152:155], a[240:243]
    buffer_load_dwordx4 v[80:83], v7, s[36:39], s60 offen
    v_mfma_f32_16x16x32_bf16 a[240:243], v[240:243], a[156:159], a[240:243]
    v_mfma_f32_16x16x32_bf16 a[244:247], v[244:247], a[156:159], a[244:247]
    ds_read_b128 a[172:175], v13 offset:26624
    v_mfma_f32_16x16x32_bf16 a[244:247], v[212:215], a[152:155], a[244:247]
    v_mfma_f32_16x16x32_bf16 a[248:251], v[216:219], a[152:155], a[248:251]
    buffer_load_dwordx4 v[84:87], v7, s[36:39], s61 offen
    v_mfma_f32_16x16x32_bf16 a[248:251], v[248:251], a[156:159], a[248:251]
    v_mfma_f32_16x16x32_bf16 a[252:255], v[252:255], a[156:159], a[252:255]
    v_mfma_f32_16x16x32_bf16 a[252:255], v[220:223], a[152:155], a[252:255]
    s_waitcnt lgkmcnt(3)
    v_mfma_f32_16x16x32_bf16 a[0:3], v[192:195], a[160:163], a[0:3]
    buffer_load_dwordx4 v[88:91], v7, s[36:39], s62 offen
    s_waitcnt lgkmcnt(2)
    v_mfma_f32_16x16x32_bf16 a[0:3], v[224:227], a[164:167], a[0:3]
    v_mfma_f32_16x16x32_bf16 a[4:7], v[228:231], a[164:167], a[4:7]
    ds_read_b32 v110, v97 offset:1712
    v_mfma_f32_16x16x32_bf16 a[4:7], v[196:199], a[160:163], a[4:7]
    s_waitcnt vmcnt(23)
    ds_read_b128 a[176:179], v12 offset:28672
    v_mfma_f32_16x16x32_bf16 a[8:11], v[200:203], a[160:163], a[8:11]
    buffer_load_dwordx4 v[92:95], v7, s[36:39], s63 offen
    v_mfma_f32_16x16x32_bf16 a[8:11], v[232:235], a[164:167], a[8:11]
    v_mfma_f32_16x16x32_bf16 a[12:15], v[236:239], a[164:167], a[12:15]
    ds_read_b32 v111, v97 offset:2544
    v_mfma_f32_16x16x32_bf16 a[12:15], v[204:207], a[160:163], a[12:15]
    v_mfma_f32_16x16x32_bf16 a[16:19], v[208:211], a[160:163], a[16:19]
    s_waitcnt lgkmcnt(2)
    s_add_u32 m0, s78, 6144
    v_lshl_add_u32 v110, v110, 8, v10
    buffer_load_dwordx4 v110, s[32:35], 0 offen lds
    v_mfma_f32_16x16x32_bf16 a[16:19], v[240:243], a[164:167], a[16:19]
    v_mfma_f32_16x16x32_bf16 a[20:23], v[244:247], a[164:167], a[20:23]
    ds_read_b32 v112, v98 offset:48
    ds_read_b128 a[180:183], v13 offset:28672
    v_mfma_f32_16x16x32_bf16 a[20:23], v[212:215], a[160:163], a[20:23]
    v_mfma_f32_16x16x32_bf16 a[24:27], v[216:219], a[160:163], a[24:27]
    s_waitcnt lgkmcnt(2)
    s_add_u32 m0, s78, 7168
    v_lshl_add_u32 v111, v111, 8, v11
    buffer_load_dwordx4 v111, s[32:35], 0 offen lds
    v_mfma_f32_16x16x32_bf16 a[24:27], v[248:251], a[164:167], a[24:27]
    v_mfma_f32_16x16x32_bf16 a[28:31], v[252:255], a[164:167], a[28:31]
    ds_read_b32 v113, v98 offset:880
    v_mfma_f32_16x16x32_bf16 a[28:31], v[220:223], a[160:163], a[28:31]
    v_mfma_f32_16x16x32_bf16 a[32:35], v[192:195], a[168:171], a[32:35]
    s_waitcnt lgkmcnt(2)
    s_add_u32 m0, s78, 8192
    v_lshl_add_u32 v112, v112, 8, v10
    buffer_load_dwordx4 v112, s[32:35], 0 offen lds
    v_mfma_f32_16x16x32_bf16 a[32:35], v[224:227], a[172:175], a[32:35]
    v_mfma_f32_16x16x32_bf16 a[36:39], v[228:231], a[172:175], a[36:39]
    ds_read_b32 v114, v98 offset:1712
    v_mfma_f32_16x16x32_bf16 a[36:39], v[196:199], a[168:171], a[36:39]
    s_waitcnt vmcnt(25)
    ds_read_b128 a[184:187], v12 offset:30720
    v_mfma_f32_16x16x32_bf16 a[40:43], v[200:203], a[168:171], a[40:43]
    s_waitcnt lgkmcnt(2)
    s_add_u32 m0, s78, 9216
    v_lshl_add_u32 v113, v113, 8, v11
    buffer_load_dwordx4 v113, s[32:35], 0 offen lds
    v_mfma_f32_16x16x32_bf16 a[40:43], v[232:235], a[172:175], a[40:43]
    v_mfma_f32_16x16x32_bf16 a[44:47], v[236:239], a[172:175], a[44:47]
    ds_read_b32 v115, v98 offset:2544
    v_mfma_f32_16x16x32_bf16 a[44:47], v[204:207], a[168:171], a[44:47]
    v_mfma_f32_16x16x32_bf16 a[48:51], v[208:211], a[168:171], a[48:51]
    s_waitcnt lgkmcnt(2)
    s_add_u32 m0, s78, 10240
    v_lshl_add_u32 v114, v114, 8, v10
    buffer_load_dwordx4 v114, s[32:35], 0 offen lds
    v_mfma_f32_16x16x32_bf16 a[48:51], v[240:243], a[172:175], a[48:51]
    v_mfma_f32_16x16x32_bf16 a[52:55], v[244:247], a[172:175], a[52:55]
    ds_read_b32 v116, v99 offset:48
    ds_read_b128 a[188:191], v13 offset:30720
    v_mfma_f32_16x16x32_bf16 a[52:55], v[212:215], a[168:171], a[52:55]
    v_mfma_f32_16x16x32_bf16 a[56:59], v[216:219], a[168:171], a[56:59]
    s_waitcnt lgkmcnt(2)
    s_add_u32 m0, s78, 11264
    v_lshl_add_u32 v115, v115, 8, v11
    buffer_load_dwordx4 v115, s[32:35], 0 offen lds
    v_mfma_f32_16x16x32_bf16 a[56:59], v[248:251], a[172:175], a[56:59]
    v_mfma_f32_16x16x32_bf16 a[60:63], v[252:255], a[172:175], a[60:63]
    ds_read_b32 v117, v99 offset:880
    v_mfma_f32_16x16x32_bf16 a[60:63], v[220:223], a[168:171], a[60:63]
    v_mfma_f32_16x16x32_bf16 a[64:67], v[192:195], a[176:179], a[64:67]
    s_waitcnt lgkmcnt(2)
    s_add_u32 m0, s78, 12288
    v_lshl_add_u32 v116, v116, 8, v10
    buffer_load_dwordx4 v116, s[32:35], 0 offen lds
    v_mfma_f32_16x16x32_bf16 a[64:67], v[224:227], a[180:183], a[64:67]
    v_mfma_f32_16x16x32_bf16 a[68:71], v[228:231], a[180:183], a[68:71]
    ds_read_b32 v118, v99 offset:1712
    v_mfma_f32_16x16x32_bf16 a[68:71], v[196:199], a[176:179], a[68:71]
    s_waitcnt vmcnt(27)
    ds_read_b128 a[128:131], v12 offset:0
    v_mfma_f32_16x16x32_bf16 a[72:75], v[200:203], a[176:179], a[72:75]
    s_waitcnt lgkmcnt(2)
    s_add_u32 m0, s78, 13312
    v_lshl_add_u32 v117, v117, 8, v11
    buffer_load_dwordx4 v117, s[32:35], 0 offen lds
    v_mfma_f32_16x16x32_bf16 a[72:75], v[232:235], a[180:183], a[72:75]
    v_mfma_f32_16x16x32_bf16 a[76:79], v[236:239], a[180:183], a[76:79]
    ds_read_b32 v119, v99 offset:2544
    v_mfma_f32_16x16x32_bf16 a[76:79], v[204:207], a[176:179], a[76:79]
    v_mfma_f32_16x16x32_bf16 a[80:83], v[208:211], a[176:179], a[80:83]
    s_waitcnt lgkmcnt(2)
    s_add_u32 m0, s78, 14336
    v_lshl_add_u32 v118, v118, 8, v10
    buffer_load_dwordx4 v118, s[32:35], 0 offen lds
    v_mfma_f32_16x16x32_bf16 a[80:83], v[240:243], a[180:183], a[80:83]
    v_mfma_f32_16x16x32_bf16 a[84:87], v[244:247], a[180:183], a[84:87]
    ds_read_b32 v104, v96 offset:56
    ds_read_b128 a[132:135], v13 offset:0
    v_mfma_f32_16x16x32_bf16 a[84:87], v[212:215], a[176:179], a[84:87]
    v_mfma_f32_16x16x32_bf16 a[88:91], v[216:219], a[176:179], a[88:91]
    s_waitcnt lgkmcnt(2)
    s_add_u32 m0, s78, 15360
    v_lshl_add_u32 v119, v119, 8, v11
    buffer_load_dwordx4 v119, s[32:35], 0 offen lds
    v_mfma_f32_16x16x32_bf16 a[88:91], v[248:251], a[180:183], a[88:91]
    v_mfma_f32_16x16x32_bf16 a[92:95], v[252:255], a[180:183], a[92:95]
    ds_read_b32 v105, v96 offset:888
    v_mfma_f32_16x16x32_bf16 a[92:95], v[220:223], a[176:179], a[92:95]
    v_mfma_f32_16x16x32_bf16 a[96:99], v[192:195], a[184:187], a[96:99]
    s_waitcnt lgkmcnt(2)
    s_add_u32 m0, s78, 16384
    v_lshl_add_u32 v104, v104, 8, v10
    buffer_load_dwordx4 v104, s[32:35], 0 offen lds
    v_mfma_f32_16x16x32_bf16 a[96:99], v[224:227], a[188:191], a[96:99]
    s_waitcnt vmcnt(19)
    v_perm_b32 v192, v36, v32, s64
    v_perm_b32 v193, v44, v40, s64
    v_perm_b32 v194, v52, v48, s64
    v_mfma_f32_16x16x32_bf16 a[100:103], v[228:231], a[188:191], a[100:103]
    v_perm_b32 v195, v60, v56, s64
    s_waitcnt vmcnt(11)
    v_perm_b32 v224, v68, v64, s64
    v_perm_b32 v225, v76, v72, s64
    ds_read_b32 v106, v96 offset:1720
    v_mfma_f32_16x16x32_bf16 a[100:103], v[196:199], a[184:187], a[100:103]
    v_perm_b32 v226, v84, v80, s64
    v_perm_b32 v227, v92, v88, s64
    v_perm_b32 v228, v68, v64, s65
    ds_read_b128 a[136:139], v12 offset:2048
    v_mfma_f32_16x16x32_bf16 a[104:107], v[200:203], a[184:187], a[104:107]
    v_perm_b32 v229, v76, v72, s65
    v_perm_b32 v230, v84, v80, s65
    v_perm_b32 v231, v92, v88, s65
    s_waitcnt lgkmcnt(2)
    s_add_u32 m0, s78, 17408
    v_lshl_add_u32 v105, v105, 8, v11
    buffer_load_dwordx4 v105, s[32:35], 0 offen lds
    v_mfma_f32_16x16x32_bf16 a[104:107], v[232:235], a[188:191], a[104:107]
    v_perm_b32 v196, v36, v32, s65
    v_perm_b32 v197, v44, v40, s65
    v_perm_b32 v198, v52, v48, s65
    v_mfma_f32_16x16x32_bf16 a[108:111], v[236:239], a[188:191], a[108:111]
    v_perm_b32 v199, v60, v56, s65
    v_perm_b32 v200, v37, v33, s64
    v_perm_b32 v201, v45, v41, s64
    ds_read_b32 v107, v96 offset:2552
    v_mfma_f32_16x16x32_bf16 a[108:111], v[204:207], a[184:187], a[108:111]
    v_perm_b32 v202, v53, v49, s64
    v_perm_b32 v203, v61, v57, s64
    v_perm_b32 v232, v69, v65, s64
    v_mfma_f32_16x16x32_bf16 a[112:115], v[208:211], a[184:187], a[112:115]
    v_perm_b32 v233, v77, v73, s64
    v_perm_b32 v234, v85, v81, s64
    v_perm_b32 v235, v93, v89, s64
    s_waitcnt lgkmcnt(2)
    s_add_u32 m0, s78, 18432
    v_lshl_add_u32 v106, v106, 8, v10
    buffer_load_dwordx4 v106, s[32:35], 0 offen lds
    v_mfma_f32_16x16x32_bf16 a[112:115], v[240:243], a[188:191], a[112:115]
    v_perm_b32 v236, v69, v65, s65
    v_perm_b32 v237, v77, v73, s65
    v_perm_b32 v238, v85, v81, s65
    v_mfma_f32_16x16x32_bf16 a[116:119], v[244:247], a[188:191], a[116:119]
    v_perm_b32 v239, v93, v89, s65
    v_perm_b32 v204, v37, v33, s65
    v_perm_b32 v205, v45, v41, s65
    ds_read_b32 v108, v97 offset:56
    ds_read_b128 a[140:143], v13 offset:2048
    v_mfma_f32_16x16x32_bf16 a[116:119], v[212:215], a[184:187], a[116:119]
    v_perm_b32 v206, v53, v49, s65
    v_perm_b32 v207, v61, v57, s65
    v_perm_b32 v208, v38, v34, s64
    v_mfma_f32_16x16x32_bf16 a[120:123], v[216:219], a[184:187], a[120:123]
    v_perm_b32 v209, v46, v42, s64
    v_perm_b32 v210, v54, v50, s64
    v_perm_b32 v211, v62, v58, s64
    s_waitcnt lgkmcnt(2)
    s_add_u32 m0, s78, 19456
    v_lshl_add_u32 v107, v107, 8, v11
    buffer_load_dwordx4 v107, s[32:35], 0 offen lds
    v_mfma_f32_16x16x32_bf16 a[120:123], v[248:251], a[188:191], a[120:123]
    v_perm_b32 v240, v70, v66, s64
    v_perm_b32 v241, v78, v74, s64
    v_perm_b32 v242, v86, v82, s64
    v_mfma_f32_16x16x32_bf16 a[124:127], v[252:255], a[188:191], a[124:127]
    v_perm_b32 v243, v94, v90, s64
    v_perm_b32 v244, v70, v66, s65
    v_perm_b32 v245, v78, v74, s65
    ds_read_b32 v109, v97 offset:888
    v_mfma_f32_16x16x32_bf16 a[124:127], v[220:223], a[184:187], a[124:127]
    v_perm_b32 v246, v86, v82, s65
    v_perm_b32 v247, v94, v90, s65
    v_perm_b32 v212, v38, v34, s65
    v_mfma_f32_16x16x32_bf16 v[128:131], v[192:195], a[128:131], v[128:131]
    v_perm_b32 v213, v46, v42, s65
    v_perm_b32 v214, v54, v50, s65
    v_perm_b32 v215, v62, v58, s65
    s_waitcnt lgkmcnt(2)
    s_add_u32 m0, s78, 20480
    v_lshl_add_u32 v108, v108, 8, v10
    buffer_load_dwordx4 v108, s[32:35], 0 offen lds
    v_mfma_f32_16x16x32_bf16 v[128:131], v[224:227], a[132:135], v[128:131]
    v_perm_b32 v216, v39, v35, s64
    v_perm_b32 v217, v47, v43, s64
    v_perm_b32 v218, v55, v51, s64
    v_mfma_f32_16x16x32_bf16 v[132:135], v[228:231], a[132:135], v[132:135]
    v_perm_b32 v219, v63, v59, s64
    v_perm_b32 v248, v71, v67, s64
    v_perm_b32 v249, v79, v75, s64
    v_mfma_f32_16x16x32_bf16 v[132:135], v[196:199], a[128:131], v[132:135]
    v_perm_b32 v250, v87, v83, s64
    v_perm_b32 v251, v95, v91, s64
    v_perm_b32 v252, v71, v67, s65
    ds_read_b128 a[144:147], v12 offset:4096
    v_mfma_f32_16x16x32_bf16 v[136:139], v[200:203], a[128:131], v[136:139]
    v_perm_b32 v253, v79, v75, s65
    v_perm_b32 v254, v87, v83, s65
    v_perm_b32 v255, v95, v91, s65
    s_waitcnt lgkmcnt(1)
    s_add_u32 m0, s78, 21504
    v_lshl_add_u32 v109, v109, 8, v11
    buffer_load_dwordx4 v109, s[32:35], 0 offen lds
    v_mfma_f32_16x16x32_bf16 v[136:139], v[232:235], a[132:135], v[136:139]
    v_perm_b32 v220, v39, v35, s65
    v_perm_b32 v221, v47, v43, s65
    v_perm_b32 v222, v55, v51, s65
    v_mfma_f32_16x16x32_bf16 v[140:143], v[236:239], a[132:135], v[140:143]
    v_perm_b32 v223, v63, v59, s65
    v_mfma_f32_16x16x32_bf16 v[140:143], v[204:207], a[128:131], v[140:143]
    v_mfma_f32_16x16x32_bf16 v[144:147], v[208:211], a[128:131], v[144:147]
    v_add_u32 v7, 1490944, v7
    buffer_load_dwordx4 v[32:35], v7, s[36:39], s56 offen
    v_mfma_f32_16x16x32_bf16 v[144:147], v[240:243], a[132:135], v[144:147]
    v_mfma_f32_16x16x32_bf16 v[148:151], v[244:247], a[132:135], v[148:151]
    ds_read_b128 a[148:151], v13 offset:4096
    v_mfma_f32_16x16x32_bf16 v[148:151], v[212:215], a[128:131], v[148:151]
    v_mfma_f32_16x16x32_bf16 v[152:155], v[216:219], a[128:131], v[152:155]
    buffer_load_dwordx4 v[36:39], v7, s[36:39], s57 offen
    v_mfma_f32_16x16x32_bf16 v[152:155], v[248:251], a[132:135], v[152:155]
    v_mfma_f32_16x16x32_bf16 v[156:159], v[252:255], a[132:135], v[156:159]
    v_mfma_f32_16x16x32_bf16 v[156:159], v[220:223], a[128:131], v[156:159]
    v_mfma_f32_16x16x32_bf16 v[160:163], v[192:195], a[136:139], v[160:163]
    buffer_load_dwordx4 v[40:43], v7, s[36:39], s58 offen
    v_mfma_f32_16x16x32_bf16 v[160:163], v[224:227], a[140:143], v[160:163]
    v_mfma_f32_16x16x32_bf16 v[164:167], v[228:231], a[140:143], v[164:167]
    v_mfma_f32_16x16x32_bf16 v[164:167], v[196:199], a[136:139], v[164:167]
    s_waitcnt vmcnt(17)
    ds_read_b128 a[152:155], v12 offset:6144
    v_mfma_f32_16x16x32_bf16 v[168:171], v[200:203], a[136:139], v[168:171]
    buffer_load_dwordx4 v[44:47], v7, s[36:39], s59 offen
    v_mfma_f32_16x16x32_bf16 v[168:171], v[232:235], a[140:143], v[168:171]
    v_mfma_f32_16x16x32_bf16 v[172:175], v[236:239], a[140:143], v[172:175]
    v_mfma_f32_16x16x32_bf16 v[172:175], v[204:207], a[136:139], v[172:175]
    v_mfma_f32_16x16x32_bf16 v[176:179], v[208:211], a[136:139], v[176:179]
    buffer_load_dwordx4 v[48:51], v7, s[36:39], s60 offen
    v_mfma_f32_16x16x32_bf16 v[176:179], v[240:243], a[140:143], v[176:179]
    v_mfma_f32_16x16x32_bf16 v[180:183], v[244:247], a[140:143], v[180:183]
    ds_read_b128 a[156:159], v13 offset:6144
    v_mfma_f32_16x16x32_bf16 v[180:183], v[212:215], a[136:139], v[180:183]
    v_mfma_f32_16x16x32_bf16 v[184:187], v[216:219], a[136:139], v[184:187]
    buffer_load_dwordx4 v[52:55], v7, s[36:39], s61 offen
    v_mfma_f32_16x16x32_bf16 v[184:187], v[248:251], a[140:143], v[184:187]
    v_mfma_f32_16x16x32_bf16 v[188:191], v[252:255], a[140:143], v[188:191]
    v_mfma_f32_16x16x32_bf16 v[188:191], v[220:223], a[136:139], v[188:191]
    s_waitcnt lgkmcnt(3)
    v_mfma_f32_16x16x32_bf16 a[192:195], v[192:195], a[144:147], a[192:195]
    buffer_load_dwordx4 v[56:59], v7, s[36:39], s62 offen
    s_waitcnt lgkmcnt(2)
    v_mfma_f32_16x16x32_bf16 a[192:195], v[224:227], a[148:151], a[192:195]
    v_mfma_f32_16x16x32_bf16 a[196:199], v[228:231], a[148:151], a[196:199]
    v_mfma_f32_16x16x32_bf16 a[196:199], v[196:199], a[144:147], a[196:199]
    s_waitcnt vmcnt(19)
    ds_read_b128 a[160:163], v12 offset:8192
    v_mfma_f32_16x16x32_bf16 a[200:203], v[200:203], a[144:147], a[200:203]
    buffer_load_dwordx4 v[60:63], v7, s[36:39], s63 offen
    v_mfma_f32_16x16x32_bf16 a[200:203], v[232:235], a[148:151], a[200:203]
    v_mfma_f32_16x16x32_bf16 a[204:207], v[236:239], a[148:151], a[204:207]
    v_mfma_f32_16x16x32_bf16 a[204:207], v[204:207], a[144:147], a[204:207]
    v_mfma_f32_16x16x32_bf16 a[208:211], v[208:211], a[144:147], a[208:211]
    v_add_u32 v7, 212992, v7
    buffer_load_dwordx4 v[64:67], v7, s[36:39], s56 offen
    v_mfma_f32_16x16x32_bf16 a[208:211], v[240:243], a[148:151], a[208:211]
    v_mfma_f32_16x16x32_bf16 a[212:215], v[244:247], a[148:151], a[212:215]
    ds_read_b128 a[164:167], v13 offset:8192
    v_mfma_f32_16x16x32_bf16 a[212:215], v[212:215], a[144:147], a[212:215]
    v_mfma_f32_16x16x32_bf16 a[216:219], v[216:219], a[144:147], a[216:219]
    buffer_load_dwordx4 v[68:71], v7, s[36:39], s57 offen
    v_mfma_f32_16x16x32_bf16 a[216:219], v[248:251], a[148:151], a[216:219]
    v_mfma_f32_16x16x32_bf16 a[220:223], v[252:255], a[148:151], a[220:223]
    v_mfma_f32_16x16x32_bf16 a[220:223], v[220:223], a[144:147], a[220:223]
    s_waitcnt lgkmcnt(3)
    v_mfma_f32_16x16x32_bf16 a[224:227], v[192:195], a[152:155], a[224:227]
    buffer_load_dwordx4 v[72:75], v7, s[36:39], s58 offen
    s_waitcnt lgkmcnt(2)
    v_mfma_f32_16x16x32_bf16 a[224:227], v[224:227], a[156:159], a[224:227]
    v_mfma_f32_16x16x32_bf16 a[228:231], v[228:231], a[156:159], a[228:231]
    v_mfma_f32_16x16x32_bf16 a[228:231], v[196:199], a[152:155], a[228:231]
    s_waitcnt vmcnt(21)
    ds_read_b128 a[168:171], v12 offset:10240
    v_mfma_f32_16x16x32_bf16 a[232:235], v[200:203], a[152:155], a[232:235]
    buffer_load_dwordx4 v[76:79], v7, s[36:39], s59 offen
    v_mfma_f32_16x16x32_bf16 a[232:235], v[232:235], a[156:159], a[232:235]
    v_mfma_f32_16x16x32_bf16 a[236:239], v[236:239], a[156:159], a[236:239]
    v_mfma_f32_16x16x32_bf16 a[236:239], v[204:207], a[152:155], a[236:239]
    v_mfma_f32_16x16x32_bf16 a[240:243], v[208:211], a[152:155], a[240:243]
    buffer_load_dwordx4 v[80:83], v7, s[36:39], s60 offen
    v_mfma_f32_16x16x32_bf16 a[240:243], v[240:243], a[156:159], a[240:243]
    v_mfma_f32_16x16x32_bf16 a[244:247], v[244:247], a[156:159], a[244:247]
    ds_read_b128 a[172:175], v13 offset:10240
    v_mfma_f32_16x16x32_bf16 a[244:247], v[212:215], a[152:155], a[244:247]
    v_mfma_f32_16x16x32_bf16 a[248:251], v[216:219], a[152:155], a[248:251]
    buffer_load_dwordx4 v[84:87], v7, s[36:39], s61 offen
    v_mfma_f32_16x16x32_bf16 a[248:251], v[248:251], a[156:159], a[248:251]
    v_mfma_f32_16x16x32_bf16 a[252:255], v[252:255], a[156:159], a[252:255]
    v_mfma_f32_16x16x32_bf16 a[252:255], v[220:223], a[152:155], a[252:255]
    s_waitcnt lgkmcnt(3)
    v_mfma_f32_16x16x32_bf16 a[0:3], v[192:195], a[160:163], a[0:3]
    buffer_load_dwordx4 v[88:91], v7, s[36:39], s62 offen
    s_waitcnt lgkmcnt(2)
    v_mfma_f32_16x16x32_bf16 a[0:3], v[224:227], a[164:167], a[0:3]
    v_mfma_f32_16x16x32_bf16 a[4:7], v[228:231], a[164:167], a[4:7]
    ds_read_b32 v110, v97 offset:1720
    v_mfma_f32_16x16x32_bf16 a[4:7], v[196:199], a[160:163], a[4:7]
    s_waitcnt vmcnt(23)
    ds_read_b128 a[176:179], v12 offset:12288
    v_mfma_f32_16x16x32_bf16 a[8:11], v[200:203], a[160:163], a[8:11]
    buffer_load_dwordx4 v[92:95], v7, s[36:39], s63 offen
    v_mfma_f32_16x16x32_bf16 a[8:11], v[232:235], a[164:167], a[8:11]
    v_mfma_f32_16x16x32_bf16 a[12:15], v[236:239], a[164:167], a[12:15]
    ds_read_b32 v111, v97 offset:2552
    v_mfma_f32_16x16x32_bf16 a[12:15], v[204:207], a[160:163], a[12:15]
    v_mfma_f32_16x16x32_bf16 a[16:19], v[208:211], a[160:163], a[16:19]
    s_waitcnt lgkmcnt(2)
    s_add_u32 m0, s78, 22528
    v_lshl_add_u32 v110, v110, 8, v10
    buffer_load_dwordx4 v110, s[32:35], 0 offen lds
    v_mfma_f32_16x16x32_bf16 a[16:19], v[240:243], a[164:167], a[16:19]
    v_mfma_f32_16x16x32_bf16 a[20:23], v[244:247], a[164:167], a[20:23]
    ds_read_b32 v112, v98 offset:56
    ds_read_b128 a[180:183], v13 offset:12288
    v_mfma_f32_16x16x32_bf16 a[20:23], v[212:215], a[160:163], a[20:23]
    v_mfma_f32_16x16x32_bf16 a[24:27], v[216:219], a[160:163], a[24:27]
    s_waitcnt lgkmcnt(2)
    s_add_u32 m0, s78, 23552
    v_lshl_add_u32 v111, v111, 8, v11
    buffer_load_dwordx4 v111, s[32:35], 0 offen lds
    v_mfma_f32_16x16x32_bf16 a[24:27], v[248:251], a[164:167], a[24:27]
    v_mfma_f32_16x16x32_bf16 a[28:31], v[252:255], a[164:167], a[28:31]
    ds_read_b32 v113, v98 offset:888
    v_mfma_f32_16x16x32_bf16 a[28:31], v[220:223], a[160:163], a[28:31]
    v_mfma_f32_16x16x32_bf16 a[32:35], v[192:195], a[168:171], a[32:35]
    s_waitcnt lgkmcnt(2)
    s_add_u32 m0, s78, 24576
    v_lshl_add_u32 v112, v112, 8, v10
    buffer_load_dwordx4 v112, s[32:35], 0 offen lds
    v_mfma_f32_16x16x32_bf16 a[32:35], v[224:227], a[172:175], a[32:35]
    v_mfma_f32_16x16x32_bf16 a[36:39], v[228:231], a[172:175], a[36:39]
    ds_read_b32 v114, v98 offset:1720
    v_mfma_f32_16x16x32_bf16 a[36:39], v[196:199], a[168:171], a[36:39]
    s_waitcnt vmcnt(25)
    ds_read_b128 a[184:187], v12 offset:14336
    v_mfma_f32_16x16x32_bf16 a[40:43], v[200:203], a[168:171], a[40:43]
    s_waitcnt lgkmcnt(2)
    s_add_u32 m0, s78, 25600
    v_lshl_add_u32 v113, v113, 8, v11
    buffer_load_dwordx4 v113, s[32:35], 0 offen lds
    v_mfma_f32_16x16x32_bf16 a[40:43], v[232:235], a[172:175], a[40:43]
    v_mfma_f32_16x16x32_bf16 a[44:47], v[236:239], a[172:175], a[44:47]
    ds_read_b32 v115, v98 offset:2552
    v_mfma_f32_16x16x32_bf16 a[44:47], v[204:207], a[168:171], a[44:47]
    v_mfma_f32_16x16x32_bf16 a[48:51], v[208:211], a[168:171], a[48:51]
    s_waitcnt lgkmcnt(2)
    s_add_u32 m0, s78, 26624
    v_lshl_add_u32 v114, v114, 8, v10
    buffer_load_dwordx4 v114, s[32:35], 0 offen lds
    v_mfma_f32_16x16x32_bf16 a[48:51], v[240:243], a[172:175], a[48:51]
    v_mfma_f32_16x16x32_bf16 a[52:55], v[244:247], a[172:175], a[52:55]
    ds_read_b32 v116, v99 offset:56
    ds_read_b128 a[188:191], v13 offset:14336
    v_mfma_f32_16x16x32_bf16 a[52:55], v[212:215], a[168:171], a[52:55]
    v_mfma_f32_16x16x32_bf16 a[56:59], v[216:219], a[168:171], a[56:59]
    s_waitcnt lgkmcnt(2)
    s_add_u32 m0, s78, 27648
    v_lshl_add_u32 v115, v115, 8, v11
    buffer_load_dwordx4 v115, s[32:35], 0 offen lds
    v_mfma_f32_16x16x32_bf16 a[56:59], v[248:251], a[172:175], a[56:59]
    v_mfma_f32_16x16x32_bf16 a[60:63], v[252:255], a[172:175], a[60:63]
    ds_read_b32 v117, v99 offset:888
    v_mfma_f32_16x16x32_bf16 a[60:63], v[220:223], a[168:171], a[60:63]
    v_mfma_f32_16x16x32_bf16 a[64:67], v[192:195], a[176:179], a[64:67]
    s_waitcnt lgkmcnt(2)
    s_add_u32 m0, s78, 28672
    v_lshl_add_u32 v116, v116, 8, v10
    buffer_load_dwordx4 v116, s[32:35], 0 offen lds
    v_mfma_f32_16x16x32_bf16 a[64:67], v[224:227], a[180:183], a[64:67]
    v_mfma_f32_16x16x32_bf16 a[68:71], v[228:231], a[180:183], a[68:71]
    ds_read_b32 v118, v99 offset:1720
    v_mfma_f32_16x16x32_bf16 a[68:71], v[196:199], a[176:179], a[68:71]
    s_waitcnt vmcnt(27)
    ds_read_b128 a[128:131], v12 offset:16384
    v_mfma_f32_16x16x32_bf16 a[72:75], v[200:203], a[176:179], a[72:75]
    s_waitcnt lgkmcnt(2)
    s_add_u32 m0, s78, 29696
    v_lshl_add_u32 v117, v117, 8, v11
    buffer_load_dwordx4 v117, s[32:35], 0 offen lds
    v_mfma_f32_16x16x32_bf16 a[72:75], v[232:235], a[180:183], a[72:75]
    v_mfma_f32_16x16x32_bf16 a[76:79], v[236:239], a[180:183], a[76:79]
    ds_read_b32 v119, v99 offset:2552
    v_mfma_f32_16x16x32_bf16 a[76:79], v[204:207], a[176:179], a[76:79]
    v_mfma_f32_16x16x32_bf16 a[80:83], v[208:211], a[176:179], a[80:83]
    s_waitcnt lgkmcnt(2)
    s_add_u32 m0, s78, 30720
    v_lshl_add_u32 v118, v118, 8, v10
    buffer_load_dwordx4 v118, s[32:35], 0 offen lds
    v_mfma_f32_16x16x32_bf16 a[80:83], v[240:243], a[180:183], a[80:83]
    v_mfma_f32_16x16x32_bf16 a[84:87], v[244:247], a[180:183], a[84:87]
    ds_read_b32 v104, v96 offset:64
    ds_read_b128 a[132:135], v13 offset:16384
    v_mfma_f32_16x16x32_bf16 a[84:87], v[212:215], a[176:179], a[84:87]
    v_mfma_f32_16x16x32_bf16 a[88:91], v[216:219], a[176:179], a[88:91]
    s_waitcnt lgkmcnt(2)
    s_add_u32 m0, s78, 31744
    v_lshl_add_u32 v119, v119, 8, v11
    buffer_load_dwordx4 v119, s[32:35], 0 offen lds
    v_mfma_f32_16x16x32_bf16 a[88:91], v[248:251], a[180:183], a[88:91]
    v_mfma_f32_16x16x32_bf16 a[92:95], v[252:255], a[180:183], a[92:95]
    ds_read_b32 v105, v96 offset:896
    v_mfma_f32_16x16x32_bf16 a[92:95], v[220:223], a[176:179], a[92:95]
    v_mfma_f32_16x16x32_bf16 a[96:99], v[192:195], a[184:187], a[96:99]
    s_waitcnt lgkmcnt(2)
    s_add_u32 m0, s78, 0
    v_lshl_add_u32 v104, v104, 8, v10
    buffer_load_dwordx4 v104, s[32:35], 0 offen lds
    v_mfma_f32_16x16x32_bf16 a[96:99], v[224:227], a[188:191], a[96:99]
    s_waitcnt vmcnt(19)
    v_perm_b32 v192, v36, v32, s64
    v_perm_b32 v193, v44, v40, s64
    v_perm_b32 v194, v52, v48, s64
    v_mfma_f32_16x16x32_bf16 a[100:103], v[228:231], a[188:191], a[100:103]
    v_perm_b32 v195, v60, v56, s64
    s_waitcnt vmcnt(11)
    v_perm_b32 v224, v68, v64, s64
    v_perm_b32 v225, v76, v72, s64
    ds_read_b32 v106, v96 offset:1728
    v_mfma_f32_16x16x32_bf16 a[100:103], v[196:199], a[184:187], a[100:103]
    v_perm_b32 v226, v84, v80, s64
    v_perm_b32 v227, v92, v88, s64
    v_perm_b32 v228, v68, v64, s65
    ds_read_b128 a[136:139], v12 offset:18432
    v_mfma_f32_16x16x32_bf16 a[104:107], v[200:203], a[184:187], a[104:107]
    v_perm_b32 v229, v76, v72, s65
    v_perm_b32 v230, v84, v80, s65
    v_perm_b32 v231, v92, v88, s65
    s_waitcnt lgkmcnt(2)
    s_add_u32 m0, s78, 1024
    v_lshl_add_u32 v105, v105, 8, v11
    buffer_load_dwordx4 v105, s[32:35], 0 offen lds
    v_mfma_f32_16x16x32_bf16 a[104:107], v[232:235], a[188:191], a[104:107]
    v_perm_b32 v196, v36, v32, s65
    v_perm_b32 v197, v44, v40, s65
    v_perm_b32 v198, v52, v48, s65
    v_mfma_f32_16x16x32_bf16 a[108:111], v[236:239], a[188:191], a[108:111]
    v_perm_b32 v199, v60, v56, s65
    v_perm_b32 v200, v37, v33, s64
    v_perm_b32 v201, v45, v41, s64
    ds_read_b32 v107, v96 offset:2560
    v_mfma_f32_16x16x32_bf16 a[108:111], v[204:207], a[184:187], a[108:111]
    v_perm_b32 v202, v53, v49, s64
    v_perm_b32 v203, v61, v57, s64
    v_perm_b32 v232, v69, v65, s64
    v_mfma_f32_16x16x32_bf16 a[112:115], v[208:211], a[184:187], a[112:115]
    v_perm_b32 v233, v77, v73, s64
    v_perm_b32 v234, v85, v81, s64
    v_perm_b32 v235, v93, v89, s64
    s_waitcnt lgkmcnt(2)
    s_add_u32 m0, s78, 2048
    v_lshl_add_u32 v106, v106, 8, v10
    buffer_load_dwordx4 v106, s[32:35], 0 offen lds
    v_mfma_f32_16x16x32_bf16 a[112:115], v[240:243], a[188:191], a[112:115]
    v_perm_b32 v236, v69, v65, s65
    v_perm_b32 v237, v77, v73, s65
    v_perm_b32 v238, v85, v81, s65
    v_mfma_f32_16x16x32_bf16 a[116:119], v[244:247], a[188:191], a[116:119]
    v_perm_b32 v239, v93, v89, s65
    v_perm_b32 v204, v37, v33, s65
    v_perm_b32 v205, v45, v41, s65
    ds_read_b32 v108, v97 offset:64
    ds_read_b128 a[140:143], v13 offset:18432
    v_mfma_f32_16x16x32_bf16 a[116:119], v[212:215], a[184:187], a[116:119]
    v_perm_b32 v206, v53, v49, s65
    v_perm_b32 v207, v61, v57, s65
    v_perm_b32 v208, v38, v34, s64
    v_mfma_f32_16x16x32_bf16 a[120:123], v[216:219], a[184:187], a[120:123]
    v_perm_b32 v209, v46, v42, s64
    v_perm_b32 v210, v54, v50, s64
    v_perm_b32 v211, v62, v58, s64
    s_waitcnt lgkmcnt(2)
    s_add_u32 m0, s78, 3072
    v_lshl_add_u32 v107, v107, 8, v11
    buffer_load_dwordx4 v107, s[32:35], 0 offen lds
    v_mfma_f32_16x16x32_bf16 a[120:123], v[248:251], a[188:191], a[120:123]
    v_perm_b32 v240, v70, v66, s64
    v_perm_b32 v241, v78, v74, s64
    v_perm_b32 v242, v86, v82, s64
    v_mfma_f32_16x16x32_bf16 a[124:127], v[252:255], a[188:191], a[124:127]
    v_perm_b32 v243, v94, v90, s64
    v_perm_b32 v244, v70, v66, s65
    v_perm_b32 v245, v78, v74, s65
    ds_read_b32 v109, v97 offset:896
    v_mfma_f32_16x16x32_bf16 a[124:127], v[220:223], a[184:187], a[124:127]
    v_perm_b32 v246, v86, v82, s65
    v_perm_b32 v247, v94, v90, s65
    v_perm_b32 v212, v38, v34, s65
    v_mfma_f32_16x16x32_bf16 v[128:131], v[192:195], a[128:131], v[128:131]
    v_perm_b32 v213, v46, v42, s65
    v_perm_b32 v214, v54, v50, s65
    v_perm_b32 v215, v62, v58, s65
    s_waitcnt lgkmcnt(2)
    s_add_u32 m0, s78, 4096
    v_lshl_add_u32 v108, v108, 8, v10
    buffer_load_dwordx4 v108, s[32:35], 0 offen lds
    v_mfma_f32_16x16x32_bf16 v[128:131], v[224:227], a[132:135], v[128:131]
    v_perm_b32 v216, v39, v35, s64
    v_perm_b32 v217, v47, v43, s64
    v_perm_b32 v218, v55, v51, s64
    v_mfma_f32_16x16x32_bf16 v[132:135], v[228:231], a[132:135], v[132:135]
    v_perm_b32 v219, v63, v59, s64
    v_perm_b32 v248, v71, v67, s64
    v_perm_b32 v249, v79, v75, s64
    v_mfma_f32_16x16x32_bf16 v[132:135], v[196:199], a[128:131], v[132:135]
    v_perm_b32 v250, v87, v83, s64
    v_perm_b32 v251, v95, v91, s64
    v_perm_b32 v252, v71, v67, s65
    ds_read_b128 a[144:147], v12 offset:20480
    v_mfma_f32_16x16x32_bf16 v[136:139], v[200:203], a[128:131], v[136:139]
    v_perm_b32 v253, v79, v75, s65
    v_perm_b32 v254, v87, v83, s65
    v_perm_b32 v255, v95, v91, s65
    s_waitcnt lgkmcnt(1)
    s_add_u32 m0, s78, 5120
    v_lshl_add_u32 v109, v109, 8, v11
    buffer_load_dwordx4 v109, s[32:35], 0 offen lds
    v_mfma_f32_16x16x32_bf16 v[136:139], v[232:235], a[132:135], v[136:139]
    v_perm_b32 v220, v39, v35, s65
    v_perm_b32 v221, v47, v43, s65
    v_perm_b32 v222, v55, v51, s65
    v_mfma_f32_16x16x32_bf16 v[140:143], v[236:239], a[132:135], v[140:143]
    v_perm_b32 v223, v63, v59, s65
    v_mfma_f32_16x16x32_bf16 v[140:143], v[204:207], a[128:131], v[140:143]
    v_mfma_f32_16x16x32_bf16 v[144:147], v[208:211], a[128:131], v[144:147]
    v_add_u32 v7, 1490944, v7
    buffer_load_dwordx4 v[32:35], v7, s[36:39], s56 offen
    v_mfma_f32_16x16x32_bf16 v[144:147], v[240:243], a[132:135], v[144:147]
    v_mfma_f32_16x16x32_bf16 v[148:151], v[244:247], a[132:135], v[148:151]
    ds_read_b128 a[148:151], v13 offset:20480
    v_mfma_f32_16x16x32_bf16 v[148:151], v[212:215], a[128:131], v[148:151]
    v_mfma_f32_16x16x32_bf16 v[152:155], v[216:219], a[128:131], v[152:155]
    buffer_load_dwordx4 v[36:39], v7, s[36:39], s57 offen
    v_mfma_f32_16x16x32_bf16 v[152:155], v[248:251], a[132:135], v[152:155]
    v_mfma_f32_16x16x32_bf16 v[156:159], v[252:255], a[132:135], v[156:159]
    v_mfma_f32_16x16x32_bf16 v[156:159], v[220:223], a[128:131], v[156:159]
    v_mfma_f32_16x16x32_bf16 v[160:163], v[192:195], a[136:139], v[160:163]
    buffer_load_dwordx4 v[40:43], v7, s[36:39], s58 offen
    v_mfma_f32_16x16x32_bf16 v[160:163], v[224:227], a[140:143], v[160:163]
    v_mfma_f32_16x16x32_bf16 v[164:167], v[228:231], a[140:143], v[164:167]
    v_mfma_f32_16x16x32_bf16 v[164:167], v[196:199], a[136:139], v[164:167]
    s_waitcnt vmcnt(17)
    ds_read_b128 a[152:155], v12 offset:22528
    v_mfma_f32_16x16x32_bf16 v[168:171], v[200:203], a[136:139], v[168:171]
    buffer_load_dwordx4 v[44:47], v7, s[36:39], s59 offen
    v_mfma_f32_16x16x32_bf16 v[168:171], v[232:235], a[140:143], v[168:171]
    v_mfma_f32_16x16x32_bf16 v[172:175], v[236:239], a[140:143], v[172:175]
    v_mfma_f32_16x16x32_bf16 v[172:175], v[204:207], a[136:139], v[172:175]
    v_mfma_f32_16x16x32_bf16 v[176:179], v[208:211], a[136:139], v[176:179]
    buffer_load_dwordx4 v[48:51], v7, s[36:39], s60 offen
    v_mfma_f32_16x16x32_bf16 v[176:179], v[240:243], a[140:143], v[176:179]
    v_mfma_f32_16x16x32_bf16 v[180:183], v[244:247], a[140:143], v[180:183]
    ds_read_b128 a[156:159], v13 offset:22528
    v_mfma_f32_16x16x32_bf16 v[180:183], v[212:215], a[136:139], v[180:183]
    v_mfma_f32_16x16x32_bf16 v[184:187], v[216:219], a[136:139], v[184:187]
    buffer_load_dwordx4 v[52:55], v7, s[36:39], s61 offen
    v_mfma_f32_16x16x32_bf16 v[184:187], v[248:251], a[140:143], v[184:187]
    v_mfma_f32_16x16x32_bf16 v[188:191], v[252:255], a[140:143], v[188:191]
    v_mfma_f32_16x16x32_bf16 v[188:191], v[220:223], a[136:139], v[188:191]
    s_waitcnt lgkmcnt(3)
    v_mfma_f32_16x16x32_bf16 a[192:195], v[192:195], a[144:147], a[192:195]
    buffer_load_dwordx4 v[56:59], v7, s[36:39], s62 offen
    s_waitcnt lgkmcnt(2)
    v_mfma_f32_16x16x32_bf16 a[192:195], v[224:227], a[148:151], a[192:195]
    v_mfma_f32_16x16x32_bf16 a[196:199], v[228:231], a[148:151], a[196:199]
    v_mfma_f32_16x16x32_bf16 a[196:199], v[196:199], a[144:147], a[196:199]
    s_waitcnt vmcnt(19)
    ds_read_b128 a[160:163], v12 offset:24576
    v_mfma_f32_16x16x32_bf16 a[200:203], v[200:203], a[144:147], a[200:203]
    buffer_load_dwordx4 v[60:63], v7, s[36:39], s63 offen
    v_mfma_f32_16x16x32_bf16 a[200:203], v[232:235], a[148:151], a[200:203]
    v_mfma_f32_16x16x32_bf16 a[204:207], v[236:239], a[148:151], a[204:207]
    v_mfma_f32_16x16x32_bf16 a[204:207], v[204:207], a[144:147], a[204:207]
    v_mfma_f32_16x16x32_bf16 a[208:211], v[208:211], a[144:147], a[208:211]
    v_add_u32 v7, 212992, v7
    buffer_load_dwordx4 v[64:67], v7, s[36:39], s56 offen
    v_mfma_f32_16x16x32_bf16 a[208:211], v[240:243], a[148:151], a[208:211]
    v_mfma_f32_16x16x32_bf16 a[212:215], v[244:247], a[148:151], a[212:215]
    ds_read_b128 a[164:167], v13 offset:24576
    v_mfma_f32_16x16x32_bf16 a[212:215], v[212:215], a[144:147], a[212:215]
    v_mfma_f32_16x16x32_bf16 a[216:219], v[216:219], a[144:147], a[216:219]
    buffer_load_dwordx4 v[68:71], v7, s[36:39], s57 offen
    v_mfma_f32_16x16x32_bf16 a[216:219], v[248:251], a[148:151], a[216:219]
    v_mfma_f32_16x16x32_bf16 a[220:223], v[252:255], a[148:151], a[220:223]
    v_mfma_f32_16x16x32_bf16 a[220:223], v[220:223], a[144:147], a[220:223]
    s_waitcnt lgkmcnt(3)
    v_mfma_f32_16x16x32_bf16 a[224:227], v[192:195], a[152:155], a[224:227]
    buffer_load_dwordx4 v[72:75], v7, s[36:39], s58 offen
    s_waitcnt lgkmcnt(2)
    v_mfma_f32_16x16x32_bf16 a[224:227], v[224:227], a[156:159], a[224:227]
    v_mfma_f32_16x16x32_bf16 a[228:231], v[228:231], a[156:159], a[228:231]
    v_mfma_f32_16x16x32_bf16 a[228:231], v[196:199], a[152:155], a[228:231]
    s_waitcnt vmcnt(21)
    ds_read_b128 a[168:171], v12 offset:26624
    v_mfma_f32_16x16x32_bf16 a[232:235], v[200:203], a[152:155], a[232:235]
    buffer_load_dwordx4 v[76:79], v7, s[36:39], s59 offen
    v_mfma_f32_16x16x32_bf16 a[232:235], v[232:235], a[156:159], a[232:235]
    v_mfma_f32_16x16x32_bf16 a[236:239], v[236:239], a[156:159], a[236:239]
    v_mfma_f32_16x16x32_bf16 a[236:239], v[204:207], a[152:155], a[236:239]
    v_mfma_f32_16x16x32_bf16 a[240:243], v[208:211], a[152:155], a[240:243]
    buffer_load_dwordx4 v[80:83], v7, s[36:39], s60 offen
    v_mfma_f32_16x16x32_bf16 a[240:243], v[240:243], a[156:159], a[240:243]
    v_mfma_f32_16x16x32_bf16 a[244:247], v[244:247], a[156:159], a[244:247]
    ds_read_b128 a[172:175], v13 offset:26624
    v_mfma_f32_16x16x32_bf16 a[244:247], v[212:215], a[152:155], a[244:247]
    v_mfma_f32_16x16x32_bf16 a[248:251], v[216:219], a[152:155], a[248:251]
    buffer_load_dwordx4 v[84:87], v7, s[36:39], s61 offen
    v_mfma_f32_16x16x32_bf16 a[248:251], v[248:251], a[156:159], a[248:251]
    v_mfma_f32_16x16x32_bf16 a[252:255], v[252:255], a[156:159], a[252:255]
    v_mfma_f32_16x16x32_bf16 a[252:255], v[220:223], a[152:155], a[252:255]
    s_waitcnt lgkmcnt(3)
    v_mfma_f32_16x16x32_bf16 a[0:3], v[192:195], a[160:163], a[0:3]
    buffer_load_dwordx4 v[88:91], v7, s[36:39], s62 offen
    s_waitcnt lgkmcnt(2)
    v_mfma_f32_16x16x32_bf16 a[0:3], v[224:227], a[164:167], a[0:3]
    v_mfma_f32_16x16x32_bf16 a[4:7], v[228:231], a[164:167], a[4:7]
    ds_read_b32 v110, v97 offset:1728
    v_mfma_f32_16x16x32_bf16 a[4:7], v[196:199], a[160:163], a[4:7]
    s_waitcnt vmcnt(23)
    ds_read_b128 a[176:179], v12 offset:28672
    v_mfma_f32_16x16x32_bf16 a[8:11], v[200:203], a[160:163], a[8:11]
    buffer_load_dwordx4 v[92:95], v7, s[36:39], s63 offen
    v_mfma_f32_16x16x32_bf16 a[8:11], v[232:235], a[164:167], a[8:11]
    v_mfma_f32_16x16x32_bf16 a[12:15], v[236:239], a[164:167], a[12:15]
    ds_read_b32 v111, v97 offset:2560
    v_mfma_f32_16x16x32_bf16 a[12:15], v[204:207], a[160:163], a[12:15]
    v_mfma_f32_16x16x32_bf16 a[16:19], v[208:211], a[160:163], a[16:19]
    s_waitcnt lgkmcnt(2)
    s_add_u32 m0, s78, 6144
    v_lshl_add_u32 v110, v110, 8, v10
    buffer_load_dwordx4 v110, s[32:35], 0 offen lds
    v_mfma_f32_16x16x32_bf16 a[16:19], v[240:243], a[164:167], a[16:19]
    v_mfma_f32_16x16x32_bf16 a[20:23], v[244:247], a[164:167], a[20:23]
    ds_read_b32 v112, v98 offset:64
    ds_read_b128 a[180:183], v13 offset:28672
    v_mfma_f32_16x16x32_bf16 a[20:23], v[212:215], a[160:163], a[20:23]
    v_mfma_f32_16x16x32_bf16 a[24:27], v[216:219], a[160:163], a[24:27]
    s_waitcnt lgkmcnt(2)
    s_add_u32 m0, s78, 7168
    v_lshl_add_u32 v111, v111, 8, v11
    buffer_load_dwordx4 v111, s[32:35], 0 offen lds
    v_mfma_f32_16x16x32_bf16 a[24:27], v[248:251], a[164:167], a[24:27]
    v_mfma_f32_16x16x32_bf16 a[28:31], v[252:255], a[164:167], a[28:31]
    ds_read_b32 v113, v98 offset:896
    v_mfma_f32_16x16x32_bf16 a[28:31], v[220:223], a[160:163], a[28:31]
    v_mfma_f32_16x16x32_bf16 a[32:35], v[192:195], a[168:171], a[32:35]
    s_waitcnt lgkmcnt(2)
    s_add_u32 m0, s78, 8192
    v_lshl_add_u32 v112, v112, 8, v10
    buffer_load_dwordx4 v112, s[32:35], 0 offen lds
    v_mfma_f32_16x16x32_bf16 a[32:35], v[224:227], a[172:175], a[32:35]
    v_mfma_f32_16x16x32_bf16 a[36:39], v[228:231], a[172:175], a[36:39]
    ds_read_b32 v114, v98 offset:1728
    v_mfma_f32_16x16x32_bf16 a[36:39], v[196:199], a[168:171], a[36:39]
    s_waitcnt vmcnt(25)
    ds_read_b128 a[184:187], v12 offset:30720
    v_mfma_f32_16x16x32_bf16 a[40:43], v[200:203], a[168:171], a[40:43]
    s_waitcnt lgkmcnt(2)
    s_add_u32 m0, s78, 9216
    v_lshl_add_u32 v113, v113, 8, v11
    buffer_load_dwordx4 v113, s[32:35], 0 offen lds
    v_mfma_f32_16x16x32_bf16 a[40:43], v[232:235], a[172:175], a[40:43]
    v_mfma_f32_16x16x32_bf16 a[44:47], v[236:239], a[172:175], a[44:47]
    ds_read_b32 v115, v98 offset:2560
    v_mfma_f32_16x16x32_bf16 a[44:47], v[204:207], a[168:171], a[44:47]
    v_mfma_f32_16x16x32_bf16 a[48:51], v[208:211], a[168:171], a[48:51]
    s_waitcnt lgkmcnt(2)
    s_add_u32 m0, s78, 10240
    v_lshl_add_u32 v114, v114, 8, v10
    buffer_load_dwordx4 v114, s[32:35], 0 offen lds
    v_mfma_f32_16x16x32_bf16 a[48:51], v[240:243], a[172:175], a[48:51]
    v_mfma_f32_16x16x32_bf16 a[52:55], v[244:247], a[172:175], a[52:55]
    ds_read_b32 v116, v99 offset:64
    ds_read_b128 a[188:191], v13 offset:30720
    v_mfma_f32_16x16x32_bf16 a[52:55], v[212:215], a[168:171], a[52:55]
    v_mfma_f32_16x16x32_bf16 a[56:59], v[216:219], a[168:171], a[56:59]
    s_waitcnt lgkmcnt(2)
    s_add_u32 m0, s78, 11264
    v_lshl_add_u32 v115, v115, 8, v11
    buffer_load_dwordx4 v115, s[32:35], 0 offen lds
    v_mfma_f32_16x16x32_bf16 a[56:59], v[248:251], a[172:175], a[56:59]
    v_mfma_f32_16x16x32_bf16 a[60:63], v[252:255], a[172:175], a[60:63]
    ds_read_b32 v117, v99 offset:896
    v_mfma_f32_16x16x32_bf16 a[60:63], v[220:223], a[168:171], a[60:63]
    v_mfma_f32_16x16x32_bf16 a[64:67], v[192:195], a[176:179], a[64:67]
    s_waitcnt lgkmcnt(2)
    s_add_u32 m0, s78, 12288
    v_lshl_add_u32 v116, v116, 8, v10
    buffer_load_dwordx4 v116, s[32:35], 0 offen lds
    v_mfma_f32_16x16x32_bf16 a[64:67], v[224:227], a[180:183], a[64:67]
    v_mfma_f32_16x16x32_bf16 a[68:71], v[228:231], a[180:183], a[68:71]
    ds_read_b32 v118, v99 offset:1728
    v_mfma_f32_16x16x32_bf16 a[68:71], v[196:199], a[176:179], a[68:71]
    s_waitcnt vmcnt(27)
    ds_read_b128 a[128:131], v12 offset:0
    v_mfma_f32_16x16x32_bf16 a[72:75], v[200:203], a[176:179], a[72:75]
    s_waitcnt lgkmcnt(2)
    s_add_u32 m0, s78, 13312
    v_lshl_add_u32 v117, v117, 8, v11
    buffer_load_dwordx4 v117, s[32:35], 0 offen lds
    v_mfma_f32_16x16x32_bf16 a[72:75], v[232:235], a[180:183], a[72:75]
    v_mfma_f32_16x16x32_bf16 a[76:79], v[236:239], a[180:183], a[76:79]
    ds_read_b32 v119, v99 offset:2560
    v_mfma_f32_16x16x32_bf16 a[76:79], v[204:207], a[176:179], a[76:79]
    v_mfma_f32_16x16x32_bf16 a[80:83], v[208:211], a[176:179], a[80:83]
    s_waitcnt lgkmcnt(2)
    s_add_u32 m0, s78, 14336
    v_lshl_add_u32 v118, v118, 8, v10
    buffer_load_dwordx4 v118, s[32:35], 0 offen lds
    v_mfma_f32_16x16x32_bf16 a[80:83], v[240:243], a[180:183], a[80:83]
    v_mfma_f32_16x16x32_bf16 a[84:87], v[244:247], a[180:183], a[84:87]
    ds_read_b32 v104, v96 offset:72
    ds_read_b128 a[132:135], v13 offset:0
    v_mfma_f32_16x16x32_bf16 a[84:87], v[212:215], a[176:179], a[84:87]
    v_mfma_f32_16x16x32_bf16 a[88:91], v[216:219], a[176:179], a[88:91]
    s_waitcnt lgkmcnt(2)
    s_add_u32 m0, s78, 15360
    v_lshl_add_u32 v119, v119, 8, v11
    buffer_load_dwordx4 v119, s[32:35], 0 offen lds
    v_mfma_f32_16x16x32_bf16 a[88:91], v[248:251], a[180:183], a[88:91]
    v_mfma_f32_16x16x32_bf16 a[92:95], v[252:255], a[180:183], a[92:95]
    ds_read_b32 v105, v96 offset:904
    v_mfma_f32_16x16x32_bf16 a[92:95], v[220:223], a[176:179], a[92:95]
    v_mfma_f32_16x16x32_bf16 a[96:99], v[192:195], a[184:187], a[96:99]
    s_waitcnt lgkmcnt(2)
    s_add_u32 m0, s78, 16384
    v_lshl_add_u32 v104, v104, 8, v10
    buffer_load_dwordx4 v104, s[32:35], 0 offen lds
    v_mfma_f32_16x16x32_bf16 a[96:99], v[224:227], a[188:191], a[96:99]
    s_waitcnt vmcnt(19)
    v_perm_b32 v192, v36, v32, s64
    v_perm_b32 v193, v44, v40, s64
    v_perm_b32 v194, v52, v48, s64
    v_mfma_f32_16x16x32_bf16 a[100:103], v[228:231], a[188:191], a[100:103]
    v_perm_b32 v195, v60, v56, s64
    s_waitcnt vmcnt(11)
    v_perm_b32 v224, v68, v64, s64
    v_perm_b32 v225, v76, v72, s64
    ds_read_b32 v106, v96 offset:1736
    v_mfma_f32_16x16x32_bf16 a[100:103], v[196:199], a[184:187], a[100:103]
    v_perm_b32 v226, v84, v80, s64
    v_perm_b32 v227, v92, v88, s64
    v_perm_b32 v228, v68, v64, s65
    ds_read_b128 a[136:139], v12 offset:2048
    v_mfma_f32_16x16x32_bf16 a[104:107], v[200:203], a[184:187], a[104:107]
    v_perm_b32 v229, v76, v72, s65
    v_perm_b32 v230, v84, v80, s65
    v_perm_b32 v231, v92, v88, s65
    s_waitcnt lgkmcnt(2)
    s_add_u32 m0, s78, 17408
    v_lshl_add_u32 v105, v105, 8, v11
    buffer_load_dwordx4 v105, s[32:35], 0 offen lds
    v_mfma_f32_16x16x32_bf16 a[104:107], v[232:235], a[188:191], a[104:107]
    v_perm_b32 v196, v36, v32, s65
    v_perm_b32 v197, v44, v40, s65
    v_perm_b32 v198, v52, v48, s65
    v_mfma_f32_16x16x32_bf16 a[108:111], v[236:239], a[188:191], a[108:111]
    v_perm_b32 v199, v60, v56, s65
    v_perm_b32 v200, v37, v33, s64
    v_perm_b32 v201, v45, v41, s64
    ds_read_b32 v107, v96 offset:2568
    v_mfma_f32_16x16x32_bf16 a[108:111], v[204:207], a[184:187], a[108:111]
    v_perm_b32 v202, v53, v49, s64
    v_perm_b32 v203, v61, v57, s64
    v_perm_b32 v232, v69, v65, s64
    v_mfma_f32_16x16x32_bf16 a[112:115], v[208:211], a[184:187], a[112:115]
    v_perm_b32 v233, v77, v73, s64
    v_perm_b32 v234, v85, v81, s64
    v_perm_b32 v235, v93, v89, s64
    s_waitcnt lgkmcnt(2)
    s_add_u32 m0, s78, 18432
    v_lshl_add_u32 v106, v106, 8, v10
    buffer_load_dwordx4 v106, s[32:35], 0 offen lds
    v_mfma_f32_16x16x32_bf16 a[112:115], v[240:243], a[188:191], a[112:115]
    v_perm_b32 v236, v69, v65, s65
    v_perm_b32 v237, v77, v73, s65
    v_perm_b32 v238, v85, v81, s65
    v_mfma_f32_16x16x32_bf16 a[116:119], v[244:247], a[188:191], a[116:119]
    v_perm_b32 v239, v93, v89, s65
    v_perm_b32 v204, v37, v33, s65
    v_perm_b32 v205, v45, v41, s65
    ds_read_b32 v108, v97 offset:72
    ds_read_b128 a[140:143], v13 offset:2048
    v_mfma_f32_16x16x32_bf16 a[116:119], v[212:215], a[184:187], a[116:119]
    v_perm_b32 v206, v53, v49, s65
    v_perm_b32 v207, v61, v57, s65
    v_perm_b32 v208, v38, v34, s64
    v_mfma_f32_16x16x32_bf16 a[120:123], v[216:219], a[184:187], a[120:123]
    v_perm_b32 v209, v46, v42, s64
    v_perm_b32 v210, v54, v50, s64
    v_perm_b32 v211, v62, v58, s64
    s_waitcnt lgkmcnt(2)
    s_add_u32 m0, s78, 19456
    v_lshl_add_u32 v107, v107, 8, v11
    buffer_load_dwordx4 v107, s[32:35], 0 offen lds
    v_mfma_f32_16x16x32_bf16 a[120:123], v[248:251], a[188:191], a[120:123]
    v_perm_b32 v240, v70, v66, s64
    v_perm_b32 v241, v78, v74, s64
    v_perm_b32 v242, v86, v82, s64
    v_mfma_f32_16x16x32_bf16 a[124:127], v[252:255], a[188:191], a[124:127]
    v_perm_b32 v243, v94, v90, s64
    v_perm_b32 v244, v70, v66, s65
    v_perm_b32 v245, v78, v74, s65
    ds_read_b32 v109, v97 offset:904
    v_mfma_f32_16x16x32_bf16 a[124:127], v[220:223], a[184:187], a[124:127]
    v_perm_b32 v246, v86, v82, s65
    v_perm_b32 v247, v94, v90, s65
    v_perm_b32 v212, v38, v34, s65
    v_mfma_f32_16x16x32_bf16 v[128:131], v[192:195], a[128:131], v[128:131]
    v_perm_b32 v213, v46, v42, s65
    v_perm_b32 v214, v54, v50, s65
    v_perm_b32 v215, v62, v58, s65
    s_waitcnt lgkmcnt(2)
    s_add_u32 m0, s78, 20480
    v_lshl_add_u32 v108, v108, 8, v10
    buffer_load_dwordx4 v108, s[32:35], 0 offen lds
    v_mfma_f32_16x16x32_bf16 v[128:131], v[224:227], a[132:135], v[128:131]
    v_perm_b32 v216, v39, v35, s64
    v_perm_b32 v217, v47, v43, s64
    v_perm_b32 v218, v55, v51, s64
    v_mfma_f32_16x16x32_bf16 v[132:135], v[228:231], a[132:135], v[132:135]
    v_perm_b32 v219, v63, v59, s64
    v_perm_b32 v248, v71, v67, s64
    v_perm_b32 v249, v79, v75, s64
    v_mfma_f32_16x16x32_bf16 v[132:135], v[196:199], a[128:131], v[132:135]
    v_perm_b32 v250, v87, v83, s64
    v_perm_b32 v251, v95, v91, s64
    v_perm_b32 v252, v71, v67, s65
    ds_read_b128 a[144:147], v12 offset:4096
    v_mfma_f32_16x16x32_bf16 v[136:139], v[200:203], a[128:131], v[136:139]
    v_perm_b32 v253, v79, v75, s65
    v_perm_b32 v254, v87, v83, s65
    v_perm_b32 v255, v95, v91, s65
    s_waitcnt lgkmcnt(1)
    s_add_u32 m0, s78, 21504
    v_lshl_add_u32 v109, v109, 8, v11
    buffer_load_dwordx4 v109, s[32:35], 0 offen lds
    v_mfma_f32_16x16x32_bf16 v[136:139], v[232:235], a[132:135], v[136:139]
    v_perm_b32 v220, v39, v35, s65
    v_perm_b32 v221, v47, v43, s65
    v_perm_b32 v222, v55, v51, s65
    v_mfma_f32_16x16x32_bf16 v[140:143], v[236:239], a[132:135], v[140:143]
    v_perm_b32 v223, v63, v59, s65
    v_mfma_f32_16x16x32_bf16 v[140:143], v[204:207], a[128:131], v[140:143]
    v_mfma_f32_16x16x32_bf16 v[144:147], v[208:211], a[128:131], v[144:147]
    v_add_u32 v7, 1490944, v7
    buffer_load_dwordx4 v[32:35], v7, s[36:39], s56 offen
    v_mfma_f32_16x16x32_bf16 v[144:147], v[240:243], a[132:135], v[144:147]
    v_mfma_f32_16x16x32_bf16 v[148:151], v[244:247], a[132:135], v[148:151]
    ds_read_b128 a[148:151], v13 offset:4096
    v_mfma_f32_16x16x32_bf16 v[148:151], v[212:215], a[128:131], v[148:151]
    v_mfma_f32_16x16x32_bf16 v[152:155], v[216:219], a[128:131], v[152:155]
    buffer_load_dwordx4 v[36:39], v7, s[36:39], s57 offen
    v_mfma_f32_16x16x32_bf16 v[152:155], v[248:251], a[132:135], v[152:155]
    v_mfma_f32_16x16x32_bf16 v[156:159], v[252:255], a[132:135], v[156:159]
    v_mfma_f32_16x16x32_bf16 v[156:159], v[220:223], a[128:131], v[156:159]
    v_mfma_f32_16x16x32_bf16 v[160:163], v[192:195], a[136:139], v[160:163]
    buffer_load_dwordx4 v[40:43], v7, s[36:39], s58 offen
    v_mfma_f32_16x16x32_bf16 v[160:163], v[224:227], a[140:143], v[160:163]
    v_mfma_f32_16x16x32_bf16 v[164:167], v[228:231], a[140:143], v[164:167]
    v_mfma_f32_16x16x32_bf16 v[164:167], v[196:199], a[136:139], v[164:167]
    s_waitcnt vmcnt(17)
    ds_read_b128 a[152:155], v12 offset:6144
    v_mfma_f32_16x16x32_bf16 v[168:171], v[200:203], a[136:139], v[168:171]
    buffer_load_dwordx4 v[44:47], v7, s[36:39], s59 offen
    v_mfma_f32_16x16x32_bf16 v[168:171], v[232:235], a[140:143], v[168:171]
    v_mfma_f32_16x16x32_bf16 v[172:175], v[236:239], a[140:143], v[172:175]
    v_mfma_f32_16x16x32_bf16 v[172:175], v[204:207], a[136:139], v[172:175]
    v_mfma_f32_16x16x32_bf16 v[176:179], v[208:211], a[136:139], v[176:179]
    buffer_load_dwordx4 v[48:51], v7, s[36:39], s60 offen
    v_mfma_f32_16x16x32_bf16 v[176:179], v[240:243], a[140:143], v[176:179]
    v_mfma_f32_16x16x32_bf16 v[180:183], v[244:247], a[140:143], v[180:183]
    ds_read_b128 a[156:159], v13 offset:6144
    v_mfma_f32_16x16x32_bf16 v[180:183], v[212:215], a[136:139], v[180:183]
    v_mfma_f32_16x16x32_bf16 v[184:187], v[216:219], a[136:139], v[184:187]
    buffer_load_dwordx4 v[52:55], v7, s[36:39], s61 offen
    v_mfma_f32_16x16x32_bf16 v[184:187], v[248:251], a[140:143], v[184:187]
    v_mfma_f32_16x16x32_bf16 v[188:191], v[252:255], a[140:143], v[188:191]
    v_mfma_f32_16x16x32_bf16 v[188:191], v[220:223], a[136:139], v[188:191]
    s_waitcnt lgkmcnt(3)
    v_mfma_f32_16x16x32_bf16 a[192:195], v[192:195], a[144:147], a[192:195]
    buffer_load_dwordx4 v[56:59], v7, s[36:39], s62 offen
    s_waitcnt lgkmcnt(2)
    v_mfma_f32_16x16x32_bf16 a[192:195], v[224:227], a[148:151], a[192:195]
    v_mfma_f32_16x16x32_bf16 a[196:199], v[228:231], a[148:151], a[196:199]
    v_mfma_f32_16x16x32_bf16 a[196:199], v[196:199], a[144:147], a[196:199]
    s_waitcnt vmcnt(19)
    ds_read_b128 a[160:163], v12 offset:8192
    v_mfma_f32_16x16x32_bf16 a[200:203], v[200:203], a[144:147], a[200:203]
    buffer_load_dwordx4 v[60:63], v7, s[36:39], s63 offen
    v_mfma_f32_16x16x32_bf16 a[200:203], v[232:235], a[148:151], a[200:203]
    v_mfma_f32_16x16x32_bf16 a[204:207], v[236:239], a[148:151], a[204:207]
    v_mfma_f32_16x16x32_bf16 a[204:207], v[204:207], a[144:147], a[204:207]
    v_mfma_f32_16x16x32_bf16 a[208:211], v[208:211], a[144:147], a[208:211]
    v_add_u32 v7, 212992, v7
    buffer_load_dwordx4 v[64:67], v7, s[36:39], s56 offen
    v_mfma_f32_16x16x32_bf16 a[208:211], v[240:243], a[148:151], a[208:211]
    v_mfma_f32_16x16x32_bf16 a[212:215], v[244:247], a[148:151], a[212:215]
    ds_read_b128 a[164:167], v13 offset:8192
    v_mfma_f32_16x16x32_bf16 a[212:215], v[212:215], a[144:147], a[212:215]
    v_mfma_f32_16x16x32_bf16 a[216:219], v[216:219], a[144:147], a[216:219]
    buffer_load_dwordx4 v[68:71], v7, s[36:39], s57 offen
    v_mfma_f32_16x16x32_bf16 a[216:219], v[248:251], a[148:151], a[216:219]
    v_mfma_f32_16x16x32_bf16 a[220:223], v[252:255], a[148:151], a[220:223]
    v_mfma_f32_16x16x32_bf16 a[220:223], v[220:223], a[144:147], a[220:223]
    s_waitcnt lgkmcnt(3)
    v_mfma_f32_16x16x32_bf16 a[224:227], v[192:195], a[152:155], a[224:227]
    buffer_load_dwordx4 v[72:75], v7, s[36:39], s58 offen
    s_waitcnt lgkmcnt(2)
    v_mfma_f32_16x16x32_bf16 a[224:227], v[224:227], a[156:159], a[224:227]
    v_mfma_f32_16x16x32_bf16 a[228:231], v[228:231], a[156:159], a[228:231]
    v_mfma_f32_16x16x32_bf16 a[228:231], v[196:199], a[152:155], a[228:231]
    s_waitcnt vmcnt(21)
    ds_read_b128 a[168:171], v12 offset:10240
    v_mfma_f32_16x16x32_bf16 a[232:235], v[200:203], a[152:155], a[232:235]
    buffer_load_dwordx4 v[76:79], v7, s[36:39], s59 offen
    v_mfma_f32_16x16x32_bf16 a[232:235], v[232:235], a[156:159], a[232:235]
    v_mfma_f32_16x16x32_bf16 a[236:239], v[236:239], a[156:159], a[236:239]
    v_mfma_f32_16x16x32_bf16 a[236:239], v[204:207], a[152:155], a[236:239]
    v_mfma_f32_16x16x32_bf16 a[240:243], v[208:211], a[152:155], a[240:243]
    buffer_load_dwordx4 v[80:83], v7, s[36:39], s60 offen
    v_mfma_f32_16x16x32_bf16 a[240:243], v[240:243], a[156:159], a[240:243]
    v_mfma_f32_16x16x32_bf16 a[244:247], v[244:247], a[156:159], a[244:247]
    ds_read_b128 a[172:175], v13 offset:10240
    v_mfma_f32_16x16x32_bf16 a[244:247], v[212:215], a[152:155], a[244:247]
    v_mfma_f32_16x16x32_bf16 a[248:251], v[216:219], a[152:155], a[248:251]
    buffer_load_dwordx4 v[84:87], v7, s[36:39], s61 offen
    v_mfma_f32_16x16x32_bf16 a[248:251], v[248:251], a[156:159], a[248:251]
    v_mfma_f32_16x16x32_bf16 a[252:255], v[252:255], a[156:159], a[252:255]
    v_mfma_f32_16x16x32_bf16 a[252:255], v[220:223], a[152:155], a[252:255]
    s_waitcnt lgkmcnt(3)
    v_mfma_f32_16x16x32_bf16 a[0:3], v[192:195], a[160:163], a[0:3]
    buffer_load_dwordx4 v[88:91], v7, s[36:39], s62 offen
    s_waitcnt lgkmcnt(2)
    v_mfma_f32_16x16x32_bf16 a[0:3], v[224:227], a[164:167], a[0:3]
    v_mfma_f32_16x16x32_bf16 a[4:7], v[228:231], a[164:167], a[4:7]
    ds_read_b32 v110, v97 offset:1736
    v_mfma_f32_16x16x32_bf16 a[4:7], v[196:199], a[160:163], a[4:7]
    s_waitcnt vmcnt(23)
    ds_read_b128 a[176:179], v12 offset:12288
    v_mfma_f32_16x16x32_bf16 a[8:11], v[200:203], a[160:163], a[8:11]
    buffer_load_dwordx4 v[92:95], v7, s[36:39], s63 offen
    v_mfma_f32_16x16x32_bf16 a[8:11], v[232:235], a[164:167], a[8:11]
    v_mfma_f32_16x16x32_bf16 a[12:15], v[236:239], a[164:167], a[12:15]
    ds_read_b32 v111, v97 offset:2568
    v_mfma_f32_16x16x32_bf16 a[12:15], v[204:207], a[160:163], a[12:15]
    v_mfma_f32_16x16x32_bf16 a[16:19], v[208:211], a[160:163], a[16:19]
    s_waitcnt lgkmcnt(2)
    s_add_u32 m0, s78, 22528
    v_lshl_add_u32 v110, v110, 8, v10
    buffer_load_dwordx4 v110, s[32:35], 0 offen lds
    v_mfma_f32_16x16x32_bf16 a[16:19], v[240:243], a[164:167], a[16:19]
    v_mfma_f32_16x16x32_bf16 a[20:23], v[244:247], a[164:167], a[20:23]
    ds_read_b32 v112, v98 offset:72
    ds_read_b128 a[180:183], v13 offset:12288
    v_mfma_f32_16x16x32_bf16 a[20:23], v[212:215], a[160:163], a[20:23]
    v_mfma_f32_16x16x32_bf16 a[24:27], v[216:219], a[160:163], a[24:27]
    s_waitcnt lgkmcnt(2)
    s_add_u32 m0, s78, 23552
    v_lshl_add_u32 v111, v111, 8, v11
    buffer_load_dwordx4 v111, s[32:35], 0 offen lds
    v_mfma_f32_16x16x32_bf16 a[24:27], v[248:251], a[164:167], a[24:27]
    v_mfma_f32_16x16x32_bf16 a[28:31], v[252:255], a[164:167], a[28:31]
    ds_read_b32 v113, v98 offset:904
    v_mfma_f32_16x16x32_bf16 a[28:31], v[220:223], a[160:163], a[28:31]
    v_mfma_f32_16x16x32_bf16 a[32:35], v[192:195], a[168:171], a[32:35]
    s_waitcnt lgkmcnt(2)
    s_add_u32 m0, s78, 24576
    v_lshl_add_u32 v112, v112, 8, v10
    buffer_load_dwordx4 v112, s[32:35], 0 offen lds
    v_mfma_f32_16x16x32_bf16 a[32:35], v[224:227], a[172:175], a[32:35]
    v_mfma_f32_16x16x32_bf16 a[36:39], v[228:231], a[172:175], a[36:39]
    ds_read_b32 v114, v98 offset:1736
    v_mfma_f32_16x16x32_bf16 a[36:39], v[196:199], a[168:171], a[36:39]
    s_waitcnt vmcnt(25)
    ds_read_b128 a[184:187], v12 offset:14336
    v_mfma_f32_16x16x32_bf16 a[40:43], v[200:203], a[168:171], a[40:43]
    s_waitcnt lgkmcnt(2)
    s_add_u32 m0, s78, 25600
    v_lshl_add_u32 v113, v113, 8, v11
    buffer_load_dwordx4 v113, s[32:35], 0 offen lds
    v_mfma_f32_16x16x32_bf16 a[40:43], v[232:235], a[172:175], a[40:43]
    v_mfma_f32_16x16x32_bf16 a[44:47], v[236:239], a[172:175], a[44:47]
    ds_read_b32 v115, v98 offset:2568
    v_mfma_f32_16x16x32_bf16 a[44:47], v[204:207], a[168:171], a[44:47]
    v_mfma_f32_16x16x32_bf16 a[48:51], v[208:211], a[168:171], a[48:51]
    s_waitcnt lgkmcnt(2)
    s_add_u32 m0, s78, 26624
    v_lshl_add_u32 v114, v114, 8, v10
    buffer_load_dwordx4 v114, s[32:35], 0 offen lds
    v_mfma_f32_16x16x32_bf16 a[48:51], v[240:243], a[172:175], a[48:51]
    v_mfma_f32_16x16x32_bf16 a[52:55], v[244:247], a[172:175], a[52:55]
    ds_read_b32 v116, v99 offset:72
    ds_read_b128 a[188:191], v13 offset:14336
    v_mfma_f32_16x16x32_bf16 a[52:55], v[212:215], a[168:171], a[52:55]
    v_mfma_f32_16x16x32_bf16 a[56:59], v[216:219], a[168:171], a[56:59]
    s_waitcnt lgkmcnt(2)
    s_add_u32 m0, s78, 27648
    v_lshl_add_u32 v115, v115, 8, v11
    buffer_load_dwordx4 v115, s[32:35], 0 offen lds
    v_mfma_f32_16x16x32_bf16 a[56:59], v[248:251], a[172:175], a[56:59]
    v_mfma_f32_16x16x32_bf16 a[60:63], v[252:255], a[172:175], a[60:63]
    ds_read_b32 v117, v99 offset:904
    v_mfma_f32_16x16x32_bf16 a[60:63], v[220:223], a[168:171], a[60:63]
    v_mfma_f32_16x16x32_bf16 a[64:67], v[192:195], a[176:179], a[64:67]
    s_waitcnt lgkmcnt(2)
    s_add_u32 m0, s78, 28672
    v_lshl_add_u32 v116, v116, 8, v10
    buffer_load_dwordx4 v116, s[32:35], 0 offen lds
    v_mfma_f32_16x16x32_bf16 a[64:67], v[224:227], a[180:183], a[64:67]
    v_mfma_f32_16x16x32_bf16 a[68:71], v[228:231], a[180:183], a[68:71]
    ds_read_b32 v118, v99 offset:1736
    v_mfma_f32_16x16x32_bf16 a[68:71], v[196:199], a[176:179], a[68:71]
    s_waitcnt vmcnt(27)
    ds_read_b128 a[128:131], v12 offset:16384
    v_mfma_f32_16x16x32_bf16 a[72:75], v[200:203], a[176:179], a[72:75]
    s_waitcnt lgkmcnt(2)
    s_add_u32 m0, s78, 29696
    v_lshl_add_u32 v117, v117, 8, v11
    buffer_load_dwordx4 v117, s[32:35], 0 offen lds
    v_mfma_f32_16x16x32_bf16 a[72:75], v[232:235], a[180:183], a[72:75]
    v_mfma_f32_16x16x32_bf16 a[76:79], v[236:239], a[180:183], a[76:79]
    ds_read_b32 v119, v99 offset:2568
    v_mfma_f32_16x16x32_bf16 a[76:79], v[204:207], a[176:179], a[76:79]
    v_mfma_f32_16x16x32_bf16 a[80:83], v[208:211], a[176:179], a[80:83]
    s_waitcnt lgkmcnt(2)
    s_add_u32 m0, s78, 30720
    v_lshl_add_u32 v118, v118, 8, v10
    buffer_load_dwordx4 v118, s[32:35], 0 offen lds
    v_mfma_f32_16x16x32_bf16 a[80:83], v[240:243], a[180:183], a[80:83]
    v_mfma_f32_16x16x32_bf16 a[84:87], v[244:247], a[180:183], a[84:87]
    ds_read_b32 v104, v96 offset:80
    ds_read_b128 a[132:135], v13 offset:16384
    v_mfma_f32_16x16x32_bf16 a[84:87], v[212:215], a[176:179], a[84:87]
    v_mfma_f32_16x16x32_bf16 a[88:91], v[216:219], a[176:179], a[88:91]
    s_waitcnt lgkmcnt(2)
    s_add_u32 m0, s78, 31744
    v_lshl_add_u32 v119, v119, 8, v11
    buffer_load_dwordx4 v119, s[32:35], 0 offen lds
    v_mfma_f32_16x16x32_bf16 a[88:91], v[248:251], a[180:183], a[88:91]
    v_mfma_f32_16x16x32_bf16 a[92:95], v[252:255], a[180:183], a[92:95]
    ds_read_b32 v105, v96 offset:912
    v_mfma_f32_16x16x32_bf16 a[92:95], v[220:223], a[176:179], a[92:95]
    v_mfma_f32_16x16x32_bf16 a[96:99], v[192:195], a[184:187], a[96:99]
    s_waitcnt lgkmcnt(2)
    s_add_u32 m0, s78, 0
    v_lshl_add_u32 v104, v104, 8, v10
    buffer_load_dwordx4 v104, s[32:35], 0 offen lds
    v_mfma_f32_16x16x32_bf16 a[96:99], v[224:227], a[188:191], a[96:99]
    s_waitcnt vmcnt(19)
    v_perm_b32 v192, v36, v32, s64
    v_perm_b32 v193, v44, v40, s64
    v_perm_b32 v194, v52, v48, s64
    v_mfma_f32_16x16x32_bf16 a[100:103], v[228:231], a[188:191], a[100:103]
    v_perm_b32 v195, v60, v56, s64
    s_waitcnt vmcnt(11)
    v_perm_b32 v224, v68, v64, s64
    v_perm_b32 v225, v76, v72, s64
    ds_read_b32 v106, v96 offset:1744
    v_mfma_f32_16x16x32_bf16 a[100:103], v[196:199], a[184:187], a[100:103]
    v_perm_b32 v226, v84, v80, s64
    v_perm_b32 v227, v92, v88, s64
    v_perm_b32 v228, v68, v64, s65
    ds_read_b128 a[136:139], v12 offset:18432
    v_mfma_f32_16x16x32_bf16 a[104:107], v[200:203], a[184:187], a[104:107]
    v_perm_b32 v229, v76, v72, s65
    v_perm_b32 v230, v84, v80, s65
    v_perm_b32 v231, v92, v88, s65
    s_waitcnt lgkmcnt(2)
    s_add_u32 m0, s78, 1024
    v_lshl_add_u32 v105, v105, 8, v11
    buffer_load_dwordx4 v105, s[32:35], 0 offen lds
    v_mfma_f32_16x16x32_bf16 a[104:107], v[232:235], a[188:191], a[104:107]
    v_perm_b32 v196, v36, v32, s65
    v_perm_b32 v197, v44, v40, s65
    v_perm_b32 v198, v52, v48, s65
    v_mfma_f32_16x16x32_bf16 a[108:111], v[236:239], a[188:191], a[108:111]
    v_perm_b32 v199, v60, v56, s65
    v_perm_b32 v200, v37, v33, s64
    v_perm_b32 v201, v45, v41, s64
    ds_read_b32 v107, v96 offset:2576
    v_mfma_f32_16x16x32_bf16 a[108:111], v[204:207], a[184:187], a[108:111]
    v_perm_b32 v202, v53, v49, s64
    v_perm_b32 v203, v61, v57, s64
    v_perm_b32 v232, v69, v65, s64
    v_mfma_f32_16x16x32_bf16 a[112:115], v[208:211], a[184:187], a[112:115]
    v_perm_b32 v233, v77, v73, s64
    v_perm_b32 v234, v85, v81, s64
    v_perm_b32 v235, v93, v89, s64
    s_waitcnt lgkmcnt(2)
    s_add_u32 m0, s78, 2048
    v_lshl_add_u32 v106, v106, 8, v10
    buffer_load_dwordx4 v106, s[32:35], 0 offen lds
    v_mfma_f32_16x16x32_bf16 a[112:115], v[240:243], a[188:191], a[112:115]
    v_perm_b32 v236, v69, v65, s65
    v_perm_b32 v237, v77, v73, s65
    v_perm_b32 v238, v85, v81, s65
    v_mfma_f32_16x16x32_bf16 a[116:119], v[244:247], a[188:191], a[116:119]
    v_perm_b32 v239, v93, v89, s65
    v_perm_b32 v204, v37, v33, s65
    v_perm_b32 v205, v45, v41, s65
    ds_read_b32 v108, v97 offset:80
    ds_read_b128 a[140:143], v13 offset:18432
    v_mfma_f32_16x16x32_bf16 a[116:119], v[212:215], a[184:187], a[116:119]
    v_perm_b32 v206, v53, v49, s65
    v_perm_b32 v207, v61, v57, s65
    v_perm_b32 v208, v38, v34, s64
    v_mfma_f32_16x16x32_bf16 a[120:123], v[216:219], a[184:187], a[120:123]
    v_perm_b32 v209, v46, v42, s64
    v_perm_b32 v210, v54, v50, s64
    v_perm_b32 v211, v62, v58, s64
    s_waitcnt lgkmcnt(2)
    s_add_u32 m0, s78, 3072
    v_lshl_add_u32 v107, v107, 8, v11
    buffer_load_dwordx4 v107, s[32:35], 0 offen lds
    v_mfma_f32_16x16x32_bf16 a[120:123], v[248:251], a[188:191], a[120:123]
    v_perm_b32 v240, v70, v66, s64
    v_perm_b32 v241, v78, v74, s64
    v_perm_b32 v242, v86, v82, s64
    v_mfma_f32_16x16x32_bf16 a[124:127], v[252:255], a[188:191], a[124:127]
    v_perm_b32 v243, v94, v90, s64
    v_perm_b32 v244, v70, v66, s65
    v_perm_b32 v245, v78, v74, s65
    ds_read_b32 v109, v97 offset:912
    v_mfma_f32_16x16x32_bf16 a[124:127], v[220:223], a[184:187], a[124:127]
    v_perm_b32 v246, v86, v82, s65
    v_perm_b32 v247, v94, v90, s65
    v_perm_b32 v212, v38, v34, s65
    v_mfma_f32_16x16x32_bf16 v[128:131], v[192:195], a[128:131], v[128:131]
    v_perm_b32 v213, v46, v42, s65
    v_perm_b32 v214, v54, v50, s65
    v_perm_b32 v215, v62, v58, s65
    s_waitcnt lgkmcnt(2)
    s_add_u32 m0, s78, 4096
    v_lshl_add_u32 v108, v108, 8, v10
    buffer_load_dwordx4 v108, s[32:35], 0 offen lds
    v_mfma_f32_16x16x32_bf16 v[128:131], v[224:227], a[132:135], v[128:131]
    v_perm_b32 v216, v39, v35, s64
    v_perm_b32 v217, v47, v43, s64
    v_perm_b32 v218, v55, v51, s64
    v_mfma_f32_16x16x32_bf16 v[132:135], v[228:231], a[132:135], v[132:135]
    v_perm_b32 v219, v63, v59, s64
    v_perm_b32 v248, v71, v67, s64
    v_perm_b32 v249, v79, v75, s64
    v_mfma_f32_16x16x32_bf16 v[132:135], v[196:199], a[128:131], v[132:135]
    v_perm_b32 v250, v87, v83, s64
    v_perm_b32 v251, v95, v91, s64
    v_perm_b32 v252, v71, v67, s65
    ds_read_b128 a[144:147], v12 offset:20480
    v_mfma_f32_16x16x32_bf16 v[136:139], v[200:203], a[128:131], v[136:139]
    v_perm_b32 v253, v79, v75, s65
    v_perm_b32 v254, v87, v83, s65
    v_perm_b32 v255, v95, v91, s65
    s_waitcnt lgkmcnt(1)
    s_add_u32 m0, s78, 5120
    v_lshl_add_u32 v109, v109, 8, v11
    buffer_load_dwordx4 v109, s[32:35], 0 offen lds
    v_mfma_f32_16x16x32_bf16 v[136:139], v[232:235], a[132:135], v[136:139]
    v_perm_b32 v220, v39, v35, s65
    v_perm_b32 v221, v47, v43, s65
    v_perm_b32 v222, v55, v51, s65
    v_mfma_f32_16x16x32_bf16 v[140:143], v[236:239], a[132:135], v[140:143]
    v_perm_b32 v223, v63, v59, s65
    v_mfma_f32_16x16x32_bf16 v[140:143], v[204:207], a[128:131], v[140:143]
    v_mfma_f32_16x16x32_bf16 v[144:147], v[208:211], a[128:131], v[144:147]
    v_add_u32 v7, 1490944, v7
    buffer_load_dwordx4 v[32:35], v7, s[36:39], s56 offen
    v_mfma_f32_16x16x32_bf16 v[144:147], v[240:243], a[132:135], v[144:147]
    v_mfma_f32_16x16x32_bf16 v[148:151], v[244:247], a[132:135], v[148:151]
    ds_read_b128 a[148:151], v13 offset:20480
    v_mfma_f32_16x16x32_bf16 v[148:151], v[212:215], a[128:131], v[148:151]
    v_mfma_f32_16x16x32_bf16 v[152:155], v[216:219], a[128:131], v[152:155]
    buffer_load_dwordx4 v[36:39], v7, s[36:39], s57 offen
    v_mfma_f32_16x16x32_bf16 v[152:155], v[248:251], a[132:135], v[152:155]
    v_mfma_f32_16x16x32_bf16 v[156:159], v[252:255], a[132:135], v[156:159]
    v_mfma_f32_16x16x32_bf16 v[156:159], v[220:223], a[128:131], v[156:159]
    v_mfma_f32_16x16x32_bf16 v[160:163], v[192:195], a[136:139], v[160:163]
    buffer_load_dwordx4 v[40:43], v7, s[36:39], s58 offen
    v_mfma_f32_16x16x32_bf16 v[160:163], v[224:227], a[140:143], v[160:163]
    v_mfma_f32_16x16x32_bf16 v[164:167], v[228:231], a[140:143], v[164:167]
    v_mfma_f32_16x16x32_bf16 v[164:167], v[196:199], a[136:139], v[164:167]
    s_waitcnt vmcnt(17)
    ds_read_b128 a[152:155], v12 offset:22528
    v_mfma_f32_16x16x32_bf16 v[168:171], v[200:203], a[136:139], v[168:171]
    buffer_load_dwordx4 v[44:47], v7, s[36:39], s59 offen
    v_mfma_f32_16x16x32_bf16 v[168:171], v[232:235], a[140:143], v[168:171]
    v_mfma_f32_16x16x32_bf16 v[172:175], v[236:239], a[140:143], v[172:175]
    v_mfma_f32_16x16x32_bf16 v[172:175], v[204:207], a[136:139], v[172:175]
    v_mfma_f32_16x16x32_bf16 v[176:179], v[208:211], a[136:139], v[176:179]
    buffer_load_dwordx4 v[48:51], v7, s[36:39], s60 offen
    v_mfma_f32_16x16x32_bf16 v[176:179], v[240:243], a[140:143], v[176:179]
    v_mfma_f32_16x16x32_bf16 v[180:183], v[244:247], a[140:143], v[180:183]
    ds_read_b128 a[156:159], v13 offset:22528
    v_mfma_f32_16x16x32_bf16 v[180:183], v[212:215], a[136:139], v[180:183]
    v_mfma_f32_16x16x32_bf16 v[184:187], v[216:219], a[136:139], v[184:187]
    buffer_load_dwordx4 v[52:55], v7, s[36:39], s61 offen
    v_mfma_f32_16x16x32_bf16 v[184:187], v[248:251], a[140:143], v[184:187]
    v_mfma_f32_16x16x32_bf16 v[188:191], v[252:255], a[140:143], v[188:191]
    v_mfma_f32_16x16x32_bf16 v[188:191], v[220:223], a[136:139], v[188:191]
    s_waitcnt lgkmcnt(3)
    v_mfma_f32_16x16x32_bf16 a[192:195], v[192:195], a[144:147], a[192:195]
    buffer_load_dwordx4 v[56:59], v7, s[36:39], s62 offen
    s_waitcnt lgkmcnt(2)
    v_mfma_f32_16x16x32_bf16 a[192:195], v[224:227], a[148:151], a[192:195]
    v_mfma_f32_16x16x32_bf16 a[196:199], v[228:231], a[148:151], a[196:199]
    v_mfma_f32_16x16x32_bf16 a[196:199], v[196:199], a[144:147], a[196:199]
    s_waitcnt vmcnt(19)
    ds_read_b128 a[160:163], v12 offset:24576
    v_mfma_f32_16x16x32_bf16 a[200:203], v[200:203], a[144:147], a[200:203]
    buffer_load_dwordx4 v[60:63], v7, s[36:39], s63 offen
    v_mfma_f32_16x16x32_bf16 a[200:203], v[232:235], a[148:151], a[200:203]
    v_mfma_f32_16x16x32_bf16 a[204:207], v[236:239], a[148:151], a[204:207]
    v_mfma_f32_16x16x32_bf16 a[204:207], v[204:207], a[144:147], a[204:207]
    v_mfma_f32_16x16x32_bf16 a[208:211], v[208:211], a[144:147], a[208:211]
    v_add_u32 v7, 212992, v7
    buffer_load_dwordx4 v[64:67], v7, s[36:39], s56 offen
    v_mfma_f32_16x16x32_bf16 a[208:211], v[240:243], a[148:151], a[208:211]
    v_mfma_f32_16x16x32_bf16 a[212:215], v[244:247], a[148:151], a[212:215]
    ds_read_b128 a[164:167], v13 offset:24576
    v_mfma_f32_16x16x32_bf16 a[212:215], v[212:215], a[144:147], a[212:215]
    v_mfma_f32_16x16x32_bf16 a[216:219], v[216:219], a[144:147], a[216:219]
    buffer_load_dwordx4 v[68:71], v7, s[36:39], s57 offen
    v_mfma_f32_16x16x32_bf16 a[216:219], v[248:251], a[148:151], a[216:219]
    v_mfma_f32_16x16x32_bf16 a[220:223], v[252:255], a[148:151], a[220:223]
    v_mfma_f32_16x16x32_bf16 a[220:223], v[220:223], a[144:147], a[220:223]
    s_waitcnt lgkmcnt(3)
    v_mfma_f32_16x16x32_bf16 a[224:227], v[192:195], a[152:155], a[224:227]
    buffer_load_dwordx4 v[72:75], v7, s[36:39], s58 offen
    s_waitcnt lgkmcnt(2)
    v_mfma_f32_16x16x32_bf16 a[224:227], v[224:227], a[156:159], a[224:227]
    v_mfma_f32_16x16x32_bf16 a[228:231], v[228:231], a[156:159], a[228:231]
    v_mfma_f32_16x16x32_bf16 a[228:231], v[196:199], a[152:155], a[228:231]
    s_waitcnt vmcnt(21)
    ds_read_b128 a[168:171], v12 offset:26624
    v_mfma_f32_16x16x32_bf16 a[232:235], v[200:203], a[152:155], a[232:235]
    buffer_load_dwordx4 v[76:79], v7, s[36:39], s59 offen
    v_mfma_f32_16x16x32_bf16 a[232:235], v[232:235], a[156:159], a[232:235]
    v_mfma_f32_16x16x32_bf16 a[236:239], v[236:239], a[156:159], a[236:239]
    v_mfma_f32_16x16x32_bf16 a[236:239], v[204:207], a[152:155], a[236:239]
    v_mfma_f32_16x16x32_bf16 a[240:243], v[208:211], a[152:155], a[240:243]
    buffer_load_dwordx4 v[80:83], v7, s[36:39], s60 offen
    v_mfma_f32_16x16x32_bf16 a[240:243], v[240:243], a[156:159], a[240:243]
    v_mfma_f32_16x16x32_bf16 a[244:247], v[244:247], a[156:159], a[244:247]
    ds_read_b128 a[172:175], v13 offset:26624
    v_mfma_f32_16x16x32_bf16 a[244:247], v[212:215], a[152:155], a[244:247]
    v_mfma_f32_16x16x32_bf16 a[248:251], v[216:219], a[152:155], a[248:251]
    buffer_load_dwordx4 v[84:87], v7, s[36:39], s61 offen
    v_mfma_f32_16x16x32_bf16 a[248:251], v[248:251], a[156:159], a[248:251]
    v_mfma_f32_16x16x32_bf16 a[252:255], v[252:255], a[156:159], a[252:255]
    v_mfma_f32_16x16x32_bf16 a[252:255], v[220:223], a[152:155], a[252:255]
    s_waitcnt lgkmcnt(3)
    v_mfma_f32_16x16x32_bf16 a[0:3], v[192:195], a[160:163], a[0:3]
    buffer_load_dwordx4 v[88:91], v7, s[36:39], s62 offen
    s_waitcnt lgkmcnt(2)
    v_mfma_f32_16x16x32_bf16 a[0:3], v[224:227], a[164:167], a[0:3]
    v_mfma_f32_16x16x32_bf16 a[4:7], v[228:231], a[164:167], a[4:7]
    ds_read_b32 v110, v97 offset:1744
    v_mfma_f32_16x16x32_bf16 a[4:7], v[196:199], a[160:163], a[4:7]
    s_waitcnt vmcnt(23)
    ds_read_b128 a[176:179], v12 offset:28672
    v_mfma_f32_16x16x32_bf16 a[8:11], v[200:203], a[160:163], a[8:11]
    buffer_load_dwordx4 v[92:95], v7, s[36:39], s63 offen
    v_mfma_f32_16x16x32_bf16 a[8:11], v[232:235], a[164:167], a[8:11]
    v_mfma_f32_16x16x32_bf16 a[12:15], v[236:239], a[164:167], a[12:15]
    ds_read_b32 v111, v97 offset:2576
    v_mfma_f32_16x16x32_bf16 a[12:15], v[204:207], a[160:163], a[12:15]
    v_mfma_f32_16x16x32_bf16 a[16:19], v[208:211], a[160:163], a[16:19]
    s_waitcnt lgkmcnt(2)
    s_add_u32 m0, s78, 6144
    v_lshl_add_u32 v110, v110, 8, v10
    buffer_load_dwordx4 v110, s[32:35], 0 offen lds
    v_mfma_f32_16x16x32_bf16 a[16:19], v[240:243], a[164:167], a[16:19]
    v_mfma_f32_16x16x32_bf16 a[20:23], v[244:247], a[164:167], a[20:23]
    ds_read_b32 v112, v98 offset:80
    ds_read_b128 a[180:183], v13 offset:28672
    v_mfma_f32_16x16x32_bf16 a[20:23], v[212:215], a[160:163], a[20:23]
    v_mfma_f32_16x16x32_bf16 a[24:27], v[216:219], a[160:163], a[24:27]
    s_waitcnt lgkmcnt(2)
    s_add_u32 m0, s78, 7168
    v_lshl_add_u32 v111, v111, 8, v11
    buffer_load_dwordx4 v111, s[32:35], 0 offen lds
    v_mfma_f32_16x16x32_bf16 a[24:27], v[248:251], a[164:167], a[24:27]
    v_mfma_f32_16x16x32_bf16 a[28:31], v[252:255], a[164:167], a[28:31]
    ds_read_b32 v113, v98 offset:912
    v_mfma_f32_16x16x32_bf16 a[28:31], v[220:223], a[160:163], a[28:31]
    v_mfma_f32_16x16x32_bf16 a[32:35], v[192:195], a[168:171], a[32:35]
    s_waitcnt lgkmcnt(2)
    s_add_u32 m0, s78, 8192
    v_lshl_add_u32 v112, v112, 8, v10
    buffer_load_dwordx4 v112, s[32:35], 0 offen lds
    v_mfma_f32_16x16x32_bf16 a[32:35], v[224:227], a[172:175], a[32:35]
    v_mfma_f32_16x16x32_bf16 a[36:39], v[228:231], a[172:175], a[36:39]
    ds_read_b32 v114, v98 offset:1744
    v_mfma_f32_16x16x32_bf16 a[36:39], v[196:199], a[168:171], a[36:39]
    s_waitcnt vmcnt(25)
    ds_read_b128 a[184:187], v12 offset:30720
    v_mfma_f32_16x16x32_bf16 a[40:43], v[200:203], a[168:171], a[40:43]
    s_waitcnt lgkmcnt(2)
    s_add_u32 m0, s78, 9216
    v_lshl_add_u32 v113, v113, 8, v11
    buffer_load_dwordx4 v113, s[32:35], 0 offen lds
    v_mfma_f32_16x16x32_bf16 a[40:43], v[232:235], a[172:175], a[40:43]
    v_mfma_f32_16x16x32_bf16 a[44:47], v[236:239], a[172:175], a[44:47]
    ds_read_b32 v115, v98 offset:2576
    v_mfma_f32_16x16x32_bf16 a[44:47], v[204:207], a[168:171], a[44:47]
    v_mfma_f32_16x16x32_bf16 a[48:51], v[208:211], a[168:171], a[48:51]
    s_waitcnt lgkmcnt(2)
    s_add_u32 m0, s78, 10240
    v_lshl_add_u32 v114, v114, 8, v10
    buffer_load_dwordx4 v114, s[32:35], 0 offen lds
    v_mfma_f32_16x16x32_bf16 a[48:51], v[240:243], a[172:175], a[48:51]
    v_mfma_f32_16x16x32_bf16 a[52:55], v[244:247], a[172:175], a[52:55]
    ds_read_b32 v116, v99 offset:80
    ds_read_b128 a[188:191], v13 offset:30720
    v_mfma_f32_16x16x32_bf16 a[52:55], v[212:215], a[168:171], a[52:55]
    v_mfma_f32_16x16x32_bf16 a[56:59], v[216:219], a[168:171], a[56:59]
    s_waitcnt lgkmcnt(2)
    s_add_u32 m0, s78, 11264
    v_lshl_add_u32 v115, v115, 8, v11
    buffer_load_dwordx4 v115, s[32:35], 0 offen lds
    v_mfma_f32_16x16x32_bf16 a[56:59], v[248:251], a[172:175], a[56:59]
    v_mfma_f32_16x16x32_bf16 a[60:63], v[252:255], a[172:175], a[60:63]
    ds_read_b32 v117, v99 offset:912
    v_mfma_f32_16x16x32_bf16 a[60:63], v[220:223], a[168:171], a[60:63]
    v_mfma_f32_16x16x32_bf16 a[64:67], v[192:195], a[176:179], a[64:67]
    s_waitcnt lgkmcnt(2)
    s_add_u32 m0, s78, 12288
    v_lshl_add_u32 v116, v116, 8, v10
    buffer_load_dwordx4 v116, s[32:35], 0 offen lds
    v_mfma_f32_16x16x32_bf16 a[64:67], v[224:227], a[180:183], a[64:67]
    v_mfma_f32_16x16x32_bf16 a[68:71], v[228:231], a[180:183], a[68:71]
    ds_read_b32 v118, v99 offset:1744
    v_mfma_f32_16x16x32_bf16 a[68:71], v[196:199], a[176:179], a[68:71]
    s_waitcnt vmcnt(27)
    ds_read_b128 a[128:131], v12 offset:0
    v_mfma_f32_16x16x32_bf16 a[72:75], v[200:203], a[176:179], a[72:75]
    s_waitcnt lgkmcnt(2)
    s_add_u32 m0, s78, 13312
    v_lshl_add_u32 v117, v117, 8, v11
    buffer_load_dwordx4 v117, s[32:35], 0 offen lds
    v_mfma_f32_16x16x32_bf16 a[72:75], v[232:235], a[180:183], a[72:75]
    v_mfma_f32_16x16x32_bf16 a[76:79], v[236:239], a[180:183], a[76:79]
    ds_read_b32 v119, v99 offset:2576
    v_mfma_f32_16x16x32_bf16 a[76:79], v[204:207], a[176:179], a[76:79]
    v_mfma_f32_16x16x32_bf16 a[80:83], v[208:211], a[176:179], a[80:83]
    s_waitcnt lgkmcnt(2)
    s_add_u32 m0, s78, 14336
    v_lshl_add_u32 v118, v118, 8, v10
    buffer_load_dwordx4 v118, s[32:35], 0 offen lds
    v_mfma_f32_16x16x32_bf16 a[80:83], v[240:243], a[180:183], a[80:83]
    v_mfma_f32_16x16x32_bf16 a[84:87], v[244:247], a[180:183], a[84:87]
    ds_read_b32 v104, v96 offset:88
    ds_read_b128 a[132:135], v13 offset:0
    v_mfma_f32_16x16x32_bf16 a[84:87], v[212:215], a[176:179], a[84:87]
    v_mfma_f32_16x16x32_bf16 a[88:91], v[216:219], a[176:179], a[88:91]
    s_waitcnt lgkmcnt(2)
    s_add_u32 m0, s78, 15360
    v_lshl_add_u32 v119, v119, 8, v11
    buffer_load_dwordx4 v119, s[32:35], 0 offen lds
    v_mfma_f32_16x16x32_bf16 a[88:91], v[248:251], a[180:183], a[88:91]
    v_mfma_f32_16x16x32_bf16 a[92:95], v[252:255], a[180:183], a[92:95]
    ds_read_b32 v105, v96 offset:920
    v_mfma_f32_16x16x32_bf16 a[92:95], v[220:223], a[176:179], a[92:95]
    v_mfma_f32_16x16x32_bf16 a[96:99], v[192:195], a[184:187], a[96:99]
    s_waitcnt lgkmcnt(2)
    s_add_u32 m0, s78, 16384
    v_lshl_add_u32 v104, v104, 8, v10
    buffer_load_dwordx4 v104, s[32:35], 0 offen lds
    v_mfma_f32_16x16x32_bf16 a[96:99], v[224:227], a[188:191], a[96:99]
    s_waitcnt vmcnt(19)
    v_perm_b32 v192, v36, v32, s64
    v_perm_b32 v193, v44, v40, s64
    v_perm_b32 v194, v52, v48, s64
    v_mfma_f32_16x16x32_bf16 a[100:103], v[228:231], a[188:191], a[100:103]
    v_perm_b32 v195, v60, v56, s64
    s_waitcnt vmcnt(11)
    v_perm_b32 v224, v68, v64, s64
    v_perm_b32 v225, v76, v72, s64
    ds_read_b32 v106, v96 offset:1752
    v_mfma_f32_16x16x32_bf16 a[100:103], v[196:199], a[184:187], a[100:103]
    v_perm_b32 v226, v84, v80, s64
    v_perm_b32 v227, v92, v88, s64
    v_perm_b32 v228, v68, v64, s65
    ds_read_b128 a[136:139], v12 offset:2048
    v_mfma_f32_16x16x32_bf16 a[104:107], v[200:203], a[184:187], a[104:107]
    v_perm_b32 v229, v76, v72, s65
    v_perm_b32 v230, v84, v80, s65
    v_perm_b32 v231, v92, v88, s65
    s_waitcnt lgkmcnt(2)
    s_add_u32 m0, s78, 17408
    v_lshl_add_u32 v105, v105, 8, v11
    buffer_load_dwordx4 v105, s[32:35], 0 offen lds
    v_mfma_f32_16x16x32_bf16 a[104:107], v[232:235], a[188:191], a[104:107]
    v_perm_b32 v196, v36, v32, s65
    v_perm_b32 v197, v44, v40, s65
    v_perm_b32 v198, v52, v48, s65
    v_mfma_f32_16x16x32_bf16 a[108:111], v[236:239], a[188:191], a[108:111]
    v_perm_b32 v199, v60, v56, s65
    v_perm_b32 v200, v37, v33, s64
    v_perm_b32 v201, v45, v41, s64
    ds_read_b32 v107, v96 offset:2584
    v_mfma_f32_16x16x32_bf16 a[108:111], v[204:207], a[184:187], a[108:111]
    v_perm_b32 v202, v53, v49, s64
    v_perm_b32 v203, v61, v57, s64
    v_perm_b32 v232, v69, v65, s64
    v_mfma_f32_16x16x32_bf16 a[112:115], v[208:211], a[184:187], a[112:115]
    v_perm_b32 v233, v77, v73, s64
    v_perm_b32 v234, v85, v81, s64
    v_perm_b32 v235, v93, v89, s64
    s_waitcnt lgkmcnt(2)
    s_add_u32 m0, s78, 18432
    v_lshl_add_u32 v106, v106, 8, v10
    buffer_load_dwordx4 v106, s[32:35], 0 offen lds
    v_mfma_f32_16x16x32_bf16 a[112:115], v[240:243], a[188:191], a[112:115]
    v_perm_b32 v236, v69, v65, s65
    v_perm_b32 v237, v77, v73, s65
    v_perm_b32 v238, v85, v81, s65
    v_mfma_f32_16x16x32_bf16 a[116:119], v[244:247], a[188:191], a[116:119]
    v_perm_b32 v239, v93, v89, s65
    v_perm_b32 v204, v37, v33, s65
    v_perm_b32 v205, v45, v41, s65
    ds_read_b32 v108, v97 offset:88
    ds_read_b128 a[140:143], v13 offset:2048
    v_mfma_f32_16x16x32_bf16 a[116:119], v[212:215], a[184:187], a[116:119]
    v_perm_b32 v206, v53, v49, s65
    v_perm_b32 v207, v61, v57, s65
    v_perm_b32 v208, v38, v34, s64
    v_mfma_f32_16x16x32_bf16 a[120:123], v[216:219], a[184:187], a[120:123]
    v_perm_b32 v209, v46, v42, s64
    v_perm_b32 v210, v54, v50, s64
    v_perm_b32 v211, v62, v58, s64
    s_waitcnt lgkmcnt(2)
    s_add_u32 m0, s78, 19456
    v_lshl_add_u32 v107, v107, 8, v11
    buffer_load_dwordx4 v107, s[32:35], 0 offen lds
    v_mfma_f32_16x16x32_bf16 a[120:123], v[248:251], a[188:191], a[120:123]
    v_perm_b32 v240, v70, v66, s64
    v_perm_b32 v241, v78, v74, s64
    v_perm_b32 v242, v86, v82, s64
    v_mfma_f32_16x16x32_bf16 a[124:127], v[252:255], a[188:191], a[124:127]
    v_perm_b32 v243, v94, v90, s64
    v_perm_b32 v244, v70, v66, s65
    v_perm_b32 v245, v78, v74, s65
    ds_read_b32 v109, v97 offset:920
    v_mfma_f32_16x16x32_bf16 a[124:127], v[220:223], a[184:187], a[124:127]
    v_perm_b32 v246, v86, v82, s65
    v_perm_b32 v247, v94, v90, s65
    v_perm_b32 v212, v38, v34, s65
    v_mfma_f32_16x16x32_bf16 v[128:131], v[192:195], a[128:131], v[128:131]
    v_perm_b32 v213, v46, v42, s65
    v_perm_b32 v214, v54, v50, s65
    v_perm_b32 v215, v62, v58, s65
    s_waitcnt lgkmcnt(2)
    s_add_u32 m0, s78, 20480
    v_lshl_add_u32 v108, v108, 8, v10
    buffer_load_dwordx4 v108, s[32:35], 0 offen lds
    v_mfma_f32_16x16x32_bf16 v[128:131], v[224:227], a[132:135], v[128:131]
    v_perm_b32 v216, v39, v35, s64
    v_perm_b32 v217, v47, v43, s64
    v_perm_b32 v218, v55, v51, s64
    v_mfma_f32_16x16x32_bf16 v[132:135], v[228:231], a[132:135], v[132:135]
    v_perm_b32 v219, v63, v59, s64
    v_perm_b32 v248, v71, v67, s64
    v_perm_b32 v249, v79, v75, s64
    v_mfma_f32_16x16x32_bf16 v[132:135], v[196:199], a[128:131], v[132:135]
    v_perm_b32 v250, v87, v83, s64
    v_perm_b32 v251, v95, v91, s64
    v_perm_b32 v252, v71, v67, s65
    ds_read_b128 a[144:147], v12 offset:4096
    v_mfma_f32_16x16x32_bf16 v[136:139], v[200:203], a[128:131], v[136:139]
    v_perm_b32 v253, v79, v75, s65
    v_perm_b32 v254, v87, v83, s65
    v_perm_b32 v255, v95, v91, s65
    s_waitcnt lgkmcnt(1)
    s_add_u32 m0, s78, 21504
    v_lshl_add_u32 v109, v109, 8, v11
    buffer_load_dwordx4 v109, s[32:35], 0 offen lds
    v_mfma_f32_16x16x32_bf16 v[136:139], v[232:235], a[132:135], v[136:139]
    v_perm_b32 v220, v39, v35, s65
    v_perm_b32 v221, v47, v43, s65
    v_perm_b32 v222, v55, v51, s65
    v_mfma_f32_16x16x32_bf16 v[140:143], v[236:239], a[132:135], v[140:143]
    v_perm_b32 v223, v63, v59, s65
    v_mfma_f32_16x16x32_bf16 v[140:143], v[204:207], a[128:131], v[140:143]
    v_mfma_f32_16x16x32_bf16 v[144:147], v[208:211], a[128:131], v[144:147]
    v_add_u32 v7, 1490944, v7
    buffer_load_dwordx4 v[32:35], v7, s[36:39], s56 offen
    v_mfma_f32_16x16x32_bf16 v[144:147], v[240:243], a[132:135], v[144:147]
    v_mfma_f32_16x16x32_bf16 v[148:151], v[244:247], a[132:135], v[148:151]
    ds_read_b128 a[148:151], v13 offset:4096
    v_mfma_f32_16x16x32_bf16 v[148:151], v[212:215], a[128:131], v[148:151]
    v_mfma_f32_16x16x32_bf16 v[152:155], v[216:219], a[128:131], v[152:155]
    buffer_load_dwordx4 v[36:39], v7, s[36:39], s57 offen
    v_mfma_f32_16x16x32_bf16 v[152:155], v[248:251], a[132:135], v[152:155]
    v_mfma_f32_16x16x32_bf16 v[156:159], v[252:255], a[132:135], v[156:159]
    v_mfma_f32_16x16x32_bf16 v[156:159], v[220:223], a[128:131], v[156:159]
    v_mfma_f32_16x16x32_bf16 v[160:163], v[192:195], a[136:139], v[160:163]
    buffer_load_dwordx4 v[40:43], v7, s[36:39], s58 offen
    v_mfma_f32_16x16x32_bf16 v[160:163], v[224:227], a[140:143], v[160:163]
    v_mfma_f32_16x16x32_bf16 v[164:167], v[228:231], a[140:143], v[164:167]
    v_mfma_f32_16x16x32_bf16 v[164:167], v[196:199], a[136:139], v[164:167]
    s_waitcnt vmcnt(17)
    ds_read_b128 a[152:155], v12 offset:6144
    v_mfma_f32_16x16x32_bf16 v[168:171], v[200:203], a[136:139], v[168:171]
    buffer_load_dwordx4 v[44:47], v7, s[36:39], s59 offen
    v_mfma_f32_16x16x32_bf16 v[168:171], v[232:235], a[140:143], v[168:171]
    v_mfma_f32_16x16x32_bf16 v[172:175], v[236:239], a[140:143], v[172:175]
    v_mfma_f32_16x16x32_bf16 v[172:175], v[204:207], a[136:139], v[172:175]
    v_mfma_f32_16x16x32_bf16 v[176:179], v[208:211], a[136:139], v[176:179]
    buffer_load_dwordx4 v[48:51], v7, s[36:39], s60 offen
    v_mfma_f32_16x16x32_bf16 v[176:179], v[240:243], a[140:143], v[176:179]
    v_mfma_f32_16x16x32_bf16 v[180:183], v[244:247], a[140:143], v[180:183]
    ds_read_b128 a[156:159], v13 offset:6144
    v_mfma_f32_16x16x32_bf16 v[180:183], v[212:215], a[136:139], v[180:183]
    v_mfma_f32_16x16x32_bf16 v[184:187], v[216:219], a[136:139], v[184:187]
    buffer_load_dwordx4 v[52:55], v7, s[36:39], s61 offen
    v_mfma_f32_16x16x32_bf16 v[184:187], v[248:251], a[140:143], v[184:187]
    v_mfma_f32_16x16x32_bf16 v[188:191], v[252:255], a[140:143], v[188:191]
    v_mfma_f32_16x16x32_bf16 v[188:191], v[220:223], a[136:139], v[188:191]
    s_waitcnt lgkmcnt(3)
    v_mfma_f32_16x16x32_bf16 a[192:195], v[192:195], a[144:147], a[192:195]
    buffer_load_dwordx4 v[56:59], v7, s[36:39], s62 offen
    s_waitcnt lgkmcnt(2)
    v_mfma_f32_16x16x32_bf16 a[192:195], v[224:227], a[148:151], a[192:195]
    v_mfma_f32_16x16x32_bf16 a[196:199], v[228:231], a[148:151], a[196:199]
    v_mfma_f32_16x16x32_bf16 a[196:199], v[196:199], a[144:147], a[196:199]
    s_waitcnt vmcnt(19)
    ds_read_b128 a[160:163], v12 offset:8192
    v_mfma_f32_16x16x32_bf16 a[200:203], v[200:203], a[144:147], a[200:203]
    buffer_load_dwordx4 v[60:63], v7, s[36:39], s63 offen
    v_mfma_f32_16x16x32_bf16 a[200:203], v[232:235], a[148:151], a[200:203]
    v_mfma_f32_16x16x32_bf16 a[204:207], v[236:239], a[148:151], a[204:207]
    v_mfma_f32_16x16x32_bf16 a[204:207], v[204:207], a[144:147], a[204:207]
    v_mfma_f32_16x16x32_bf16 a[208:211], v[208:211], a[144:147], a[208:211]
    v_add_u32 v7, 212992, v7
    buffer_load_dwordx4 v[64:67], v7, s[36:39], s56 offen
    v_mfma_f32_16x16x32_bf16 a[208:211], v[240:243], a[148:151], a[208:211]
    v_mfma_f32_16x16x32_bf16 a[212:215], v[244:247], a[148:151], a[212:215]
    ds_read_b128 a[164:167], v13 offset:8192
    v_mfma_f32_16x16x32_bf16 a[212:215], v[212:215], a[144:147], a[212:215]
    v_mfma_f32_16x16x32_bf16 a[216:219], v[216:219], a[144:147], a[216:219]
    buffer_load_dwordx4 v[68:71], v7, s[36:39], s57 offen
    v_mfma_f32_16x16x32_bf16 a[216:219], v[248:251], a[148:151], a[216:219]
    v_mfma_f32_16x16x32_bf16 a[220:223], v[252:255], a[148:151], a[220:223]
    v_mfma_f32_16x16x32_bf16 a[220:223], v[220:223], a[144:147], a[220:223]
    s_waitcnt lgkmcnt(3)
    v_mfma_f32_16x16x32_bf16 a[224:227], v[192:195], a[152:155], a[224:227]
    buffer_load_dwordx4 v[72:75], v7, s[36:39], s58 offen
    s_waitcnt lgkmcnt(2)
    v_mfma_f32_16x16x32_bf16 a[224:227], v[224:227], a[156:159], a[224:227]
    v_mfma_f32_16x16x32_bf16 a[228:231], v[228:231], a[156:159], a[228:231]
    v_mfma_f32_16x16x32_bf16 a[228:231], v[196:199], a[152:155], a[228:231]
    s_waitcnt vmcnt(21)
    ds_read_b128 a[168:171], v12 offset:10240
    v_mfma_f32_16x16x32_bf16 a[232:235], v[200:203], a[152:155], a[232:235]
    buffer_load_dwordx4 v[76:79], v7, s[36:39], s59 offen
    v_mfma_f32_16x16x32_bf16 a[232:235], v[232:235], a[156:159], a[232:235]
    v_mfma_f32_16x16x32_bf16 a[236:239], v[236:239], a[156:159], a[236:239]
    v_mfma_f32_16x16x32_bf16 a[236:239], v[204:207], a[152:155], a[236:239]
    v_mfma_f32_16x16x32_bf16 a[240:243], v[208:211], a[152:155], a[240:243]
    buffer_load_dwordx4 v[80:83], v7, s[36:39], s60 offen
    v_mfma_f32_16x16x32_bf16 a[240:243], v[240:243], a[156:159], a[240:243]
    v_mfma_f32_16x16x32_bf16 a[244:247], v[244:247], a[156:159], a[244:247]
    ds_read_b128 a[172:175], v13 offset:10240
    v_mfma_f32_16x16x32_bf16 a[244:247], v[212:215], a[152:155], a[244:247]
    v_mfma_f32_16x16x32_bf16 a[248:251], v[216:219], a[152:155], a[248:251]
    buffer_load_dwordx4 v[84:87], v7, s[36:39], s61 offen
    v_mfma_f32_16x16x32_bf16 a[248:251], v[248:251], a[156:159], a[248:251]
    v_mfma_f32_16x16x32_bf16 a[252:255], v[252:255], a[156:159], a[252:255]
    v_mfma_f32_16x16x32_bf16 a[252:255], v[220:223], a[152:155], a[252:255]
    s_waitcnt lgkmcnt(3)
    v_mfma_f32_16x16x32_bf16 a[0:3], v[192:195], a[160:163], a[0:3]
    buffer_load_dwordx4 v[88:91], v7, s[36:39], s62 offen
    s_waitcnt lgkmcnt(2)
    v_mfma_f32_16x16x32_bf16 a[0:3], v[224:227], a[164:167], a[0:3]
    v_mfma_f32_16x16x32_bf16 a[4:7], v[228:231], a[164:167], a[4:7]
    ds_read_b32 v110, v97 offset:1752
    v_mfma_f32_16x16x32_bf16 a[4:7], v[196:199], a[160:163], a[4:7]
    s_waitcnt vmcnt(23)
    ds_read_b128 a[176:179], v12 offset:12288
    v_mfma_f32_16x16x32_bf16 a[8:11], v[200:203], a[160:163], a[8:11]
    buffer_load_dwordx4 v[92:95], v7, s[36:39], s63 offen
    v_mfma_f32_16x16x32_bf16 a[8:11], v[232:235], a[164:167], a[8:11]
    v_mfma_f32_16x16x32_bf16 a[12:15], v[236:239], a[164:167], a[12:15]
    ds_read_b32 v111, v97 offset:2584
    v_mfma_f32_16x16x32_bf16 a[12:15], v[204:207], a[160:163], a[12:15]
    v_mfma_f32_16x16x32_bf16 a[16:19], v[208:211], a[160:163], a[16:19]
    s_waitcnt lgkmcnt(2)
    s_add_u32 m0, s78, 22528
    v_lshl_add_u32 v110, v110, 8, v10
    buffer_load_dwordx4 v110, s[32:35], 0 offen lds
    v_mfma_f32_16x16x32_bf16 a[16:19], v[240:243], a[164:167], a[16:19]
    v_mfma_f32_16x16x32_bf16 a[20:23], v[244:247], a[164:167], a[20:23]
    ds_read_b32 v112, v98 offset:88
    ds_read_b128 a[180:183], v13 offset:12288
    v_mfma_f32_16x16x32_bf16 a[20:23], v[212:215], a[160:163], a[20:23]
    v_mfma_f32_16x16x32_bf16 a[24:27], v[216:219], a[160:163], a[24:27]
    s_waitcnt lgkmcnt(2)
    s_add_u32 m0, s78, 23552
    v_lshl_add_u32 v111, v111, 8, v11
    buffer_load_dwordx4 v111, s[32:35], 0 offen lds
    v_mfma_f32_16x16x32_bf16 a[24:27], v[248:251], a[164:167], a[24:27]
    v_mfma_f32_16x16x32_bf16 a[28:31], v[252:255], a[164:167], a[28:31]
    ds_read_b32 v113, v98 offset:920
    v_mfma_f32_16x16x32_bf16 a[28:31], v[220:223], a[160:163], a[28:31]
    v_mfma_f32_16x16x32_bf16 a[32:35], v[192:195], a[168:171], a[32:35]
    s_waitcnt lgkmcnt(2)
    s_add_u32 m0, s78, 24576
    v_lshl_add_u32 v112, v112, 8, v10
    buffer_load_dwordx4 v112, s[32:35], 0 offen lds
    v_mfma_f32_16x16x32_bf16 a[32:35], v[224:227], a[172:175], a[32:35]
    v_mfma_f32_16x16x32_bf16 a[36:39], v[228:231], a[172:175], a[36:39]
    ds_read_b32 v114, v98 offset:1752
    v_mfma_f32_16x16x32_bf16 a[36:39], v[196:199], a[168:171], a[36:39]
    s_waitcnt vmcnt(25)
    ds_read_b128 a[184:187], v12 offset:14336
    v_mfma_f32_16x16x32_bf16 a[40:43], v[200:203], a[168:171], a[40:43]
    s_waitcnt lgkmcnt(2)
    s_add_u32 m0, s78, 25600
    v_lshl_add_u32 v113, v113, 8, v11
    buffer_load_dwordx4 v113, s[32:35], 0 offen lds
    v_mfma_f32_16x16x32_bf16 a[40:43], v[232:235], a[172:175], a[40:43]
    v_mfma_f32_16x16x32_bf16 a[44:47], v[236:239], a[172:175], a[44:47]
    ds_read_b32 v115, v98 offset:2584
    v_mfma_f32_16x16x32_bf16 a[44:47], v[204:207], a[168:171], a[44:47]
    v_mfma_f32_16x16x32_bf16 a[48:51], v[208:211], a[168:171], a[48:51]
    s_waitcnt lgkmcnt(2)
    s_add_u32 m0, s78, 26624
    v_lshl_add_u32 v114, v114, 8, v10
    buffer_load_dwordx4 v114, s[32:35], 0 offen lds
    v_mfma_f32_16x16x32_bf16 a[48:51], v[240:243], a[172:175], a[48:51]
    v_mfma_f32_16x16x32_bf16 a[52:55], v[244:247], a[172:175], a[52:55]
    ds_read_b32 v116, v99 offset:88
    ds_read_b128 a[188:191], v13 offset:14336
    v_mfma_f32_16x16x32_bf16 a[52:55], v[212:215], a[168:171], a[52:55]
    v_mfma_f32_16x16x32_bf16 a[56:59], v[216:219], a[168:171], a[56:59]
    s_waitcnt lgkmcnt(2)
    s_add_u32 m0, s78, 27648
    v_lshl_add_u32 v115, v115, 8, v11
    buffer_load_dwordx4 v115, s[32:35], 0 offen lds
    v_mfma_f32_16x16x32_bf16 a[56:59], v[248:251], a[172:175], a[56:59]
    v_mfma_f32_16x16x32_bf16 a[60:63], v[252:255], a[172:175], a[60:63]
    ds_read_b32 v117, v99 offset:920
    v_mfma_f32_16x16x32_bf16 a[60:63], v[220:223], a[168:171], a[60:63]
    v_mfma_f32_16x16x32_bf16 a[64:67], v[192:195], a[176:179], a[64:67]
    s_waitcnt lgkmcnt(2)
    s_add_u32 m0, s78, 28672
    v_lshl_add_u32 v116, v116, 8, v10
    buffer_load_dwordx4 v116, s[32:35], 0 offen lds
    v_mfma_f32_16x16x32_bf16 a[64:67], v[224:227], a[180:183], a[64:67]
    v_mfma_f32_16x16x32_bf16 a[68:71], v[228:231], a[180:183], a[68:71]
    ds_read_b32 v118, v99 offset:1752
    v_mfma_f32_16x16x32_bf16 a[68:71], v[196:199], a[176:179], a[68:71]
    s_waitcnt vmcnt(27)
    ds_read_b128 a[128:131], v12 offset:16384
    v_mfma_f32_16x16x32_bf16 a[72:75], v[200:203], a[176:179], a[72:75]
    s_waitcnt lgkmcnt(2)
    s_add_u32 m0, s78, 29696
    v_lshl_add_u32 v117, v117, 8, v11
    buffer_load_dwordx4 v117, s[32:35], 0 offen lds
    v_mfma_f32_16x16x32_bf16 a[72:75], v[232:235], a[180:183], a[72:75]
    v_mfma_f32_16x16x32_bf16 a[76:79], v[236:239], a[180:183], a[76:79]
    ds_read_b32 v119, v99 offset:2584
    v_mfma_f32_16x16x32_bf16 a[76:79], v[204:207], a[176:179], a[76:79]
    v_mfma_f32_16x16x32_bf16 a[80:83], v[208:211], a[176:179], a[80:83]
    s_waitcnt lgkmcnt(2)
    s_add_u32 m0, s78, 30720
    v_lshl_add_u32 v118, v118, 8, v10
    buffer_load_dwordx4 v118, s[32:35], 0 offen lds
    v_mfma_f32_16x16x32_bf16 a[80:83], v[240:243], a[180:183], a[80:83]
    v_mfma_f32_16x16x32_bf16 a[84:87], v[244:247], a[180:183], a[84:87]
    ds_read_b32 v108, v97 offset:96
    ds_read_b128 a[132:135], v13 offset:16384
    s_getpc_b64 s[74:75]
L_pc2:
    s_add_u32 s74, s74, L_tailcode-L_pc2
    s_addc_u32 s75, s75, 0
    v_lshlrev_b32 v1, 7, v0
    global_load_dword v15, v1, s[74:75]
    v_mfma_f32_16x16x32_bf16 a[84:87], v[212:215], a[176:179], a[84:87]
    v_mfma_f32_16x16x32_bf16 a[88:91], v[216:219], a[176:179], a[88:91]
    s_waitcnt lgkmcnt(2)
    s_add_u32 m0, s78, 31744
    v_lshl_add_u32 v119, v119, 8, v11
    buffer_load_dwordx4 v119, s[32:35], 0 offen lds
    v_mfma_f32_16x16x32_bf16 a[88:91], v[248:251], a[180:183], a[88:91]
    v_mfma_f32_16x16x32_bf16 a[92:95], v[252:255], a[180:183], a[92:95]
    ds_read_b32 v109, v97 offset:928
    v_mfma_f32_16x16x32_bf16 a[92:95], v[220:223], a[176:179], a[92:95]
    v_mfma_f32_16x16x32_bf16 a[96:99], v[192:195], a[184:187], a[96:99]
    s_waitcnt lgkmcnt(2)
    s_add_u32 m0, s78, 4096
    v_lshl_add_u32 v108, v108, 8, v10
    buffer_load_dwordx4 v108, s[32:35], 0 offen lds
    v_mfma_f32_16x16x32_bf16 a[96:99], v[224:227], a[188:191], a[96:99]
    s_waitcnt vmcnt(20)
    v_perm_b32 v192, v36, v32, s64
    v_perm_b32 v193, v44, v40, s64
    v_perm_b32 v194, v52, v48, s64
    v_mfma_f32_16x16x32_bf16 a[100:103], v[228:231], a[188:191], a[100:103]
    v_perm_b32 v195, v60, v56, s64
    s_waitcnt vmcnt(12)
    v_perm_b32 v224, v68, v64, s64
    v_perm_b32 v225, v76, v72, s64
    ds_read_b32 v112, v98 offset:96
    v_mfma_f32_16x16x32_bf16 a[100:103], v[196:199], a[184:187], a[100:103]
    v_perm_b32 v226, v84, v80, s64
    v_perm_b32 v227, v92, v88, s64
    v_perm_b32 v228, v68, v64, s65
    ds_read_b128 a[136:139], v12 offset:18432
    v_mfma_f32_16x16x32_bf16 a[104:107], v[200:203], a[184:187], a[104:107]
    v_perm_b32 v229, v76, v72, s65
    v_perm_b32 v230, v84, v80, s65
    v_perm_b32 v231, v92, v88, s65
    s_waitcnt lgkmcnt(2)
    s_add_u32 m0, s78, 5120
    v_lshl_add_u32 v109, v109, 8, v11
    buffer_load_dwordx4 v109, s[32:35], 0 offen lds
    v_mfma_f32_16x16x32_bf16 a[104:107], v[232:235], a[188:191], a[104:107]
    v_perm_b32 v196, v36, v32, s65
    v_perm_b32 v197, v44, v40, s65
    v_perm_b32 v198, v52, v48, s65
    v_mfma_f32_16x16x32_bf16 a[108:111], v[236:239], a[188:191], a[108:111]
    v_perm_b32 v199, v60, v56, s65
    v_perm_b32 v200, v37, v33, s64
    v_perm_b32 v201, v45, v41, s64
    ds_read_b32 v113, v98 offset:928
    v_mfma_f32_16x16x32_bf16 a[108:111], v[204:207], a[184:187], a[108:111]
    v_perm_b32 v202, v53, v49, s64
    v_perm_b32 v203, v61, v57, s64
    v_perm_b32 v232, v69, v65, s64
    v_mfma_f32_16x16x32_bf16 a[112:115], v[208:211], a[184:187], a[112:115]
    v_perm_b32 v233, v77, v73, s64
    v_perm_b32 v234, v85, v81, s64
    v_perm_b32 v235, v93, v89, s64
    s_waitcnt lgkmcnt(2)
    s_add_u32 m0, s78, 8192
    v_lshl_add_u32 v112, v112, 8, v10
    buffer_load_dwordx4 v112, s[32:35], 0 offen lds
    v_mfma_f32_16x16x32_bf16 a[112:115], v[240:243], a[188:191], a[112:115]
    v_perm_b32 v236, v69, v65, s65
    v_perm_b32 v237, v77, v73, s65
    v_perm_b32 v238, v85, v81, s65
    v_mfma_f32_16x16x32_bf16 a[116:119], v[244:247], a[188:191], a[116:119]
    v_perm_b32 v239, v93, v89, s65
    v_perm_b32 v204, v37, v33, s65
    v_perm_b32 v205, v45, v41, s65
    ds_read_b32 v116, v99 offset:96
    ds_read_b128 a[140:143], v13 offset:18432
    v_mfma_f32_16x16x32_bf16 a[116:119], v[212:215], a[184:187], a[116:119]
    v_perm_b32 v206, v53, v49, s65
    v_perm_b32 v207, v61, v57, s65
    v_perm_b32 v208, v38, v34, s64
    v_mfma_f32_16x16x32_bf16 a[120:123], v[216:219], a[184:187], a[120:123]
    v_perm_b32 v209, v46, v42, s64
    v_perm_b32 v210, v54, v50, s64
    v_perm_b32 v211, v62, v58, s64
    s_waitcnt lgkmcnt(2)
    s_add_u32 m0, s78, 9216
    v_lshl_add_u32 v113, v113, 8, v11
    buffer_load_dwordx4 v113, s[32:35], 0 offen lds
    v_mfma_f32_16x16x32_bf16 a[120:123], v[248:251], a[188:191], a[120:123]
    v_perm_b32 v240, v70, v66, s64
    v_perm_b32 v241, v78, v74, s64
    v_perm_b32 v242, v86, v82, s64
    v_mfma_f32_16x16x32_bf16 a[124:127], v[252:255], a[188:191], a[124:127]
    v_perm_b32 v243, v94, v90, s64
    v_perm_b32 v244, v70, v66, s65
    v_perm_b32 v245, v78, v74, s65
    ds_read_b32 v117, v99 offset:928
    v_mfma_f32_16x16x32_bf16 a[124:127], v[220:223], a[184:187], a[124:127]
    v_perm_b32 v246, v86, v82, s65
    v_perm_b32 v247, v94, v90, s65
    v_perm_b32 v212, v38, v34, s65
    v_mfma_f32_16x16x32_bf16 v[128:131], v[192:195], a[128:131], v[128:131]
    v_perm_b32 v213, v46, v42, s65
    v_perm_b32 v214, v54, v50, s65
    v_perm_b32 v215, v62, v58, s65
    s_waitcnt lgkmcnt(2)
    s_add_u32 m0, s78, 12288
    v_lshl_add_u32 v116, v116, 8, v10
    buffer_load_dwordx4 v116, s[32:35], 0 offen lds
    v_mfma_f32_16x16x32_bf16 v[128:131], v[224:227], a[132:135], v[128:131]
    v_perm_b32 v216, v39, v35, s64
    v_perm_b32 v217, v47, v43, s64
    v_perm_b32 v218, v55, v51, s64
    v_mfma_f32_16x16x32_bf16 v[132:135], v[228:231], a[132:135], v[132:135]
    v_perm_b32 v219, v63, v59, s64
    v_perm_b32 v248, v71, v67, s64
    v_perm_b32 v249, v79, v75, s64
    v_mfma_f32_16x16x32_bf16 v[132:135], v[196:199], a[128:131], v[132:135]
    v_perm_b32 v250, v87, v83, s64
    v_perm_b32 v251, v95, v91, s64
    v_perm_b32 v252, v71, v67, s65
    ds_read_b128 a[144:147], v12 offset:20480
    v_mfma_f32_16x16x32_bf16 v[136:139], v[200:203], a[128:131], v[136:139]
    v_perm_b32 v253, v79, v75, s65
    v_perm_b32 v254, v87, v83, s65
    v_perm_b32 v255, v95, v91, s65
    s_waitcnt lgkmcnt(1)
    s_add_u32 m0, s78, 13312
    v_lshl_add_u32 v117, v117, 8, v11
    buffer_load_dwordx4 v117, s[32:35], 0 offen lds
    v_mfma_f32_16x16x32_bf16 v[136:139], v[232:235], a[132:135], v[136:139]
    v_perm_b32 v220, v39, v35, s65
    v_perm_b32 v221, v47, v43, s65
    v_perm_b32 v222, v55, v51, s65
    v_mfma_f32_16x16x32_bf16 v[140:143], v[236:239], a[132:135], v[140:143]
    v_perm_b32 v223, v63, v59, s65
    v_mfma_f32_16x16x32_bf16 v[140:143], v[204:207], a[128:131], v[140:143]
    v_mfma_f32_16x16x32_bf16 v[144:147], v[208:211], a[128:131], v[144:147]
    v_add_u32 v7, 1490944, v7
    buffer_load_dwordx4 v[32:35], v7, s[36:39], s56 offen
    v_mfma_f32_16x16x32_bf16 v[144:147], v[240:243], a[132:135], v[144:147]
    v_mfma_f32_16x16x32_bf16 v[148:151], v[244:247], a[132:135], v[148:151]
    ds_read_b128 a[148:151], v13 offset:20480
    v_mfma_f32_16x16x32_bf16 v[148:151], v[212:215], a[128:131], v[148:151]
    v_mfma_f32_16x16x32_bf16 v[152:155], v[216:219], a[128:131], v[152:155]
    buffer_load_dwordx4 v[36:39], v7, s[36:39], s57 offen
    v_mfma_f32_16x16x32_bf16 v[152:155], v[248:251], a[132:135], v[152:155]
    v_mfma_f32_16x16x32_bf16 v[156:159], v[252:255], a[132:135], v[156:159]
    v_mfma_f32_16x16x32_bf16 v[156:159], v[220:223], a[128:131], v[156:159]
    v_mfma_f32_16x16x32_bf16 v[160:163], v[192:195], a[136:139], v[160:163]
    buffer_load_dwordx4 v[40:43], v7, s[36:39], s58 offen
    v_mfma_f32_16x16x32_bf16 v[160:163], v[224:227], a[140:143], v[160:163]
    v_mfma_f32_16x16x32_bf16 v[164:167], v[228:231], a[140:143], v[164:167]
    v_mfma_f32_16x16x32_bf16 v[164:167], v[196:199], a[136:139], v[164:167]
    s_waitcnt vmcnt(18)
    ds_read_b128 a[152:155], v12 offset:22528
    v_mfma_f32_16x16x32_bf16 v[168:171], v[200:203], a[136:139], v[168:171]
    buffer_load_dwordx4 v[44:47], v7, s[36:39], s59 offen
    v_mfma_f32_16x16x32_bf16 v[168:171], v[232:235], a[140:143], v[168:171]
    v_mfma_f32_16x16x32_bf16 v[172:175], v[236:239], a[140:143], v[172:175]
    v_mfma_f32_16x16x32_bf16 v[172:175], v[204:207], a[136:139], v[172:175]
    v_mfma_f32_16x16x32_bf16 v[176:179], v[208:211], a[136:139], v[176:179]
    buffer_load_dwordx4 v[48:51], v7, s[36:39], s60 offen
    v_mfma_f32_16x16x32_bf16 v[176:179], v[240:243], a[140:143], v[176:179]
    v_mfma_f32_16x16x32_bf16 v[180:183], v[244:247], a[140:143], v[180:183]
    ds_read_b128 a[156:159], v13 offset:22528
    v_mfma_f32_16x16x32_bf16 v[180:183], v[212:215], a[136:139], v[180:183]
    v_mfma_f32_16x16x32_bf16 v[184:187], v[216:219], a[136:139], v[184:187]
    buffer_load_dwordx4 v[52:55], v7, s[36:39], s61 offen
    v_mfma_f32_16x16x32_bf16 v[184:187], v[248:251], a[140:143], v[184:187]
    v_mfma_f32_16x16x32_bf16 v[188:191], v[252:255], a[140:143], v[188:191]
    v_mfma_f32_16x16x32_bf16 v[188:191], v[220:223], a[136:139], v[188:191]
    s_waitcnt lgkmcnt(3)
    v_mfma_f32_16x16x32_bf16 a[192:195], v[192:195], a[144:147], a[192:195]
    buffer_load_dwordx4 v[56:59], v7, s[36:39], s62 offen
    s_waitcnt lgkmcnt(2)
    v_mfma_f32_16x16x32_bf16 a[192:195], v[224:227], a[148:151], a[192:195]
    v_mfma_f32_16x16x32_bf16 a[196:199], v[228:231], a[148:151], a[196:199]
    v_mfma_f32_16x16x32_bf16 a[196:199], v[196:199], a[144:147], a[196:199]
    s_waitcnt vmcnt(20)
    ds_read_b128 a[160:163], v12 offset:24576
    v_mfma_f32_16x16x32_bf16 a[200:203], v[200:203], a[144:147], a[200:203]
    buffer_load_dwordx4 v[60:63], v7, s[36:39], s63 offen
    v_mfma_f32_16x16x32_bf16 a[200:203], v[232:235], a[148:151], a[200:203]
    v_mfma_f32_16x16x32_bf16 a[204:207], v[236:239], a[148:151], a[204:207]
    v_mfma_f32_16x16x32_bf16 a[204:207], v[204:207], a[144:147], a[204:207]
    v_mfma_f32_16x16x32_bf16 a[208:211], v[208:211], a[144:147], a[208:211]
    v_add_u32 v7, 212992, v7
    buffer_load_dwordx4 v[64:67], v7, s[36:39], s56 offen
    v_mfma_f32_16x16x32_bf16 a[208:211], v[240:243], a[148:151], a[208:211]
    v_mfma_f32_16x16x32_bf16 a[212:215], v[244:247], a[148:151], a[212:215]
    ds_read_b128 a[164:167], v13 offset:24576
    v_mfma_f32_16x16x32_bf16 a[212:215], v[212:215], a[144:147], a[212:215]
    v_mfma_f32_16x16x32_bf16 a[216:219], v[216:219], a[144:147], a[216:219]
    buffer_load_dwordx4 v[68:71], v7, s[36:39], s57 offen
    v_mfma_f32_16x16x32_bf16 a[216:219], v[248:251], a[148:151], a[216:219]
    v_mfma_f32_16x16x32_bf16 a[220:223], v[252:255], a[148:151], a[220:223]
    v_mfma_f32_16x16x32_bf16 a[220:223], v[220:223], a[144:147], a[220:223]
    s_waitcnt lgkmcnt(3)
    v_mfma_f32_16x16x32_bf16 a[224:227], v[192:195], a[152:155], a[224:227]
    buffer_load_dwordx4 v[72:75], v7, s[36:39], s58 offen
    s_waitcnt lgkmcnt(2)
    v_mfma_f32_16x16x32_bf16 a[224:227], v[224:227], a[156:159], a[224:227]
    v_mfma_f32_16x16x32_bf16 a[228:231], v[228:231], a[156:159], a[228:231]
    v_mfma_f32_16x16x32_bf16 a[228:231], v[196:199], a[152:155], a[228:231]
    s_waitcnt vmcnt(22)
    ds_read_b128 a[168:171], v12 offset:26624
    v_mfma_f32_16x16x32_bf16 a[232:235], v[200:203], a[152:155], a[232:235]
    buffer_load_dwordx4 v[76:79], v7, s[36:39], s59 offen
    v_mfma_f32_16x16x32_bf16 a[232:235], v[232:235], a[156:159], a[232:235]
    v_mfma_f32_16x16x32_bf16 a[236:239], v[236:239], a[156:159], a[236:239]
    v_mfma_f32_16x16x32_bf16 a[236:239], v[204:207], a[152:155], a[236:239]
    v_mfma_f32_16x16x32_bf16 a[240:243], v[208:211], a[152:155], a[240:243]
    buffer_load_dwordx4 v[80:83], v7, s[36:39], s60 offen
    v_mfma_f32_16x16x32_bf16 a[240:243], v[240:243], a[156:159], a[240:243]
    v_mfma_f32_16x16x32_bf16 a[244:247], v[244:247], a[156:159], a[244:247]
    ds_read_b128 a[172:175], v13 offset:26624
    v_mfma_f32_16x16x32_bf16 a[244:247], v[212:215], a[152:155], a[244:247]
    v_mfma_f32_16x16x32_bf16 a[248:251], v[216:219], a[152:155], a[248:251]
    buffer_load_dwordx4 v[84:87], v7, s[36:39], s61 offen
    v_mfma_f32_16x16x32_bf16 a[248:251], v[248:251], a[156:159], a[248:251]
    v_mfma_f32_16x16x32_bf16 a[252:255], v[252:255], a[156:159], a[252:255]
    v_mfma_f32_16x16x32_bf16 a[252:255], v[220:223], a[152:155], a[252:255]
    s_waitcnt lgkmcnt(3)
    v_mfma_f32_16x16x32_bf16 a[0:3], v[192:195], a[160:163], a[0:3]
    buffer_load_dwordx4 v[88:91], v7, s[36:39], s62 offen
    s_waitcnt lgkmcnt(2)
    v_mfma_f32_16x16x32_bf16 a[0:3], v[224:227], a[164:167], a[0:3]
    v_mfma_f32_16x16x32_bf16 a[4:7], v[228:231], a[164:167], a[4:7]
    ds_read_b32 v110, v97 offset:1760
    v_mfma_f32_16x16x32_bf16 a[4:7], v[196:199], a[160:163], a[4:7]
    s_waitcnt vmcnt(24)
    ds_read_b128 a[176:179], v12 offset:28672
    v_mfma_f32_16x16x32_bf16 a[8:11], v[200:203], a[160:163], a[8:11]
    buffer_load_dwordx4 v[92:95], v7, s[36:39], s63 offen
    v_mfma_f32_16x16x32_bf16 a[8:11], v[232:235], a[164:167], a[8:11]
    v_mfma_f32_16x16x32_bf16 a[12:15], v[236:239], a[164:167], a[12:15]
    ds_read_b32 v111, v97 offset:2592
    v_mfma_f32_16x16x32_bf16 a[12:15], v[204:207], a[160:163], a[12:15]
    v_mfma_f32_16x16x32_bf16 a[16:19], v[208:211], a[160:163], a[16:19]
    s_waitcnt lgkmcnt(2)
    s_add_u32 m0, s78, 6144
    v_lshl_add_u32 v110, v110, 8, v10
    buffer_load_dwordx4 v110, s[32:35], 0 offen lds
    v_mfma_f32_16x16x32_bf16 a[16:19], v[240:243], a[164:167], a[16:19]
    v_mfma_f32_16x16x32_bf16 a[20:23], v[244:247], a[164:167], a[20:23]
    ds_read_b32 v104, v96 offset:96
    ds_read_b128 a[180:183], v13 offset:28672
    v_mfma_f32_16x16x32_bf16 a[20:23], v[212:215], a[160:163], a[20:23]
    v_mfma_f32_16x16x32_bf16 a[24:27], v[216:219], a[160:163], a[24:27]
    s_waitcnt lgkmcnt(2)
    s_add_u32 m0, s78, 7168
    v_lshl_add_u32 v111, v111, 8, v11
    buffer_load_dwordx4 v111, s[32:35], 0 offen lds
    v_mfma_f32_16x16x32_bf16 a[24:27], v[248:251], a[164:167], a[24:27]
    v_mfma_f32_16x16x32_bf16 a[28:31], v[252:255], a[164:167], a[28:31]
    ds_read_b32 v105, v96 offset:928
    v_mfma_f32_16x16x32_bf16 a[28:31], v[220:223], a[160:163], a[28:31]
    v_mfma_f32_16x16x32_bf16 a[32:35], v[192:195], a[168:171], a[32:35]
    s_waitcnt lgkmcnt(2)
    s_add_u32 m0, s78, 0
    v_lshl_add_u32 v104, v104, 8, v10
    buffer_load_dwordx4 v104, s[32:35], 0 offen lds
    v_mfma_f32_16x16x32_bf16 a[32:35], v[224:227], a[172:175], a[32:35]
    v_mfma_f32_16x16x32_bf16 a[36:39], v[228:231], a[172:175], a[36:39]
    ds_read_b32 v114, v98 offset:1760
    v_mfma_f32_16x16x32_bf16 a[36:39], v[196:199], a[168:171], a[36:39]
    s_waitcnt vmcnt(25)
    ds_read_b128 a[184:187], v12 offset:30720
    v_mfma_f32_16x16x32_bf16 a[40:43], v[200:203], a[168:171], a[40:43]
    s_waitcnt lgkmcnt(2)
    s_add_u32 m0, s78, 1024
    v_lshl_add_u32 v105, v105, 8, v11
    buffer_load_dwordx4 v105, s[32:35], 0 offen lds
    v_mfma_f32_16x16x32_bf16 a[40:43], v[232:235], a[172:175], a[40:43]
    v_mfma_f32_16x16x32_bf16 a[44:47], v[236:239], a[172:175], a[44:47]
    ds_read_b32 v115, v98 offset:2592
    v_mfma_f32_16x16x32_bf16 a[44:47], v[204:207], a[168:171], a[44:47]
    v_mfma_f32_16x16x32_bf16 a[48:51], v[208:211], a[168:171], a[48:51]
    s_waitcnt lgkmcnt(2)
    s_add_u32 m0, s78, 10240
    v_lshl_add_u32 v114, v114, 8, v10
    buffer_load_dwordx4 v114, s[32:35], 0 offen lds
    v_mfma_f32_16x16x32_bf16 a[48:51], v[240:243], a[172:175], a[48:51]
    v_mfma_f32_16x16x32_bf16 a[52:55], v[244:247], a[172:175], a[52:55]
    ds_read_b32 v118, v99 offset:1760
    ds_read_b128 a[188:191], v13 offset:30720
    v_mfma_f32_16x16x32_bf16 a[52:55], v[212:215], a[168:171], a[52:55]
    v_mfma_f32_16x16x32_bf16 a[56:59], v[216:219], a[168:171], a[56:59]
    s_waitcnt lgkmcnt(2)
    s_add_u32 m0, s78, 11264
    v_lshl_add_u32 v115, v115, 8, v11
    buffer_load_dwordx4 v115, s[32:35], 0 offen lds
    v_mfma_f32_16x16x32_bf16 a[56:59], v[248:251], a[172:175], a[56:59]
    v_mfma_f32_16x16x32_bf16 a[60:63], v[252:255], a[172:175], a[60:63]
    ds_read_b32 v119, v99 offset:2592
    v_mfma_f32_16x16x32_bf16 a[60:63], v[220:223], a[168:171], a[60:63]
    v_mfma_f32_16x16x32_bf16 a[64:67], v[192:195], a[176:179], a[64:67]
    s_waitcnt lgkmcnt(2)
    s_add_u32 m0, s78, 14336
    v_lshl_add_u32 v118, v118, 8, v10
    buffer_load_dwordx4 v118, s[32:35], 0 offen lds
    v_mfma_f32_16x16x32_bf16 a[64:67], v[224:227], a[180:183], a[64:67]
    v_mfma_f32_16x16x32_bf16 a[68:71], v[228:231], a[180:183], a[68:71]
    ds_read_b32 v106, v96 offset:1760
    v_mfma_f32_16x16x32_bf16 a[68:71], v[196:199], a[176:179], a[68:71]
    s_waitcnt vmcnt(27)
    ds_read_b128 a[128:131], v12 offset:4096
    v_mfma_f32_16x16x32_bf16 a[72:75], v[200:203], a[176:179], a[72:75]
    s_waitcnt lgkmcnt(2)
    s_add_u32 m0, s78, 15360
    v_lshl_add_u32 v119, v119, 8, v11
    buffer_load_dwordx4 v119, s[32:35], 0 offen lds
    v_mfma_f32_16x16x32_bf16 a[72:75], v[232:235], a[180:183], a[72:75]
    v_mfma_f32_16x16x32_bf16 a[76:79], v[236:239], a[180:183], a[76:79]
    ds_read_b32 v107, v96 offset:2592
    v_mfma_f32_16x16x32_bf16 a[76:79], v[204:207], a[176:179], a[76:79]
    v_mfma_f32_16x16x32_bf16 a[80:83], v[208:211], a[176:179], a[80:83]
    s_waitcnt lgkmcnt(2)
    s_add_u32 m0, s78, 2048
    v_lshl_add_u32 v106, v106, 8, v10
    buffer_load_dwordx4 v106, s[32:35], 0 offen lds
    v_mfma_f32_16x16x32_bf16 a[80:83], v[240:243], a[180:183], a[80:83]
    v_mfma_f32_16x16x32_bf16 a[84:87], v[244:247], a[180:183], a[84:87]
    ds_read_b128 a[132:135], v13 offset:4096
    v_mfma_f32_16x16x32_bf16 a[84:87], v[212:215], a[176:179], a[84:87]
    v_mfma_f32_16x16x32_bf16 a[88:91], v[216:219], a[176:179], a[88:91]
    s_waitcnt lgkmcnt(1)
    s_add_u32 m0, s78, 3072
    v_lshl_add_u32 v107, v107, 8, v11
    buffer_load_dwordx4 v107, s[32:35], 0 offen lds
    v_lshrrev_b32 v14, 4, v0
    s_lshl_b32 s71, s68, 8
    v_lshlrev_b32 v2, 6, v14
    v_add_u32 v2, s71, v2
    buffer_load_dwordx4 v[16:19], v2, s[44:47], 0 offen offset:0
    buffer_load_dwordx4 v[20:23], v2, s[44:47], 0 offen offset:16
    buffer_load_dwordx4 v[24:27], v2, s[44:47], 0 offen offset:32
    buffer_load_dwordx4 v[28:31], v2, s[44:47], 0 offen offset:48
    s_mov_b32 s52, s22
    s_mov_b32 s53, s23
    s_mov_b32 s54, 256
    s_mov_b32 s55, 0x00020000
    v_lshlrev_b32 v9, 2, v0
    v_add_u32 v9, 64, v9
    buffer_load_dword v8, v9, s[52:55], 0 offen sc1
    v_lshlrev_b32 v1, 4, v0
    s_add_u32 s70, s66, 4
    s_and_b32 s70, s70, 3
    s_lshl_b32 s70, s70, 15
    v_add_u32 v2, s70, v1
    s_add_u32 s70, s66, 3
    s_and_b32 s70, s70, 3
    s_lshl_b32 s70, s70, 15
    v_add_u32 v3, s70, v1
    s_add_u32 s70, s66, 2
    s_and_b32 s70, s70, 3
    s_lshl_b32 s70, s70, 15
    v_add_u32 v4, s70, v1
    s_add_u32 s70, s66, 1
    s_and_b32 s70, s70, 3
    s_lshl_b32 s70, s70, 15
    v_add_u32 v5, s70, v1
    v_mfma_f32_16x16x32_bf16 a[88:91], v[248:251], a[180:183], a[88:91]
    v_mfma_f32_16x16x32_bf16 a[92:95], v[252:255], a[180:183], a[92:95]
    v_mfma_f32_16x16x32_bf16 a[92:95], v[220:223], a[176:179], a[92:95]
    v_mfma_f32_16x16x32_bf16 a[96:99], v[192:195], a[184:187], a[96:99]
    v_mfma_f32_16x16x32_bf16 a[96:99], v[224:227], a[188:191], a[96:99]
    s_waitcnt vmcnt(23)
    v_perm_b32 v192, v36, v32, s64
    v_perm_b32 v193, v44, v40, s64
    v_perm_b32 v194, v52, v48, s64
    v_mfma_f32_16x16x32_bf16 a[100:103], v[228:231], a[188:191], a[100:103]
    v_perm_b32 v195, v60, v56, s64
    s_waitcnt vmcnt(15)
    v_perm_b32 v224, v68, v64, s64
    v_perm_b32 v225, v76, v72, s64
    v_mfma_f32_16x16x32_bf16 a[100:103], v[196:199], a[184:187], a[100:103]
    v_perm_b32 v226, v84, v80, s64
    v_perm_b32 v227, v92, v88, s64
    v_perm_b32 v228, v68, v64, s65
    ds_read_b128 a[136:139], v12 offset:8192
    v_mfma_f32_16x16x32_bf16 a[104:107], v[200:203], a[184:187], a[104:107]
    v_perm_b32 v229, v76, v72, s65
    v_perm_b32 v230, v84, v80, s65
    v_perm_b32 v231, v92, v88, s65
    v_mfma_f32_16x16x32_bf16 a[104:107], v[232:235], a[188:191], a[104:107]
    v_perm_b32 v196, v36, v32, s65
    v_perm_b32 v197, v44, v40, s65
    v_perm_b32 v198, v52, v48, s65
    v_mfma_f32_16x16x32_bf16 a[108:111], v[236:239], a[188:191], a[108:111]
    v_perm_b32 v199, v60, v56, s65
    v_perm_b32 v200, v37, v33, s64
    v_perm_b32 v201, v45, v41, s64
    v_mfma_f32_16x16x32_bf16 a[108:111], v[204:207], a[184:187], a[108:111]
    v_perm_b32 v202, v53, v49, s64
    v_perm_b32 v203, v61, v57, s64
    v_perm_b32 v232, v69, v65, s64
    v_mfma_f32_16x16x32_bf16 a[112:115], v[208:211], a[184:187], a[112:115]
    v_perm_b32 v233, v77, v73, s64
    v_perm_b32 v234, v85, v81, s64
    v_perm_b32 v235, v93, v89, s64
    v_mfma_f32_16x16x32_bf16 a[112:115], v[240:243], a[188:191], a[112:115]
    v_perm_b32 v236, v69, v65, s65
    v_perm_b32 v237, v77, v73, s65
    v_perm_b32 v238, v85, v81, s65
    v_mfma_f32_16x16x32_bf16 a[116:119], v[244:247], a[188:191], a[116:119]
    v_perm_b32 v239, v93, v89, s65
    v_perm_b32 v204, v37, v33, s65
    v_perm_b32 v205, v45, v41, s65
    ds_read_b128 a[140:143], v13 offset:8192
    v_mfma_f32_16x16x32_bf16 a[116:119], v[212:215], a[184:187], a[116:119]
    v_perm_b32 v206, v53, v49, s65
    v_perm_b32 v207, v61, v57, s65
    v_perm_b32 v208, v38, v34, s64
    v_mfma_f32_16x16x32_bf16 a[120:123], v[216:219], a[184:187], a[120:123]
    v_perm_b32 v209, v46, v42, s64
    v_perm_b32 v210, v54, v50, s64
    v_perm_b32 v211, v62, v58, s64
    v_mfma_f32_16x16x32_bf16 a[120:123], v[248:251], a[188:191], a[120:123]
    v_perm_b32 v240, v70, v66, s64
    v_perm_b32 v241, v78, v74, s64
    v_perm_b32 v242, v86, v82, s64
    v_mfma_f32_16x16x32_bf16 a[124:127], v[252:255], a[188:191], a[124:127]
    v_perm_b32 v243, v94, v90, s64
    v_perm_b32 v244, v70, v66, s65
    v_perm_b32 v245, v78, v74, s65
    v_mfma_f32_16x16x32_bf16 a[124:127], v[220:223], a[184:187], a[124:127]
    v_perm_b32 v246, v86, v82, s65
    v_perm_b32 v247, v94, v90, s65
    v_perm_b32 v212, v38, v34, s65
L_tailcode:
    v_mfma_f32_16x16x32_bf16 a[192:195], v[192:195], a[128:131], a[192:195]
    v_perm_b32 v213, v46, v42, s65
    v_perm_b32 v214, v54, v50, s65
    v_perm_b32 v215, v62, v58, s65
    s_waitcnt lgkmcnt(2)
    v_mfma_f32_16x16x32_bf16 a[192:195], v[224:227], a[132:135], a[192:195]
    v_perm_b32 v216, v39, v35, s64
    v_perm_b32 v217, v47, v43, s64
    v_perm_b32 v218, v55, v51, s64
    v_mfma_f32_16x16x32_bf16 a[196:199], v[228:231], a[132:135], a[196:199]
    v_perm_b32 v219, v63, v59, s64
    v_perm_b32 v248, v71, v67, s64
    v_perm_b32 v249, v79, v75, s64
    v_mfma_f32_16x16x32_bf16 a[196:199], v[196:199], a[128:131], a[196:199]
    v_perm_b32 v250, v87, v83, s64
    v_perm_b32 v251, v95, v91, s64
    v_perm_b32 v252, v71, v67, s65
    v_mfma_f32_16x16x32_bf16 a[200:203], v[200:203], a[128:131], a[200:203]
    v_perm_b32 v253, v79, v75, s65
    v_perm_b32 v254, v87, v83, s65
    v_perm_b32 v255, v95, v91, s65
    v_mfma_f32_16x16x32_bf16 a[200:203], v[232:235], a[132:135], a[200:203]
    v_perm_b32 v220, v39, v35, s65
    v_perm_b32 v221, v47, v43, s65
    v_perm_b32 v222, v55, v51, s65
    v_mfma_f32_16x16x32_bf16 a[204:207], v[236:239], a[132:135], a[204:207]
    v_perm_b32 v223, v63, v59, s65
    v_mfma_f32_16x16x32_bf16 a[204:207], v[204:207], a[128:131], a[204:207]
    v_mfma_f32_16x16x32_bf16 a[208:211], v[208:211], a[128:131], a[208:211]
    ds_read_b128 a[144:147], v12 offset:12288
    v_mfma_f32_16x16x32_bf16 a[208:211], v[240:243], a[132:135], a[208:211]
    ds_read_b128 a[148:151], v13 offset:12288
    ds_write_b128 v2, a[192:195] offset:16384
    v_mfma_f32_16x16x32_bf16 a[212:215], v[244:247], a[132:135], a[212:215]
    s_waitcnt vmcnt(13)
    ds_read_b128 a[152:155], v12 offset:6144
    v_mfma_f32_16x16x32_bf16 a[212:215], v[212:215], a[128:131], a[212:215]
    ds_read_b128 a[156:159], v13 offset:6144
    v_mfma_f32_16x16x32_bf16 a[216:219], v[216:219], a[128:131], a[216:219]
    s_waitcnt vmcnt(11)
    ds_read_b128 a[160:163], v12 offset:0
    ds_write_b128 v2, a[196:199] offset:17408
    v_mfma_f32_16x16x32_bf16 a[216:219], v[248:251], a[132:135], a[216:219]
    ds_read_b128 a[164:167], v13 offset:0
    v_mfma_f32_16x16x32_bf16 a[220:223], v[252:255], a[132:135], a[220:223]
    s_waitcnt vmcnt(9)
    ds_read_b128 a[168:171], v12 offset:10240
    v_mfma_f32_16x16x32_bf16 a[220:223], v[220:223], a[128:131], a[220:223]
    ds_read_b128 a[172:175], v13 offset:10240
    ds_write_b128 v2, a[200:203] offset:18432
    s_waitcnt lgkmcnt(12)
    v_mfma_f32_16x16x32_bf16 a[0:3], v[192:195], a[136:139], a[0:3]
    s_waitcnt vmcnt(7)
    ds_read_b128 a[176:179], v12 offset:14336
    s_waitcnt lgkmcnt(12)
    v_mfma_f32_16x16x32_bf16 a[0:3], v[224:227], a[140:143], a[0:3]
    ds_read_b128 a[180:183], v13 offset:14336
    v_mfma_f32_16x16x32_bf16 a[4:7], v[228:231], a[140:143], a[4:7]
    s_waitcnt vmcnt(5)
    ds_read_b128 a[184:187], v12 offset:2048
    ds_write_b128 v2, a[204:207] offset:19456
    v_mfma_f32_16x16x32_bf16 a[4:7], v[196:199], a[136:139], a[4:7]
    s_waitcnt lgkmcnt(12)
    ds_read_b128 a[188:191], v13 offset:2048
    v_mfma_f32_16x16x32_bf16 a[8:11], v[200:203], a[136:139], a[8:11]
    v_mfma_f32_16x16x32_bf16 a[8:11], v[232:235], a[140:143], a[8:11]
    ds_write_b128 v2, a[208:211] offset:20480
    v_mfma_f32_16x16x32_bf16 a[12:15], v[236:239], a[140:143], a[12:15]
    s_lshl_b32 s70, s66, 13
    s_add_u32 s70, s70, 131072
    v_add_u32 v10, s70, v1
    v_xor_b32 v11, 0x4000, v10
    v_mfma_f32_16x16x32_bf16 a[12:15], v[204:207], a[136:139], a[12:15]
    v_mfma_f32_16x16x32_bf16 a[16:19], v[208:211], a[136:139], a[16:19]
    ds_write_b128 v2, a[212:215] offset:21504
    v_mfma_f32_16x16x32_bf16 a[16:19], v[240:243], a[140:143], a[16:19]
    v_mfma_f32_16x16x32_bf16 a[20:23], v[244:247], a[140:143], a[20:23]
    v_mfma_f32_16x16x32_bf16 a[20:23], v[212:215], a[136:139], a[20:23]
    s_waitcnt lgkmcnt(12)
    ds_write_b128 v2, a[216:219] offset:22528
    v_mfma_f32_16x16x32_bf16 a[24:27], v[216:219], a[136:139], a[24:27]
    v_mfma_f32_16x16x32_bf16 a[24:27], v[248:251], a[140:143], a[24:27]
    v_mfma_f32_16x16x32_bf16 a[28:31], v[252:255], a[140:143], a[28:31]
    ds_write_b128 v2, a[220:223] offset:23552
    v_mfma_f32_16x16x32_bf16 a[28:31], v[220:223], a[136:139], a[28:31]
    s_waitcnt vmcnt(1)
    v_lshlrev_b32 v96, 16, v16
    v_mfma_f32_16x16x32_bf16 a[64:67], v[192:195], a[144:147], a[64:67]
    v_lshlrev_b32 v97, 16, v20
    v_mfma_f32_16x16x32_bf16 a[64:67], v[224:227], a[148:151], a[64:67]
    ds_write_b128 v2, a[0:3] offset:24576
    v_mfma_f32_16x16x32_bf16 a[68:71], v[228:231], a[148:151], a[68:71]
    v_lshlrev_b32 v98, 16, v24
    v_mfma_f32_16x16x32_bf16 a[68:71], v[196:199], a[144:147], a[68:71]
    v_lshlrev_b32 v99, 16, v28
    v_mfma_f32_16x16x32_bf16 a[72:75], v[200:203], a[144:147], a[72:75]
    s_waitcnt lgkmcnt(12)
    ds_write_b128 v2, a[4:7] offset:25600
    v_mfma_f32_16x16x32_bf16 a[72:75], v[232:235], a[148:151], a[72:75]
    v_and_b32 v100, s73, v16
    v_mfma_f32_16x16x32_bf16 a[76:79], v[236:239], a[148:151], a[76:79]
    v_and_b32 v101, s73, v20
    v_mfma_f32_16x16x32_bf16 a[76:79], v[204:207], a[144:147], a[76:79]
    ds_write_b128 v2, a[8:11] offset:26624
    v_mfma_f32_16x16x32_bf16 a[80:83], v[208:211], a[144:147], a[80:83]
    v_and_b32 v102, s73, v24
    v_mfma_f32_16x16x32_bf16 a[80:83], v[240:243], a[148:151], a[80:83]
    v_and_b32 v103, s73, v28
    v_mfma_f32_16x16x32_bf16 a[84:87], v[244:247], a[148:151], a[84:87]
    ds_write_b128 v2, a[12:15] offset:27648
    v_mfma_f32_16x16x32_bf16 a[84:87], v[212:215], a[144:147], a[84:87]
    v_lshlrev_b32 v104, 16, v17
    v_mfma_f32_16x16x32_bf16 a[88:91], v[216:219], a[144:147], a[88:91]
    v_lshlrev_b32 v105, 16, v21
    v_mfma_f32_16x16x32_bf16 a[88:91], v[248:251], a[148:151], a[88:91]
    s_waitcnt lgkmcnt(12)
    ds_write_b128 v2, a[16:19] offset:28672
    v_mfma_f32_16x16x32_bf16 a[92:95], v[252:255], a[148:151], a[92:95]
    v_lshlrev_b32 v106, 16, v25
    v_mfma_f32_16x16x32_bf16 a[92:95], v[220:223], a[144:147], a[92:95]
    v_lshlrev_b32 v107, 16, v29
    v_mfma_f32_16x16x32_bf16 a[224:227], v[192:195], a[152:155], a[224:227]
    ds_write_b128 v2, a[20:23] offset:29696
    v_mfma_f32_16x16x32_bf16 a[224:227], v[224:227], a[156:159], a[224:227]
    v_and_b32 v108, s73, v17
    v_mfma_f32_16x16x32_bf16 a[228:231], v[228:231], a[156:159], a[228:231]
    v_and_b32 v109, s73, v21
    v_mfma_f32_16x16x32_bf16 a[228:231], v[196:199], a[152:155], a[228:231]
    ds_write_b128 v2, a[24:27] offset:30720
    v_mfma_f32_16x16x32_bf16 a[232:235], v[200:203], a[152:155], a[232:235]
    v_and_b32 v110, s73, v25
    v_mfma_f32_16x16x32_bf16 a[232:235], v[232:235], a[156:159], a[232:235]
    v_and_b32 v111, s73, v29
    v_mfma_f32_16x16x32_bf16 a[236:239], v[236:239], a[156:159], a[236:239]
    s_waitcnt lgkmcnt(12)
    ds_write_b128 v2, a[28:31] offset:31744
    v_mfma_f32_16x16x32_bf16 a[236:239], v[204:207], a[152:155], a[236:239]
    v_lshlrev_b32 v112, 16, v18
    v_mfma_f32_16x16x32_bf16 a[240:243], v[208:211], a[152:155], a[240:243]
    v_lshlrev_b32 v113, 16, v22
    v_mfma_f32_16x16x32_bf16 a[240:243], v[240:243], a[156:159], a[240:243]
    ds_write_b128 v2, a[64:67] offset:0
    v_mfma_f32_16x16x32_bf16 a[244:247], v[244:247], a[156:159], a[244:247]
    v_lshlrev_b32 v114, 16, v26
    v_mfma_f32_16x16x32_bf16 a[244:247], v[212:215], a[152:155], a[244:247]
    v_lshlrev_b32 v115, 16, v30
    v_mfma_f32_16x16x32_bf16 a[248:251], v[216:219], a[152:155], a[248:251]
    ds_write_b128 v2, a[68:71] offset:1024
    v_mfma_f32_16x16x32_bf16 a[248:251], v[248:251], a[156:159], a[248:251]
    v_and_b32 v116, s73, v18
    v_mfma_f32_16x16x32_bf16 a[252:255], v[252:255], a[156:159], a[252:255]
    v_and_b32 v117, s73, v22
    v_mfma_f32_16x16x32_bf16 a[252:255], v[220:223], a[152:155], a[252:255]
    s_waitcnt lgkmcnt(12)
    ds_write_b128 v2, a[72:75] offset:2048
    v_mfma_f32_16x16x32_bf16 v[128:131], v[192:195], a[160:163], v[128:131]
    v_and_b32 v118, s73, v26
    v_mfma_f32_16x16x32_bf16 v[128:131], v[224:227], a[164:167], v[128:131]
    v_and_b32 v119, s73, v30
    v_mfma_f32_16x16x32_bf16 v[132:135], v[228:231], a[164:167], v[132:135]
    ds_write_b128 v2, a[76:79] offset:3072
    v_mfma_f32_16x16x32_bf16 v[132:135], v[196:199], a[160:163], v[132:135]
    v_lshlrev_b32 v120, 16, v19
    v_mfma_f32_16x16x32_bf16 v[136:139], v[200:203], a[160:163], v[136:139]
    v_lshlrev_b32 v121, 16, v23
    v_mfma_f32_16x16x32_bf16 v[136:139], v[232:235], a[164:167], v[136:139]
    ds_write_b128 v2, a[80:83] offset:4096
    v_mfma_f32_16x16x32_bf16 v[140:143], v[236:239], a[164:167], v[140:143]
    v_lshlrev_b32 v122, 16, v27
    v_mfma_f32_16x16x32_bf16 v[140:143], v[204:207], a[160:163], v[140:143]
    v_lshlrev_b32 v123, 16, v31
    v_mfma_f32_16x16x32_bf16 v[144:147], v[208:211], a[160:163], v[144:147]
    s_waitcnt lgkmcnt(12)
    ds_write_b128 v2, a[84:87] offset:5120
    v_mfma_f32_16x16x32_bf16 v[144:147], v[240:243], a[164:167], v[144:147]
    v_and_b32 v124, s73, v19
    v_mfma_f32_16x16x32_bf16 v[148:151], v[244:247], a[164:167], v[148:151]
    v_and_b32 v125, s73, v23
    v_mfma_f32_16x16x32_bf16 v[148:151], v[212:215], a[160:163], v[148:151]
    ds_write_b128 v2, a[88:91] offset:6144
    v_mfma_f32_16x16x32_bf16 v[152:155], v[216:219], a[160:163], v[152:155]
    v_and_b32 v126, s73, v27
    v_mfma_f32_16x16x32_bf16 v[152:155], v[248:251], a[164:167], v[152:155]
    v_and_b32 v127, s73, v31
    v_mfma_f32_16x16x32_bf16 v[156:159], v[252:255], a[164:167], v[156:159]
    ds_write_b128 v2, a[92:95] offset:7168
    v_mfma_f32_16x16x32_bf16 v[156:159], v[220:223], a[160:163], v[156:159]
    v_mov_b32 v16, 0xc0135761
    v_mfma_f32_16x16x32_bf16 a[32:35], v[192:195], a[168:171], a[32:35]
    v_mov_b32 v17, 0xc0135761
    v_mfma_f32_16x16x32_bf16 a[32:35], v[224:227], a[172:175], a[32:35]
    s_waitcnt lgkmcnt(12)
    ds_write_b128 v2, a[224:227] offset:8192
    v_mfma_f32_16x16x32_bf16 a[36:39], v[228:231], a[172:175], a[36:39]
    v_mov_b32 v18, 1.0
    v_mfma_f32_16x16x32_bf16 a[36:39], v[196:199], a[168:171], a[36:39]
    v_mov_b32 v19, 1.0
    v_mfma_f32_16x16x32_bf16 a[40:43], v[200:203], a[168:171], a[40:43]
    ds_write_b128 v2, a[228:231] offset:9216
    v_mfma_f32_16x16x32_bf16 a[40:43], v[232:235], a[172:175], a[40:43]
    s_mov_b32 s70, 0xbdd2d3e8
    v_mfma_f32_16x16x32_bf16 a[44:47], v[236:239], a[172:175], a[44:47]
    s_mov_b32 s71, 0xbdd2d3e8
    v_mfma_f32_16x16x32_bf16 a[44:47], v[204:207], a[168:171], a[44:47]
    ds_write_b128 v2, a[232:235] offset:10240
    v_mfma_f32_16x16x32_bf16 a[48:51], v[208:211], a[168:171], a[48:51]
    v_mfma_f32_16x16x32_bf16 a[48:51], v[240:243], a[172:175], a[48:51]
    v_mfma_f32_16x16x32_bf16 a[52:55], v[244:247], a[172:175], a[52:55]
    s_waitcnt lgkmcnt(12)
    ds_write_b128 v2, a[236:239] offset:11264
    v_mfma_f32_16x16x32_bf16 a[52:55], v[212:215], a[168:171], a[52:55]
    v_mfma_f32_16x16x32_bf16 a[56:59], v[216:219], a[168:171], a[56:59]
    v_mfma_f32_16x16x32_bf16 a[56:59], v[248:251], a[172:175], a[56:59]
    ds_write_b128 v2, a[240:243] offset:12288
    v_mfma_f32_16x16x32_bf16 a[60:63], v[252:255], a[172:175], a[60:63]
    v_mfma_f32_16x16x32_bf16 a[60:63], v[220:223], a[168:171], a[60:63]
    v_mfma_f32_16x16x32_bf16 a[96:99], v[192:195], a[176:179], a[96:99]
    ds_write_b128 v2, a[244:247] offset:13312
    v_mfma_f32_16x16x32_bf16 a[96:99], v[224:227], a[180:183], a[96:99]
    v_mfma_f32_16x16x32_bf16 a[100:103], v[228:231], a[180:183], a[100:103]
    v_mfma_f32_16x16x32_bf16 a[100:103], v[196:199], a[176:179], a[100:103]
    s_waitcnt lgkmcnt(12)
    ds_write_b128 v2, a[248:251] offset:14336
    v_mfma_f32_16x16x32_bf16 a[104:107], v[200:203], a[176:179], a[104:107]
    v_mfma_f32_16x16x32_bf16 a[104:107], v[232:235], a[180:183], a[104:107]
    v_mfma_f32_16x16x32_bf16 a[108:111], v[236:239], a[180:183], a[108:111]
    ds_write_b128 v2, a[252:255] offset:15360
    v_mfma_f32_16x16x32_bf16 a[108:111], v[204:207], a[176:179], a[108:111]
    v_mfma_f32_16x16x32_bf16 a[112:115], v[208:211], a[176:179], a[112:115]
    v_mfma_f32_16x16x32_bf16 a[112:115], v[240:243], a[180:183], a[112:115]
    v_mfma_f32_16x16x32_bf16 a[116:119], v[244:247], a[180:183], a[116:119]
    v_mfma_f32_16x16x32_bf16 a[116:119], v[212:215], a[176:179], a[116:119]
    v_mfma_f32_16x16x32_bf16 a[120:123], v[216:219], a[176:179], a[120:123]
    v_mfma_f32_16x16x32_bf16 a[120:123], v[248:251], a[180:183], a[120:123]
    v_mfma_f32_16x16x32_bf16 a[124:127], v[252:255], a[180:183], a[124:127]
    v_mfma_f32_16x16x32_bf16 a[124:127], v[220:223], a[176:179], a[124:127]
    s_waitcnt lgkmcnt(0)
    s_barrier
    ds_read_b128 v[32:35], v3 offset:16384
    ds_read_b128 v[36:39], v4 offset:24576
    ds_read_b128 v[40:43], v5 offset:0
    ds_read_b128 v[44:47], v3 offset:17408
    ds_read_b128 v[48:51], v4 offset:25600
    ds_read_b128 v[52:55], v5 offset:1024
    ds_read_b128 v[56:59], v3 offset:18432
    ds_read_b128 v[60:63], v4 offset:26624
    ds_read_b128 v[64:67], v5 offset:2048
    ds_read_b128 v[68:71], v3 offset:19456
    ds_read_b128 v[72:75], v4 offset:27648
    ds_read_b128 v[76:79], v5 offset:3072
    v_mfma_f32_16x16x32_bf16 v[160:163], v[192:195], a[184:187], v[160:163]
    v_mfma_f32_16x16x32_bf16 v[160:163], v[224:227], a[188:191], v[160:163]
    v_mfma_f32_16x16x32_bf16 v[164:167], v[228:231], a[188:191], v[164:167]
    ds_write_b128 v10, a[32:35] offset:0
    v_mfma_f32_16x16x32_bf16 v[164:167], v[196:199], a[184:187], v[164:167]
    v_mfma_f32_16x16x32_bf16 v[168:171], v[200:203], a[184:187], v[168:171]
    v_mfma_f32_16x16x32_bf16 v[168:171], v[232:235], a[188:191], v[168:171]
    v_mfma_f32_16x16x32_bf16 v[172:175], v[236:239], a[188:191], v[172:175]
    ds_write_b128 v10, a[36:39] offset:1024
    v_mfma_f32_16x16x32_bf16 v[172:175], v[204:207], a[184:187], v[172:175]
    v_mfma_f32_16x16x32_bf16 v[176:179], v[208:211], a[184:187], v[176:179]
    v_mfma_f32_16x16x32_bf16 v[176:179], v[240:243], a[188:191], v[176:179]
    v_mfma_f32_16x16x32_bf16 v[180:183], v[244:247], a[188:191], v[180:183]
    ds_write_b128 v10, a[40:43] offset:2048
    v_mfma_f32_16x16x32_bf16 v[180:183], v[212:215], a[184:187], v[180:183]
    v_mfma_f32_16x16x32_bf16 v[184:187], v[216:219], a[184:187], v[184:187]
    v_mfma_f32_16x16x32_bf16 v[184:187], v[248:251], a[188:191], v[184:187]
    v_mfma_f32_16x16x32_bf16 v[188:191], v[252:255], a[188:191], v[188:191]
    s_waitcnt lgkmcnt(12)
    ds_write_b128 v10, a[44:47] offset:3072
    v_mfma_f32_16x16x32_bf16 v[188:191], v[220:223], a[184:187], v[188:191]
    v_pk_add_f32 v[32:33], v[32:33], v[36:37]
    v_pk_add_f32 v[34:35], v[34:35], v[38:39]
    v_pk_add_f32 v[128:129], v[128:129], v[40:41]
    v_pk_add_f32 v[130:131], v[130:131], v[42:43]
    v_pk_add_f32 v[128:129], v[128:129], v[32:33]
    v_pk_add_f32 v[130:131], v[130:131], v[34:35]
    s_waitcnt lgkmcnt(10)
    v_pk_add_f32 v[44:45], v[44:45], v[48:49]
    v_pk_add_f32 v[46:47], v[46:47], v[50:51]
    v_pk_add_f32 v[132:133], v[132:133], v[52:53]
    v_pk_add_f32 v[134:135], v[134:135], v[54:55]
    v_pk_add_f32 v[132:133], v[132:133], v[44:45]
    v_pk_add_f32 v[134:135], v[134:135], v[46:47]
    ds_read_b128 v[80:83], v3 offset:20480
    ds_read_b128 v[84:87], v4 offset:28672
    ds_read_b128 v[88:91], v5 offset:4096
    ds_read_b128 v[92:95], v3 offset:21504
    ds_read_b128 v[32:35], v4 offset:29696
    s_waitcnt lgkmcnt(12)
    ds_read_b128 v[36:39], v5 offset:5120
    v_pk_mul_f32 v[24:25], v[128:129], v[128:129]
    v_pk_mul_f32 v[26:27], v[130:131], v[130:131]
    v_pk_mul_f32 v[28:29], v[132:133], v[132:133]
    v_pk_mul_f32 v[30:31], v[134:135], v[134:135]
    ds_write_b128 v10, a[48:51] offset:4096
    v_pk_fma_f32 v[24:25], v[24:25], s[70:71], v[16:17]
    v_pk_fma_f32 v[26:27], v[26:27], s[70:71], v[16:17]
    v_pk_fma_f32 v[28:29], v[28:29], s[70:71], v[16:17]
    v_pk_fma_f32 v[30:31], v[30:31], s[70:71], v[16:17]
    v_pk_mul_f32 v[24:25], v[24:25], v[128:129]
    v_pk_mul_f32 v[26:27], v[26:27], v[130:131]
    v_pk_mul_f32 v[28:29], v[28:29], v[132:133]
    v_pk_mul_f32 v[30:31], v[30:31], v[134:135]
    ds_write_b128 v10, a[52:55] offset:5120
    v_exp_f32 v24, v24
    v_exp_f32 v25, v25
    v_pk_mul_f32 v[128:129], v[128:129], v[96:97]
    v_exp_f32 v26, v26
    v_exp_f32 v27, v27
    v_pk_mul_f32 v[130:131], v[130:131], v[98:99]
    v_exp_f32 v28, v28
    v_exp_f32 v29, v29
    v_pk_mul_f32 v[132:133], v[132:133], v[100:101]
    v_exp_f32 v30, v30
    v_exp_f32 v31, v31
    v_pk_mul_f32 v[134:135], v[134:135], v[102:103]
    s_waitcnt lgkmcnt(12)
    ds_write_b128 v10, a[56:59] offset:6144
    v_pk_add_f32 v[24:25], v[24:25], v[18:19]
    v_pk_add_f32 v[26:27], v[26:27], v[18:19]
    v_pk_add_f32 v[28:29], v[28:29], v[18:19]
    v_pk_add_f32 v[30:31], v[30:31], v[18:19]
    v_rcp_f32 v24, v24
    v_rcp_f32 v25, v25
    v_rcp_f32 v26, v26
    v_rcp_f32 v27, v27
    ds_write_b128 v10, a[60:63] offset:7168
    v_rcp_f32 v28, v28
    v_rcp_f32 v29, v29
    v_rcp_f32 v30, v30
    v_rcp_f32 v31, v31
    v_pk_mul_f32 v[192:193], v[128:129], v[24:25]
    v_pk_mul_f32 v[194:195], v[130:131], v[26:27]
    v_pk_mul_f32 v[196:197], v[132:133], v[28:29]
    v_pk_mul_f32 v[198:199], v[134:135], v[30:31]
    v_pk_add_f32 v[56:57], v[56:57], v[60:61]
    v_pk_add_f32 v[58:59], v[58:59], v[62:63]
    v_pk_add_f32 v[136:137], v[136:137], v[64:65]
    v_pk_add_f32 v[138:139], v[138:139], v[66:67]
    v_pk_add_f32 v[136:137], v[136:137], v[56:57]
    v_pk_add_f32 v[138:139], v[138:139], v[58:59]
    v_pk_add_f32 v[68:69], v[68:69], v[72:73]
    v_pk_add_f32 v[70:71], v[70:71], v[74:75]
    v_pk_add_f32 v[140:141], v[140:141], v[76:77]
    v_pk_add_f32 v[142:143], v[142:143], v[78:79]
    v_pk_add_f32 v[140:141], v[140:141], v[68:69]
    v_pk_add_f32 v[142:143], v[142:143], v[70:71]
    ds_read_b128 v[40:43], v3 offset:22528
    s_waitcnt lgkmcnt(12)
    ds_read_b128 v[44:47], v4 offset:30720
    ds_read_b128 v[48:51], v5 offset:6144
    ds_read_b128 v[52:55], v3 offset:23552
    s_waitcnt lgkmcnt(12)
    ds_read_b128 v[56:59], v4 offset:31744
    ds_read_b128 v[60:63], v5 offset:7168
    v_pk_mul_f32 v[24:25], v[136:137], v[136:137]
    v_pk_mul_f32 v[26:27], v[138:139], v[138:139]
    v_pk_mul_f32 v[28:29], v[140:141], v[140:141]
    v_pk_mul_f32 v[30:31], v[142:143], v[142:143]
    ds_write_b128 v3, a[96:99] offset:16384
    v_pk_fma_f32 v[24:25], v[24:25], s[70:71], v[16:17]
    v_pk_fma_f32 v[26:27], v[26:27], s[70:71], v[16:17]
    v_pk_fma_f32 v[28:29], v[28:29], s[70:71], v[16:17]
    v_pk_fma_f32 v[30:31], v[30:31], s[70:71], v[16:17]
    v_pk_mul_f32 v[24:25], v[24:25], v[136:137]
    v_pk_mul_f32 v[26:27], v[26:27], v[138:139]
    v_pk_mul_f32 v[28:29], v[28:29], v[140:141]
    v_pk_mul_f32 v[30:31], v[30:31], v[142:143]
    s_waitcnt lgkmcnt(12)
    ds_write_b128 v3, a[100:103] offset:17408
    v_exp_f32 v24, v24
    v_exp_f32 v25, v25
    v_pk_mul_f32 v[136:137], v[136:137], v[104:105]
    v_exp_f32 v26, v26
    v_exp_f32 v27, v27
    v_pk_mul_f32 v[138:139], v[138:139], v[106:107]
    v_exp_f32 v28, v28
    v_exp_f32 v29, v29
    v_pk_mul_f32 v[140:141], v[140:141], v[108:109]
    v_exp_f32 v30, v30
    v_exp_f32 v31, v31
    v_pk_mul_f32 v[142:143], v[142:143], v[110:111]
    ds_write_b128 v3, a[104:107] offset:18432
    v_pk_add_f32 v[24:25], v[24:25], v[18:19]
    v_pk_add_f32 v[26:27], v[26:27], v[18:19]
    v_pk_add_f32 v[28:29], v[28:29], v[18:19]
    v_pk_add_f32 v[30:31], v[30:31], v[18:19]
    v_rcp_f32 v24, v24
    v_rcp_f32 v25, v25
    v_rcp_f32 v26, v26
    v_rcp_f32 v27, v27
    ds_write_b128 v3, a[108:111] offset:19456
    v_rcp_f32 v28, v28
    v_rcp_f32 v29, v29
    v_rcp_f32 v30, v30
    v_rcp_f32 v31, v31
    v_pk_fma_f32 v[192:193], v[136:137], v[24:25], v[192:193]
    v_pk_fma_f32 v[194:195], v[138:139], v[26:27], v[194:195]
    v_pk_fma_f32 v[196:197], v[140:141], v[28:29], v[196:197]
    v_pk_fma_f32 v[198:199], v[142:143], v[30:31], v[198:199]
    v_pk_add_f32 v[80:81], v[80:81], v[84:85]
    v_pk_add_f32 v[82:83], v[82:83], v[86:87]
    v_pk_add_f32 v[144:145], v[144:145], v[88:89]
    v_pk_add_f32 v[146:147], v[146:147], v[90:91]
    v_pk_add_f32 v[144:145], v[144:145], v[80:81]
    v_pk_add_f32 v[146:147], v[146:147], v[82:83]
    s_waitcnt lgkmcnt(14)
    v_pk_add_f32 v[92:93], v[92:93], v[32:33]
    v_pk_add_f32 v[94:95], v[94:95], v[34:35]
    v_pk_add_f32 v[148:149], v[148:149], v[36:37]
    v_pk_add_f32 v[150:151], v[150:151], v[38:39]
    v_pk_add_f32 v[148:149], v[148:149], v[92:93]
    v_pk_add_f32 v[150:151], v[150:151], v[94:95]
    v_pk_mul_f32 v[24:25], v[144:145], v[144:145]
    v_pk_mul_f32 v[26:27], v[146:147], v[146:147]
    v_pk_mul_f32 v[28:29], v[148:149], v[148:149]
    v_pk_mul_f32 v[30:31], v[150:151], v[150:151]
    ds_write_b128 v3, a[112:115] offset:20480
    v_pk_fma_f32 v[24:25], v[24:25], s[70:71], v[16:17]
    v_pk_fma_f32 v[26:27], v[26:27], s[70:71], v[16:17]
    v_pk_fma_f32 v[28:29], v[28:29], s[70:71], v[16:17]
    v_pk_fma_f32 v[30:31], v[30:31], s[70:71], v[16:17]
    v_pk_mul_f32 v[24:25], v[24:25], v[144:145]
    v_pk_mul_f32 v[26:27], v[26:27], v[146:147]
    v_pk_mul_f32 v[28:29], v[28:29], v[148:149]
    v_pk_mul_f32 v[30:31], v[30:31], v[150:151]
    s_waitcnt lgkmcnt(12)
    ds_write_b128 v3, a[116:119] offset:21504
    v_exp_f32 v24, v24
    v_exp_f32 v25, v25
    v_pk_mul_f32 v[144:145], v[144:145], v[112:113]
    v_exp_f32 v26, v26
    v_exp_f32 v27, v27
    v_pk_mul_f32 v[146:147], v[146:147], v[114:115]
    v_exp_f32 v28, v28
    v_exp_f32 v29, v29
    v_pk_mul_f32 v[148:149], v[148:149], v[116:117]
    v_exp_f32 v30, v30
    v_exp_f32 v31, v31
    v_pk_mul_f32 v[150:151], v[150:151], v[118:119]
    ds_write_b128 v3, a[120:123] offset:22528
    v_pk_add_f32 v[24:25], v[24:25], v[18:19]
    v_pk_add_f32 v[26:27], v[26:27], v[18:19]
    v_pk_add_f32 v[28:29], v[28:29], v[18:19]
    v_pk_add_f32 v[30:31], v[30:31], v[18:19]
    v_rcp_f32 v24, v24
    v_rcp_f32 v25, v25
    v_rcp_f32 v26, v26
    v_rcp_f32 v27, v27
    ds_write_b128 v3, a[124:127] offset:23552
    v_rcp_f32 v28, v28
    v_rcp_f32 v29, v29
    v_rcp_f32 v30, v30
    v_rcp_f32 v31, v31
    v_pk_fma_f32 v[192:193], v[144:145], v[24:25], v[192:193]
    v_pk_fma_f32 v[194:195], v[146:147], v[26:27], v[194:195]
    v_pk_fma_f32 v[196:197], v[148:149], v[28:29], v[196:197]
    v_pk_fma_f32 v[198:199], v[150:151], v[30:31], v[198:199]
    s_waitcnt lgkmcnt(11)
    v_pk_add_f32 v[40:41], v[40:41], v[44:45]
    v_pk_add_f32 v[42:43], v[42:43], v[46:47]
    v_pk_add_f32 v[152:153], v[152:153], v[48:49]
    v_pk_add_f32 v[154:155], v[154:155], v[50:51]
    v_pk_add_f32 v[152:153], v[152:153], v[40:41]
    v_pk_add_f32 v[154:155], v[154:155], v[42:43]
    s_waitcnt lgkmcnt(8)
    v_pk_add_f32 v[52:53], v[52:53], v[56:57]
    v_pk_add_f32 v[54:55], v[54:55], v[58:59]
    v_pk_add_f32 v[156:157], v[156:157], v[60:61]
    v_pk_add_f32 v[158:159], v[158:159], v[62:63]
    v_pk_add_f32 v[156:157], v[156:157], v[52:53]
    v_pk_add_f32 v[158:159], v[158:159], v[54:55]
    s_waitcnt lgkmcnt(0)
    s_barrier
    ds_read_b128 v[64:67], v3 offset:8192
    ds_read_b128 v[68:71], v11 offset:0
    ds_read_b128 v[72:75], v2 offset:16384
    ds_read_b128 v[76:79], v3 offset:9216
    ds_read_b128 v[80:83], v11 offset:1024
    ds_read_b128 v[84:87], v2 offset:17408
    ds_read_b128 v[88:91], v3 offset:10240
    ds_read_b128 v[92:95], v11 offset:2048
    ds_read_b128 v[32:35], v2 offset:18432
    ds_read_b128 v[36:39], v3 offset:11264
    ds_read_b128 v[40:43], v11 offset:3072
    ds_read_b128 v[44:47], v2 offset:19456
    v_pk_mul_f32 v[24:25], v[152:153], v[152:153]
    v_pk_mul_f32 v[26:27], v[154:155], v[154:155]
    v_pk_mul_f32 v[28:29], v[156:157], v[156:157]
    v_pk_mul_f32 v[30:31], v[158:159], v[158:159]
    v_pk_fma_f32 v[24:25], v[24:25], s[70:71], v[16:17]
    v_pk_fma_f32 v[26:27], v[26:27], s[70:71], v[16:17]
    v_pk_fma_f32 v[28:29], v[28:29], s[70:71], v[16:17]
    v_pk_fma_f32 v[30:31], v[30:31], s[70:71], v[16:17]
    v_pk_mul_f32 v[24:25], v[24:25], v[152:153]
    v_pk_mul_f32 v[26:27], v[26:27], v[154:155]
    v_pk_mul_f32 v[28:29], v[28:29], v[156:157]
    v_pk_mul_f32 v[30:31], v[30:31], v[158:159]
    v_exp_f32 v24, v24
    v_exp_f32 v25, v25
    v_pk_mul_f32 v[152:153], v[152:153], v[120:121]
    v_exp_f32 v26, v26
    v_exp_f32 v27, v27
    v_pk_mul_f32 v[154:155], v[154:155], v[122:123]
    v_exp_f32 v28, v28
    v_exp_f32 v29, v29
    v_pk_mul_f32 v[156:157], v[156:157], v[124:125]
    v_exp_f32 v30, v30
    v_exp_f32 v31, v31
    v_pk_mul_f32 v[158:159], v[158:159], v[126:127]
    v_pk_add_f32 v[24:25], v[24:25], v[18:19]
    v_pk_add_f32 v[26:27], v[26:27], v[18:19]
    v_pk_add_f32 v[28:29], v[28:29], v[18:19]
    v_pk_add_f32 v[30:31], v[30:31], v[18:19]
    v_rcp_f32 v24, v24
    v_rcp_f32 v25, v25
    v_rcp_f32 v26, v26
    v_rcp_f32 v27, v27
    v_rcp_f32 v28, v28
    v_rcp_f32 v29, v29
    v_rcp_f32 v30, v30
    v_rcp_f32 v31, v31
    v_pk_fma_f32 v[192:193], v[152:153], v[24:25], v[192:193]
    v_pk_fma_f32 v[194:195], v[154:155], v[26:27], v[194:195]
    v_pk_fma_f32 v[196:197], v[156:157], v[28:29], v[196:197]
    v_pk_fma_f32 v[198:199], v[158:159], v[30:31], v[198:199]
    s_waitcnt lgkmcnt(9)
    v_pk_add_f32 v[64:65], v[64:65], v[68:69]
    v_pk_add_f32 v[66:67], v[66:67], v[70:71]
    v_pk_add_f32 v[160:161], v[160:161], v[72:73]
    v_pk_add_f32 v[162:163], v[162:163], v[74:75]
    v_pk_add_f32 v[160:161], v[160:161], v[64:65]
    v_pk_add_f32 v[162:163], v[162:163], v[66:67]
    s_waitcnt lgkmcnt(6)
    v_pk_add_f32 v[76:77], v[76:77], v[80:81]
    v_pk_add_f32 v[78:79], v[78:79], v[82:83]
    v_pk_add_f32 v[164:165], v[164:165], v[84:85]
    v_pk_add_f32 v[166:167], v[166:167], v[86:87]
    v_pk_add_f32 v[164:165], v[164:165], v[76:77]
    v_pk_add_f32 v[166:167], v[166:167], v[78:79]
    ds_read_b128 v[48:51], v3 offset:12288
    ds_read_b128 v[52:55], v11 offset:4096
    ds_read_b128 v[56:59], v2 offset:20480
    ds_read_b128 v[60:63], v3 offset:13312
    ds_read_b128 v[64:67], v11 offset:5120
    ds_read_b128 v[68:71], v2 offset:21504
    v_pk_mul_f32 v[24:25], v[160:161], v[160:161]
    v_pk_mul_f32 v[26:27], v[162:163], v[162:163]
    v_pk_mul_f32 v[28:29], v[164:165], v[164:165]
    v_pk_mul_f32 v[30:31], v[166:167], v[166:167]
    v_pk_fma_f32 v[24:25], v[24:25], s[70:71], v[16:17]
    v_pk_fma_f32 v[26:27], v[26:27], s[70:71], v[16:17]
    v_pk_fma_f32 v[28:29], v[28:29], s[70:71], v[16:17]
    v_pk_fma_f32 v[30:31], v[30:31], s[70:71], v[16:17]
    v_pk_mul_f32 v[24:25], v[24:25], v[160:161]
    v_pk_mul_f32 v[26:27], v[26:27], v[162:163]
    v_pk_mul_f32 v[28:29], v[28:29], v[164:165]
    v_pk_mul_f32 v[30:31], v[30:31], v[166:167]
    v_exp_f32 v24, v24
    v_exp_f32 v25, v25
    v_pk_mul_f32 v[160:161], v[160:161], v[96:97]
    v_exp_f32 v26, v26
    v_exp_f32 v27, v27
    v_pk_mul_f32 v[162:163], v[162:163], v[98:99]
    v_exp_f32 v28, v28
    v_exp_f32 v29, v29
    v_pk_mul_f32 v[164:165], v[164:165], v[100:101]
    v_exp_f32 v30, v30
    v_exp_f32 v31, v31
    v_pk_mul_f32 v[166:167], v[166:167], v[102:103]
    v_pk_add_f32 v[24:25], v[24:25], v[18:19]
    v_pk_add_f32 v[26:27], v[26:27], v[18:19]
    v_pk_add_f32 v[28:29], v[28:29], v[18:19]
    v_pk_add_f32 v[30:31], v[30:31], v[18:19]
    v_rcp_f32 v24, v24
    v_rcp_f32 v25, v25
    v_rcp_f32 v26, v26
    v_rcp_f32 v27, v27
    v_rcp_f32 v28, v28
    v_rcp_f32 v29, v29
    v_rcp_f32 v30, v30
    v_rcp_f32 v31, v31
    v_pk_mul_f32 v[200:201], v[160:161], v[24:25]
    v_pk_mul_f32 v[202:203], v[162:163], v[26:27]
    v_pk_mul_f32 v[204:205], v[164:165], v[28:29]
    v_pk_mul_f32 v[206:207], v[166:167], v[30:31]
    s_waitcnt lgkmcnt(9)
    v_pk_add_f32 v[88:89], v[88:89], v[92:93]
    v_pk_add_f32 v[90:91], v[90:91], v[94:95]
    v_pk_add_f32 v[168:169], v[168:169], v[32:33]
    v_pk_add_f32 v[170:171], v[170:171], v[34:35]
    v_pk_add_f32 v[168:169], v[168:169], v[88:89]
    v_pk_add_f32 v[170:171], v[170:171], v[90:91]
    s_waitcnt lgkmcnt(6)
    v_pk_add_f32 v[36:37], v[36:37], v[40:41]
    v_pk_add_f32 v[38:39], v[38:39], v[42:43]
    v_pk_add_f32 v[172:173], v[172:173], v[44:45]
    v_pk_add_f32 v[174:175], v[174:175], v[46:47]
    v_pk_add_f32 v[172:173], v[172:173], v[36:37]
    v_pk_add_f32 v[174:175], v[174:175], v[38:39]
    ds_read_b128 v[72:75], v3 offset:14336
    ds_read_b128 v[76:79], v11 offset:6144
    ds_read_b128 v[80:83], v2 offset:22528
    ds_read_b128 v[84:87], v3 offset:15360
    ds_read_b128 v[88:91], v11 offset:7168
    ds_read_b128 v[92:95], v2 offset:23552
    v_pk_mul_f32 v[24:25], v[168:169], v[168:169]
    v_pk_mul_f32 v[26:27], v[170:171], v[170:171]
    v_pk_mul_f32 v[28:29], v[172:173], v[172:173]
    v_pk_mul_f32 v[30:31], v[174:175], v[174:175]
    v_pk_fma_f32 v[24:25], v[24:25], s[70:71], v[16:17]
    v_pk_fma_f32 v[26:27], v[26:27], s[70:71], v[16:17]
    v_pk_fma_f32 v[28:29], v[28:29], s[70:71], v[16:17]
    v_pk_fma_f32 v[30:31], v[30:31], s[70:71], v[16:17]
    v_pk_mul_f32 v[24:25], v[24:25], v[168:169]
    v_pk_mul_f32 v[26:27], v[26:27], v[170:171]
    v_pk_mul_f32 v[28:29], v[28:29], v[172:173]
    v_pk_mul_f32 v[30:31], v[30:31], v[174:175]
    v_exp_f32 v24, v24
    v_exp_f32 v25, v25
    v_pk_mul_f32 v[168:169], v[168:169], v[104:105]
    v_exp_f32 v26, v26
    v_exp_f32 v27, v27
    v_pk_mul_f32 v[170:171], v[170:171], v[106:107]
    v_exp_f32 v28, v28
    v_exp_f32 v29, v29
    v_pk_mul_f32 v[172:173], v[172:173], v[108:109]
    v_exp_f32 v30, v30
    v_exp_f32 v31, v31
    v_pk_mul_f32 v[174:175], v[174:175], v[110:111]
    v_pk_add_f32 v[24:25], v[24:25], v[18:19]
    v_pk_add_f32 v[26:27], v[26:27], v[18:19]
    v_pk_add_f32 v[28:29], v[28:29], v[18:19]
    v_pk_add_f32 v[30:31], v[30:31], v[18:19]
    v_rcp_f32 v24, v24
    v_rcp_f32 v25, v25
    v_rcp_f32 v26, v26
    v_rcp_f32 v27, v27
    v_rcp_f32 v28, v28
    v_rcp_f32 v29, v29
    v_rcp_f32 v30, v30
    v_rcp_f32 v31, v31
    v_pk_fma_f32 v[200:201], v[168:169], v[24:25], v[200:201]
    v_pk_fma_f32 v[202:203], v[170:171], v[26:27], v[202:203]
    v_pk_fma_f32 v[204:205], v[172:173], v[28:29], v[204:205]
    v_pk_fma_f32 v[206:207], v[174:175], v[30:31], v[206:207]
    s_waitcnt lgkmcnt(9)
    v_pk_add_f32 v[48:49], v[48:49], v[52:53]
    v_pk_add_f32 v[50:51], v[50:51], v[54:55]
    v_pk_add_f32 v[176:177], v[176:177], v[56:57]
    v_pk_add_f32 v[178:179], v[178:179], v[58:59]
    v_pk_add_f32 v[176:177], v[176:177], v[48:49]
    v_pk_add_f32 v[178:179], v[178:179], v[50:51]
    s_waitcnt lgkmcnt(6)
    v_pk_add_f32 v[60:61], v[60:61], v[64:65]
    v_pk_add_f32 v[62:63], v[62:63], v[66:67]
    v_pk_add_f32 v[180:181], v[180:181], v[68:69]
    v_pk_add_f32 v[182:183], v[182:183], v[70:71]
    v_pk_add_f32 v[180:181], v[180:181], v[60:61]
    v_pk_add_f32 v[182:183], v[182:183], v[62:63]
    v_pk_mul_f32 v[24:25], v[176:177], v[176:177]
    v_pk_mul_f32 v[26:27], v[178:179], v[178:179]
    v_pk_mul_f32 v[28:29], v[180:181], v[180:181]
    v_pk_mul_f32 v[30:31], v[182:183], v[182:183]
    v_pk_fma_f32 v[24:25], v[24:25], s[70:71], v[16:17]
    v_pk_fma_f32 v[26:27], v[26:27], s[70:71], v[16:17]
    v_pk_fma_f32 v[28:29], v[28:29], s[70:71], v[16:17]
    v_pk_fma_f32 v[30:31], v[30:31], s[70:71], v[16:17]
    v_pk_mul_f32 v[24:25], v[24:25], v[176:177]
    v_pk_mul_f32 v[26:27], v[26:27], v[178:179]
    v_pk_mul_f32 v[28:29], v[28:29], v[180:181]
    v_pk_mul_f32 v[30:31], v[30:31], v[182:183]
    v_exp_f32 v24, v24
    v_exp_f32 v25, v25
    v_pk_mul_f32 v[176:177], v[176:177], v[112:113]
    v_exp_f32 v26, v26
    v_exp_f32 v27, v27
    v_pk_mul_f32 v[178:179], v[178:179], v[114:115]
    v_exp_f32 v28, v28
    v_exp_f32 v29, v29
    v_pk_mul_f32 v[180:181], v[180:181], v[116:117]
    v_exp_f32 v30, v30
    v_exp_f32 v31, v31
    v_pk_mul_f32 v[182:183], v[182:183], v[118:119]
    v_pk_add_f32 v[24:25], v[24:25], v[18:19]
    v_pk_add_f32 v[26:27], v[26:27], v[18:19]
    v_pk_add_f32 v[28:29], v[28:29], v[18:19]
    v_pk_add_f32 v[30:31], v[30:31], v[18:19]
    v_rcp_f32 v24, v24
    v_rcp_f32 v25, v25
    v_rcp_f32 v26, v26
    v_rcp_f32 v27, v27
    v_rcp_f32 v28, v28
    v_rcp_f32 v29, v29
    v_rcp_f32 v30, v30
    v_rcp_f32 v31, v31
    v_pk_fma_f32 v[200:201], v[176:177], v[24:25], v[200:201]
    v_pk_fma_f32 v[202:203], v[178:179], v[26:27], v[202:203]
    v_pk_fma_f32 v[204:205], v[180:181], v[28:29], v[204:205]
    v_pk_fma_f32 v[206:207], v[182:183], v[30:31], v[206:207]
    s_waitcnt lgkmcnt(3)
    v_pk_add_f32 v[72:73], v[72:73], v[76:77]
    v_pk_add_f32 v[74:75], v[74:75], v[78:79]
    v_pk_add_f32 v[184:185], v[184:185], v[80:81]
    v_pk_add_f32 v[186:187], v[186:187], v[82:83]
    v_pk_add_f32 v[184:185], v[184:185], v[72:73]
    v_pk_add_f32 v[186:187], v[186:187], v[74:75]
    s_waitcnt lgkmcnt(0)
    v_pk_add_f32 v[84:85], v[84:85], v[88:89]
    v_pk_add_f32 v[86:87], v[86:87], v[90:91]
    v_pk_add_f32 v[188:189], v[188:189], v[92:93]
    v_pk_add_f32 v[190:191], v[190:191], v[94:95]
    v_pk_add_f32 v[188:189], v[188:189], v[84:85]
    v_pk_add_f32 v[190:191], v[190:191], v[86:87]
    v_pk_mul_f32 v[24:25], v[184:185], v[184:185]
    v_pk_mul_f32 v[26:27], v[186:187], v[186:187]
    v_pk_mul_f32 v[28:29], v[188:189], v[188:189]
    v_pk_mul_f32 v[30:31], v[190:191], v[190:191]
    v_pk_fma_f32 v[24:25], v[24:25], s[70:71], v[16:17]
    v_pk_fma_f32 v[26:27], v[26:27], s[70:71], v[16:17]
    v_pk_fma_f32 v[28:29], v[28:29], s[70:71], v[16:17]
    v_pk_fma_f32 v[30:31], v[30:31], s[70:71], v[16:17]
    v_pk_mul_f32 v[24:25], v[24:25], v[184:185]
    v_pk_mul_f32 v[26:27], v[26:27], v[186:187]
    v_pk_mul_f32 v[28:29], v[28:29], v[188:189]
    v_pk_mul_f32 v[30:31], v[30:31], v[190:191]
    v_exp_f32 v24, v24
    v_exp_f32 v25, v25
    v_pk_mul_f32 v[184:185], v[184:185], v[120:121]
    v_exp_f32 v26, v26
    v_exp_f32 v27, v27
    v_pk_mul_f32 v[186:187], v[186:187], v[122:123]
    v_exp_f32 v28, v28
    v_exp_f32 v29, v29
    v_pk_mul_f32 v[188:189], v[188:189], v[124:125]
    v_exp_f32 v30, v30
    v_exp_f32 v31, v31
    v_pk_mul_f32 v[190:191], v[190:191], v[126:127]
    v_pk_add_f32 v[24:25], v[24:25], v[18:19]
    v_pk_add_f32 v[26:27], v[26:27], v[18:19]
    v_pk_add_f32 v[28:29], v[28:29], v[18:19]
    v_pk_add_f32 v[30:31], v[30:31], v[18:19]
    v_rcp_f32 v24, v24
    v_rcp_f32 v25, v25
    v_rcp_f32 v26, v26
    v_rcp_f32 v27, v27
    v_rcp_f32 v28, v28
    v_rcp_f32 v29, v29
    v_rcp_f32 v30, v30
    v_rcp_f32 v31, v31
    v_pk_fma_f32 v[200:201], v[184:185], v[24:25], v[200:201]
    v_pk_fma_f32 v[202:203], v[186:187], v[26:27], v[202:203]
    v_pk_fma_f32 v[204:205], v[188:189], v[28:29], v[204:205]
    v_pk_fma_f32 v[206:207], v[190:191], v[30:31], v[206:207]
    s_waitcnt vmcnt(0)
    v_mov_b32 v7, v8
    v_mov_b32 v15, v9
    v_pk_add_f32 v[192:193], v[192:193], v[194:195]
    v_pk_add_f32 v[196:197], v[196:197], v[198:199]
    v_pk_add_f32 v[200:201], v[200:201], v[202:203]
    v_pk_add_f32 v[204:205], v[204:205], v[206:207]
    v_pk_add_f32 v[192:193], v[192:193], v[196:197]
    v_pk_add_f32 v[200:201], v[200:201], v[204:205]
    v_add_f32 v8, v192, v193
    v_add_f32 v9, v200, v201
    s_nop 1
    v_permlane32_swap_b32 v8, v9
    s_nop 1
    v_add_f32 v8, v8, v9
    v_mov_b32 v9, v8
    s_nop 1
    v_permlane16_swap_b32 v8, v9
    s_nop 1
    v_add_f32 v8, v8, v9
    v_lshrrev_b32 v1, 5, v0
    v_lshlrev_b32 v1, 4, v1
    v_and_b32 v2, 15, v0
    v_add_u32 v1, v1, v2
    s_lshl_b32 s70, s67, 7
    s_lshl_b32 s71, s66, 5
    s_add_u32 s70, s70, s71
    s_lshl_b32 s71, s68, 10
    s_add_u32 s70, s70, s71
    v_add_u32 v1, s70, v1
    v_lshlrev_b32 v1, 3, v1
    v_mov_b32 v9, 1
    s_mov_b32 exec_lo, -1
    s_mov_b32 exec_hi, 0xffff
    s_mov_b32 s72, 0
L_fchk:
    v_cmp_ne_u32 vcc, 1, v7
    s_cbranch_vccz L_fok
    buffer_load_dword v7, v15, s[52:55], 0 offen sc1
    s_waitcnt vmcnt(0)
    s_add_u32 s72, s72, 1
    s_cmp_lt_u32 s72, 40000
    s_cbranch_scc1 L_fchk
L_fok:
    s_mov_b32 exec_lo, 0xffff
    s_mov_b32 exec_hi, 0xffff
    buffer_store_dwordx2 v[8:9], v1, s[48:51], 0 offen sc1
    s_mov_b64 exec, -1
    s_endpgm
L_cin:
    s_lshl_b32 s72, s66, 6
    v_add_u32 v1, s72, v0
    s_getpc_b64 s[74:75]
L_pc1:
    s_add_u32 s74, s74, L_tab-L_pc1
    s_addc_u32 s75, s75, 0
    v_lshrrev_b32 v46, 5, v1
    v_lshlrev_b32 v46, 6, v46
    global_load_dwordx4 v[224:227], v46, s[74:75] offset:0
    global_load_dwordx4 v[228:231], v46, s[74:75] offset:16
    global_load_dwordx4 v[232:235], v46, s[74:75] offset:32
    global_load_dwordx4 v[236:239], v46, s[74:75] offset:48
    v_mov_b32 v3, 0x7ff00000
    s_lshr_b32 s65, s70, 1
    s_and_b32 s64, s70, 1
    s_mul_i32 s73, s65, 6
    s_add_u32 s73, s73, s71
    s_mul_i32 s67, s73, 21
    s_min_u32 s68, s73, 8
    s_add_u32 s67, s67, s68
    s_lshl_b32 s68, s64, 9
    s_add_u32 s67, s67, s68
    s_cmp_lt_u32 s73, 8
    s_cselect_b32 s68, 22, 21
    v_and_b32 v4, 0xfc, v0
    v_add_u32 v4, 126976, v4
    s_mul_i32 s69, s67, 104
    v_and_b32 v8, 31, v0
    v_lshrrev_b32 v9, 5, v0
    v_mov_b32 v20, 0
    v_cmp_gt_u32 vcc, 25, v8
    v_mov_b32 v21, 25
    v_cmp_eq_u32 s[72:73], 28, v8
    v_cndmask_b32 v20, v20, v8, vcc
    s_nop 0
    v_cndmask_b32 v20, v20, v21, s[72:73]
    s_or_b64 s[76:77], vcc, s[72:73]
    v_cndmask_b32 v21, 0, 1.0, s[76:77]
    v_lshlrev_b32 v23, 1, v20
    s_mov_b32 s77, 0
    v_cndmask_b32 v23, v3, v23, s[76:77]
    v_lshlrev_b32 v22, 1, v0
    v_cmp_gt_u32 vcc, 26, v0
    v_min_u32 v240, 21, v8
    v_mul_u32_u24 v240, 104, v240
    v_cndmask_b32 v22, v3, v22, vcc
    v_lshl_add_u32 v240, v9, 3, v240
    s_lshr_b32 s72, s66, 1
    s_lshl_b32 s72, s72, 2
    s_add_u32 s72, s72, 126992
    v_add_u32 v240, s72, v240
    v_lshlrev_b32 v2, 3, v1
    v_add_u32 v2, 70304, v2
    v_cmp_gt_u32 vcc, 169, v1
    v_lshlrev_b32 v47, 4, v0
    s_mov_b32 m0, 126976
    v_cndmask_b32 v2, v3, v2, vcc
    s_mov_b32 s38, 105456
    s_mov_b32 s39, 0x00020000
    s_mov_b32 s46, 156
    s_mov_b32 s47, 0x00020000
    s_mov_b32 s30, 106496
    s_mov_b32 s31, 0x00020000
    s_mov_b32 s42, 22151168
    s_mov_b32 s43, 0x00020000
    s_waitcnt lgkmcnt(0)
    global_load_dword v15, v16, s[8:9]
    s_mov_b64 s[36:37], s[8:9]
    s_mov_b64 s[44:45], s[10:11]
    s_mov_b64 s[28:29], s[4:5]
    s_mov_b64 s[40:41], s[12:13]
    s_load_dwordx8 s[56:63], s[10:11], 104
    s_load_dwordx4 s[12:15], s[10:11], 136
    s_load_dword s16, s[10:11], 152
    buffer_load_ushort v22, v22, s[44:47], 0 offen offset:52
    s_cmp_eq_u32 s66, 3
    s_cbranch_scc1 L_a3
    buffer_load_dwordx2 v[128:129], v2, s[36:39], 0 offen offset:0
    buffer_load_dwordx2 v[130:131], v2, s[36:39], 0 offen offset:1352
    buffer_load_dwordx2 v[132:133], v2, s[36:39], 0 offen offset:2704
    v_add_u32 v2, 4056, v2
    buffer_load_dwordx2 v[134:135], v2, s[36:39], 0 offen offset:0
    buffer_load_dwordx2 v[136:137], v2, s[36:39], 0 offen offset:1352
    buffer_load_dwordx2 v[138:139], v2, s[36:39], 0 offen offset:2704
    v_add_u32 v2, 4056, v2
    buffer_load_dwordx2 v[140:141], v2, s[36:39], 0 offen offset:0
    buffer_load_dwordx2 v[142:143], v2, s[36:39], 0 offen offset:1352
    buffer_load_dwordx2 v[144:145], v2, s[36:39], 0 offen offset:2704
    v_add_u32 v2, 4056, v2
    buffer_load_dwordx2 v[146:147], v2, s[36:39], 0 offen offset:0
    buffer_load_dwordx2 v[148:149], v2, s[36:39], 0 offen offset:1352
    buffer_load_dwordx2 v[150:151], v2, s[36:39], 0 offen offset:2704
    v_add_u32 v2, 4056, v2
    buffer_load_dwordx2 v[152:153], v2, s[36:39], 0 offen offset:0
    buffer_load_dwordx2 v[154:155], v2, s[36:39], 0 offen offset:1352
    buffer_load_dwordx2 v[156:157], v2, s[36:39], 0 offen offset:2704
    v_add_u32 v2, 4056, v2
    buffer_load_dwordx2 v[158:159], v2, s[36:39], 0 offen offset:0
    buffer_load_dwordx2 v[160:161], v2, s[36:39], 0 offen offset:1352
    buffer_load_dwordx2 v[162:163], v2, s[36:39], 0 offen offset:2704
    v_add_u32 v2, 4056, v2
    buffer_load_dwordx2 v[164:165], v2, s[36:39], 0 offen offset:0
    buffer_load_dwordx2 v[166:167], v2, s[36:39], 0 offen offset:1352
    buffer_load_dwordx2 v[168:169], v2, s[36:39], 0 offen offset:2704
    v_add_u32 v2, 4056, v2
    buffer_load_dwordx2 v[170:171], v2, s[36:39], 0 offen offset:0
    buffer_load_dwordx2 v[172:173], v2, s[36:39], 0 offen offset:1352
    buffer_load_dwordx2 v[174:175], v2, s[36:39], 0 offen offset:2704
    v_add_u32 v2, 4056, v2
    buffer_load_dwordx2 v[176:177], v2, s[36:39], 0 offen offset:0
    buffer_load_dwordx2 v[178:179], v2, s[36:39], 0 offen offset:1352
    s_branch L_ajoin
L_a3:
    buffer_load_dwordx4 v47, s[28:31], s69 offen offset:0 lds
    buffer_load_dwordx4 v47, s[28:31], s69 offen offset:1024 lds
    buffer_load_dwordx4 v47, s[28:31], s69 offen offset:2048 lds
    buffer_load_ushort v23, v23, s[44:47], 0 offen
    v_lshrrev_b32 v2, 3, v0
    v_mul_u32_u24 v2, 2288, v2
    v_and_b32 v3, 7, v0
    v_lshl_add_u32 v2, v3, 4, v2
    s_mov_b32 m0, 130048
    s_mov_b32 s17, 2184
    buffer_load_dwordx4 v2, s[28:31], s17 offen lds
    s_mov_b32 m0, 131072
    s_mov_b32 s17, 55432
    buffer_load_dwordx4 v2, s[28:31], s17 offen lds
    s_mov_b32 m0, 0x8000
L_a3loop:
    s_waitcnt vmcnt(32)
    buffer_load_dwordx4 v47, s[36:39], m0 offen offset:0 lds
    buffer_load_dwordx4 v47, s[36:39], m0 offen offset:1024 lds
    buffer_load_dwordx4 v47, s[36:39], m0 offen offset:2048 lds
    buffer_load_dwordx4 v47, s[36:39], m0 offen offset:3072 lds
    s_add_u32 m0, m0, 4096
    s_cmp_lg_u32 m0, 0x14000
    s_cbranch_scc1 L_a3loop
L_ajoin:
    s_mul_i32 s70, s64, 6
    s_add_u32 s70, s70, s71
    s_lshl_b32 s70, s70, 2
    s_add_u32 s70, s70, s66
    s_mul_i32 s70, s70, 26624
    s_mul_i32 s72, s65, 1664
    s_add_u32 s70, s70, s72
    v_min_u32 v2, 51, v0
    v_mul_u32_u24 v3, 79, v2
    v_lshrrev_b32 v3, 10, v3
    v_mul_u32_u24 v250, 4992, v3
    v_lshl_add_u32 v250, v2, 7, v250
    v_add_u32 v250, s70, v250
    s_mov_b32 s64, 3407872
    s_mov_b32 s32, s6
    s_mov_b32 s33, s7
    s_mov_b32 s34, 25600000
    s_mov_b32 s35, 0x00020000
    s_mov_b32 s48, s24
    s_mov_b32 s49, s25
    s_mov_b32 s50, 278528
    s_mov_b32 s51, 0x00020000
    s_mov_b32 s52, s22
    s_mov_b32 s53, s23
    s_mov_b32 s54, 256
    s_mov_b32 s55, 0x00020000
    v_lshrrev_b32 v3, 5, v1
    v_cmp_gt_u32 s[76:77], s68, v8
    v_lshl_add_u32 v5, v3, 10, v8
    v_add_u32 v5, s67, v5
    v_lshlrev_b32 v5, 3, v5
    v_mov_b32 v28, 0
    v_mov_b32 v29, 0
    s_lshl_b32 s70, s66, 6
    v_and_b32 v6, 3, v0
    v_lshlrev_b32 v6, 4, v6
    v_add_u32 v6, s70, v6
    v_cmp_gt_u32 vcc, 40, v0
    v_mov_b32 v251, 0x7ff00000
    s_nop 0
    v_cndmask_b32 v251, v251, v6, vcc
    s_lshl_b32 s78, s66, 12
    s_add_u32 s78, s78, 147456
    s_and_b32 s65, s66, 1
    s_lshl_b32 s65, s65, 7
    v_lshlrev_b32 v12, 1, v8
    v_add_u32 v12, 139392, v12
    v_mov_b32 v3, 141440
    v_cmp_eq_u32 vcc, 26, v8
    s_nop 1
    v_cndmask_b32 v12, v12, v3, vcc
    v_mov_b32 v3, 141442
    v_cmp_lt_u32 vcc, 26, v8
    s_nop 1
    v_cndmask_b32 v12, v12, v3, vcc
    v_mul_u32_u24 v3, 416, v9
    v_add_u32 v12, v12, v3
    v_bfe_u32 v10, v0, 2, 2
    v_lshl_add_u32 v10, v9, 3, v10
    v_mul_u32_u24 v10, 1352, v10
    v_bfe_u32 v11, v0, 4, 1
    v_lshl_add_u32 v10, v11, 5, v10
    v_and_b32 v11, 3, v0
    v_lshl_add_u32 v10, v11, 3, v10
    s_lshl_b32 s70, s66, 6
    s_add_u32 s70, s70, 35152
    v_add_u32 v10, s70, v10
    s_mul_i32 s70, s66, 1664
    s_add_u32 s70, s70, 81920
    v_mul_u32_u24 v11, 52, v8
    v_lshl_add_u32 v11, v9, 3, v11
    v_add_u32 v11, s70, v11
    s_lshl_b32 s70, s66, 7
    s_add_u32 s70, s70, 121856
    v_lshlrev_b32 v13, 2, v8
    v_add_u32 v13, s70, v13
    v_mul_u32_u24 v14, 1352, v20
    s_mul_i32 s70, s66, 13
    s_add_u32 s70, s70, 0
    s_lshr_b32 s71, s70, 1
    s_lshl_b32 s71, s71, 10
    s_and_b32 s70, s70, 1
    s_lshl_b32 s70, s70, 3
    s_add_u32 s70, s70, s71
    s_add_u32 s70, s70, 34816
    v_lshlrev_b32 v74, 4, v0
    v_add_u32 v74, s70, v74
    s_mul_i32 s70, s66, 13
    s_add_u32 s70, s70, 1
    s_lshr_b32 s71, s70, 1
    s_lshl_b32 s71, s71, 10
    s_and_b32 s70, s70, 1
    s_lshl_b32 s70, s70, 3
    s_add_u32 s70, s70, s71
    s_add_u32 s70, s70, 34816
    v_lshlrev_b32 v75, 4, v0
    v_add_u32 v75, s70, v75
    s_waitcnt lgkmcnt(0)
    v_mov_b32 v16, 0
    v_mov_b32 v17, 0
    v_mov_b32 v18, 0
    v_mov_b32 v19, 0
    s_mov_b32 s73, 0xffff0000
    s_cmp_eq_u32 s66, 3
    s_cbranch_scc1 L_p1skip
    s_mul_i32 s17, s66, 11264
    s_add_u32 m0, s17, 0
    s_nop 0
    buffer_load_dwordx4 v47, s[36:39], m0 offen offset:0 lds
    buffer_load_dwordx4 v47, s[36:39], m0 offen offset:1024 lds
    buffer_load_dwordx4 v47, s[36:39], m0 offen offset:2048 lds
    buffer_load_dwordx4 v47, s[36:39], m0 offen offset:3072 lds
    s_add_u32 m0, s17, 4096
    s_nop 0
    buffer_load_dwordx4 v47, s[36:39], m0 offen offset:0 lds
    buffer_load_dwordx4 v47, s[36:39], m0 offen offset:1024 lds
    buffer_load_dwordx4 v47, s[36:39], m0 offen offset:2048 lds
    buffer_load_dwordx4 v47, s[36:39], m0 offen offset:3072 lds
    s_add_u32 m0, s17, 8192
    s_nop 0
    buffer_load_dwordx4 v47, s[36:39], m0 offen offset:0 lds
    buffer_load_dwordx4 v47, s[36:39], m0 offen offset:1024 lds
    buffer_load_dwordx4 v47, s[36:39], m0 offen offset:2048 lds
    s_lshl_b32 s70, s56, 16
    s_waitcnt vmcnt(35)
    v_lshlrev_b32 v32, 16, v128
    v_and_b32 v33, s73, v128
    v_lshlrev_b32 v34, 16, v129
    v_and_b32 v35, s73, v129
    v_pk_fma_f32 v[16:17], v[32:33], s[70:71], v[16:17] op_sel_hi:[1,0,1]
    v_pk_fma_f32 v[18:19], v[34:35], s[70:71], v[18:19] op_sel_hi:[1,0,1]
    s_and_b32 s70, s56, s73
    v_lshlrev_b32 v36, 16, v130
    v_and_b32 v37, s73, v130
    v_lshlrev_b32 v38, 16, v131
    v_and_b32 v39, s73, v131
    v_pk_fma_f32 v[16:17], v[36:37], s[70:71], v[16:17] op_sel_hi:[1,0,1]
    v_pk_fma_f32 v[18:19], v[38:39], s[70:71], v[18:19] op_sel_hi:[1,0,1]
    s_lshl_b32 s70, s57, 16
    s_waitcnt vmcnt(33)
    v_lshlrev_b32 v32, 16, v132
    v_and_b32 v33, s73, v132
    v_lshlrev_b32 v34, 16, v133
    v_and_b32 v35, s73, v133
    v_pk_fma_f32 v[16:17], v[32:33], s[70:71], v[16:17] op_sel_hi:[1,0,1]
    v_pk_fma_f32 v[18:19], v[34:35], s[70:71], v[18:19] op_sel_hi:[1,0,1]
    s_and_b32 s70, s57, s73
    v_lshlrev_b32 v36, 16, v134
    v_and_b32 v37, s73, v134
    v_lshlrev_b32 v38, 16, v135
    v_and_b32 v39, s73, v135
    v_pk_fma_f32 v[16:17], v[36:37], s[70:71], v[16:17] op_sel_hi:[1,0,1]
    v_pk_fma_f32 v[18:19], v[38:39], s[70:71], v[18:19] op_sel_hi:[1,0,1]
    s_lshl_b32 s70, s58, 16
    s_waitcnt vmcnt(31)
    v_lshlrev_b32 v32, 16, v136
    v_and_b32 v33, s73, v136
    v_lshlrev_b32 v34, 16, v137
    v_and_b32 v35, s73, v137
    v_pk_fma_f32 v[16:17], v[32:33], s[70:71], v[16:17] op_sel_hi:[1,0,1]
    v_pk_fma_f32 v[18:19], v[34:35], s[70:71], v[18:19] op_sel_hi:[1,0,1]
    s_and_b32 s70, s58, s73
    v_lshlrev_b32 v36, 16, v138
    v_and_b32 v37, s73, v138
    v_lshlrev_b32 v38, 16, v139
    v_and_b32 v39, s73, v139
    v_pk_fma_f32 v[16:17], v[36:37], s[70:71], v[16:17] op_sel_hi:[1,0,1]
    v_pk_fma_f32 v[18:19], v[38:39], s[70:71], v[18:19] op_sel_hi:[1,0,1]
    s_lshl_b32 s70, s59, 16
    s_waitcnt vmcnt(29)
    v_lshlrev_b32 v32, 16, v140
    v_and_b32 v33, s73, v140
    v_lshlrev_b32 v34, 16, v141
    v_and_b32 v35, s73, v141
    v_pk_fma_f32 v[16:17], v[32:33], s[70:71], v[16:17] op_sel_hi:[1,0,1]
    v_pk_fma_f32 v[18:19], v[34:35], s[70:71], v[18:19] op_sel_hi:[1,0,1]
    s_and_b32 s70, s59, s73
    v_lshlrev_b32 v36, 16, v142
    v_and_b32 v37, s73, v142
    v_lshlrev_b32 v38, 16, v143
    v_and_b32 v39, s73, v143
    v_pk_fma_f32 v[16:17], v[36:37], s[70:71], v[16:17] op_sel_hi:[1,0,1]
    v_pk_fma_f32 v[18:19], v[38:39], s[70:71], v[18:19] op_sel_hi:[1,0,1]
    s_lshl_b32 s70, s60, 16
    s_waitcnt vmcnt(27)
    v_lshlrev_b32 v32, 16, v144
    v_and_b32 v33, s73, v144
    v_lshlrev_b32 v34, 16, v145
    v_and_b32 v35, s73, v145
    v_pk_fma_f32 v[16:17], v[32:33], s[70:71], v[16:17] op_sel_hi:[1,0,1]
    v_pk_fma_f32 v[18:19], v[34:35], s[70:71], v[18:19] op_sel_hi:[1,0,1]
    s_and_b32 s70, s60, s73
    v_lshlrev_b32 v36, 16, v146
    v_and_b32 v37, s73, v146
    v_lshlrev_b32 v38, 16, v147
    v_and_b32 v39, s73, v147
    v_pk_fma_f32 v[16:17], v[36:37], s[70:71], v[16:17] op_sel_hi:[1,0,1]
    v_pk_fma_f32 v[18:19], v[38:39], s[70:71], v[18:19] op_sel_hi:[1,0,1]
    s_lshl_b32 s70, s61, 16
    s_waitcnt vmcnt(25)
    v_lshlrev_b32 v32, 16, v148
    v_and_b32 v33, s73, v148
    v_lshlrev_b32 v34, 16, v149
    v_and_b32 v35, s73, v149
    v_pk_fma_f32 v[16:17], v[32:33], s[70:71], v[16:17] op_sel_hi:[1,0,1]
    v_pk_fma_f32 v[18:19], v[34:35], s[70:71], v[18:19] op_sel_hi:[1,0,1]
    s_and_b32 s70, s61, s73
    v_lshlrev_b32 v36, 16, v150
    v_and_b32 v37, s73, v150
    v_lshlrev_b32 v38, 16, v151
    v_and_b32 v39, s73, v151
    v_pk_fma_f32 v[16:17], v[36:37], s[70:71], v[16:17] op_sel_hi:[1,0,1]
    v_pk_fma_f32 v[18:19], v[38:39], s[70:71], v[18:19] op_sel_hi:[1,0,1]
    s_lshl_b32 s70, s62, 16
    s_waitcnt vmcnt(23)
    v_lshlrev_b32 v32, 16, v152
    v_and_b32 v33, s73, v152
    v_lshlrev_b32 v34, 16, v153
    v_and_b32 v35, s73, v153
    v_pk_fma_f32 v[16:17], v[32:33], s[70:71], v[16:17] op_sel_hi:[1,0,1]
    v_pk_fma_f32 v[18:19], v[34:35], s[70:71], v[18:19] op_sel_hi:[1,0,1]
    s_and_b32 s70, s62, s73
    v_lshlrev_b32 v36, 16, v154
    v_and_b32 v37, s73, v154
    v_lshlrev_b32 v38, 16, v155
    v_and_b32 v39, s73, v155
    v_pk_fma_f32 v[16:17], v[36:37], s[70:71], v[16:17] op_sel_hi:[1,0,1]
    v_pk_fma_f32 v[18:19], v[38:39], s[70:71], v[18:19] op_sel_hi:[1,0,1]
    s_lshl_b32 s70, s63, 16
    s_waitcnt vmcnt(21)
    v_lshlrev_b32 v32, 16, v156
    v_and_b32 v33, s73, v156
    v_lshlrev_b32 v34, 16, v157
    v_and_b32 v35, s73, v157
    v_pk_fma_f32 v[16:17], v[32:33], s[70:71], v[16:17] op_sel_hi:[1,0,1]
    v_pk_fma_f32 v[18:19], v[34:35], s[70:71], v[18:19] op_sel_hi:[1,0,1]
    s_and_b32 s70, s63, s73
    v_lshlrev_b32 v36, 16, v158
    v_and_b32 v37, s73, v158
    v_lshlrev_b32 v38, 16, v159
    v_and_b32 v39, s73, v159
    v_pk_fma_f32 v[16:17], v[36:37], s[70:71], v[16:17] op_sel_hi:[1,0,1]
    v_pk_fma_f32 v[18:19], v[38:39], s[70:71], v[18:19] op_sel_hi:[1,0,1]
    s_lshl_b32 s70, s12, 16
    s_waitcnt vmcnt(19)
    v_lshlrev_b32 v32, 16, v160
    v_and_b32 v33, s73, v160
    v_lshlrev_b32 v34, 16, v161
    v_and_b32 v35, s73, v161
    v_pk_fma_f32 v[16:17], v[32:33], s[70:71], v[16:17] op_sel_hi:[1,0,1]
    v_pk_fma_f32 v[18:19], v[34:35], s[70:71], v[18:19] op_sel_hi:[1,0,1]
    s_and_b32 s70, s12, s73
    v_lshlrev_b32 v36, 16, v162
    v_and_b32 v37, s73, v162
    v_lshlrev_b32 v38, 16, v163
    v_and_b32 v39, s73, v163
    v_pk_fma_f32 v[16:17], v[36:37], s[70:71], v[16:17] op_sel_hi:[1,0,1]
    v_pk_fma_f32 v[18:19], v[38:39], s[70:71], v[18:19] op_sel_hi:[1,0,1]
    s_lshl_b32 s70, s13, 16
    s_waitcnt vmcnt(17)
    v_lshlrev_b32 v32, 16, v164
    v_and_b32 v33, s73, v164
    v_lshlrev_b32 v34, 16, v165
    v_and_b32 v35, s73, v165
    v_pk_fma_f32 v[16:17], v[32:33], s[70:71], v[16:17] op_sel_hi:[1,0,1]
    v_pk_fma_f32 v[18:19], v[34:35], s[70:71], v[18:19] op_sel_hi:[1,0,1]
    s_and_b32 s70, s13, s73
    v_lshlrev_b32 v36, 16, v166
    v_and_b32 v37, s73, v166
    v_lshlrev_b32 v38, 16, v167
    v_and_b32 v39, s73, v167
    v_pk_fma_f32 v[16:17], v[36:37], s[70:71], v[16:17] op_sel_hi:[1,0,1]
    v_pk_fma_f32 v[18:19], v[38:39], s[70:71], v[18:19] op_sel_hi:[1,0,1]
    s_lshl_b32 s70, s14, 16
    s_waitcnt vmcnt(15)
    v_lshlrev_b32 v32, 16, v168
    v_and_b32 v33, s73, v168
    v_lshlrev_b32 v34, 16, v169
    v_and_b32 v35, s73, v169
    v_pk_fma_f32 v[16:17], v[32:33], s[70:71], v[16:17] op_sel_hi:[1,0,1]
    v_pk_fma_f32 v[18:19], v[34:35], s[70:71], v[18:19] op_sel_hi:[1,0,1]
    s_and_b32 s70, s14, s73
    v_lshlrev_b32 v36, 16, v170
    v_and_b32 v37, s73, v170
    v_lshlrev_b32 v38, 16, v171
    v_and_b32 v39, s73, v171
    v_pk_fma_f32 v[16:17], v[36:37], s[70:71], v[16:17] op_sel_hi:[1,0,1]
    v_pk_fma_f32 v[18:19], v[38:39], s[70:71], v[18:19] op_sel_hi:[1,0,1]
    s_lshl_b32 s70, s15, 16
    s_waitcnt vmcnt(13)
    v_lshlrev_b32 v32, 16, v172
    v_and_b32 v33, s73, v172
    v_lshlrev_b32 v34, 16, v173
    v_and_b32 v35, s73, v173
    v_pk_fma_f32 v[16:17], v[32:33], s[70:71], v[16:17] op_sel_hi:[1,0,1]
    v_pk_fma_f32 v[18:19], v[34:35], s[70:71], v[18:19] op_sel_hi:[1,0,1]
    s_and_b32 s70, s15, s73
    v_lshlrev_b32 v36, 16, v174
    v_and_b32 v37, s73, v174
    v_lshlrev_b32 v38, 16, v175
    v_and_b32 v39, s73, v175
    v_pk_fma_f32 v[16:17], v[36:37], s[70:71], v[16:17] op_sel_hi:[1,0,1]
    v_pk_fma_f32 v[18:19], v[38:39], s[70:71], v[18:19] op_sel_hi:[1,0,1]
    s_lshl_b32 s70, s16, 16
    s_waitcnt vmcnt(11)
    v_lshlrev_b32 v32, 16, v176
    v_and_b32 v33, s73, v176
    v_lshlrev_b32 v34, 16, v177
    v_and_b32 v35, s73, v177
    v_pk_fma_f32 v[16:17], v[32:33], s[70:71], v[16:17] op_sel_hi:[1,0,1]
    v_pk_fma_f32 v[18:19], v[34:35], s[70:71], v[18:19] op_sel_hi:[1,0,1]
    s_and_b32 s70, s16, s73
    v_lshlrev_b32 v36, 16, v178
    v_and_b32 v37, s73, v178
    v_lshlrev_b32 v38, 16, v179
    v_and_b32 v39, s73, v179
    v_pk_fma_f32 v[16:17], v[36:37], s[70:71], v[16:17] op_sel_hi:[1,0,1]
    v_pk_fma_f32 v[18:19], v[38:39], s[70:71], v[18:19] op_sel_hi:[1,0,1]
L_p1skip:
    s_waitcnt vmcnt(0)
    v_cvt_pk_bf16_f32 v16, v16, v17
    v_cvt_pk_bf16_f32 v17, v18, v19
    v_lshlrev_b32 v2, 3, v1
    v_add_u32 v2, 139392, v2
    ds_write_b64 v2, v[16:17]
    v_mov_b32 v41, 145408
    ds_write_b64 v41, v[28:29]
    v_mul_u32_u24 v2, 52, v0
    v_add_u32 v2, 141440, v2
    v_add_u32_sdwa v48, v14, v224 dst_sel:DWORD dst_unused:UNUSED_PAD src0_sel:DWORD src1_sel:WORD_0
    v_add_u32_sdwa v61, v14, v224 dst_sel:DWORD dst_unused:UNUSED_PAD src0_sel:DWORD src1_sel:WORD_1
    v_add_u32_sdwa v49, v14, v225 dst_sel:DWORD dst_unused:UNUSED_PAD src0_sel:DWORD src1_sel:WORD_0
    v_add_u32_sdwa v62, v14, v225 dst_sel:DWORD dst_unused:UNUSED_PAD src0_sel:DWORD src1_sel:WORD_1
    v_add_u32_sdwa v50, v14, v226 dst_sel:DWORD dst_unused:UNUSED_PAD src0_sel:DWORD src1_sel:WORD_0
    v_add_u32_sdwa v63, v14, v226 dst_sel:DWORD dst_unused:UNUSED_PAD src0_sel:DWORD src1_sel:WORD_1
    v_add_u32_sdwa v51, v14, v227 dst_sel:DWORD dst_unused:UNUSED_PAD src0_sel:DWORD src1_sel:WORD_0
    v_add_u32_sdwa v64, v14, v227 dst_sel:DWORD dst_unused:UNUSED_PAD src0_sel:DWORD src1_sel:WORD_1
    v_add_u32_sdwa v52, v14, v228 dst_sel:DWORD dst_unused:UNUSED_PAD src0_sel:DWORD src1_sel:WORD_0
    v_add_u32_sdwa v65, v14, v228 dst_sel:DWORD dst_unused:UNUSED_PAD src0_sel:DWORD src1_sel:WORD_1
    v_add_u32_sdwa v53, v14, v229 dst_sel:DWORD dst_unused:UNUSED_PAD src0_sel:DWORD src1_sel:WORD_0
    v_add_u32_sdwa v66, v14, v229 dst_sel:DWORD dst_unused:UNUSED_PAD src0_sel:DWORD src1_sel:WORD_1
    v_add_u32_sdwa v54, v14, v230 dst_sel:DWORD dst_unused:UNUSED_PAD src0_sel:DWORD src1_sel:WORD_0
    v_add_u32_sdwa v67, v14, v230 dst_sel:DWORD dst_unused:UNUSED_PAD src0_sel:DWORD src1_sel:WORD_1
    v_add_u32_sdwa v55, v14, v231 dst_sel:DWORD dst_unused:UNUSED_PAD src0_sel:DWORD src1_sel:WORD_0
    v_add_u32_sdwa v68, v14, v231 dst_sel:DWORD dst_unused:UNUSED_PAD src0_sel:DWORD src1_sel:WORD_1
    v_add_u32_sdwa v56, v14, v232 dst_sel:DWORD dst_unused:UNUSED_PAD src0_sel:DWORD src1_sel:WORD_0
    v_add_u32_sdwa v69, v14, v232 dst_sel:DWORD dst_unused:UNUSED_PAD src0_sel:DWORD src1_sel:WORD_1
    v_add_u32_sdwa v57, v14, v233 dst_sel:DWORD dst_unused:UNUSED_PAD src0_sel:DWORD src1_sel:WORD_0
    v_add_u32_sdwa v70, v14, v233 dst_sel:DWORD dst_unused:UNUSED_PAD src0_sel:DWORD src1_sel:WORD_1
    v_add_u32_sdwa v58, v14, v234 dst_sel:DWORD dst_unused:UNUSED_PAD src0_sel:DWORD src1_sel:WORD_0
    v_add_u32_sdwa v71, v14, v234 dst_sel:DWORD dst_unused:UNUSED_PAD src0_sel:DWORD src1_sel:WORD_1
    v_add_u32_sdwa v59, v14, v235 dst_sel:DWORD dst_unused:UNUSED_PAD src0_sel:DWORD src1_sel:WORD_0
    v_add_u32_sdwa v72, v14, v235 dst_sel:DWORD dst_unused:UNUSED_PAD src0_sel:DWORD src1_sel:WORD_1
    v_add_u32_sdwa v60, v14, v236 dst_sel:DWORD dst_unused:UNUSED_PAD src0_sel:DWORD src1_sel:WORD_0
    v_add_u32_sdwa v73, v14, v236 dst_sel:DWORD dst_unused:UNUSED_PAD src0_sel:DWORD src1_sel:WORD_1
    v_mov_b32 v15, v11
    ds_write_b32 v2, v22
    buffer_load_dword v7, v250, s[40:43], s64 offen
    s_add_u32 s64, s64, 1277952
    s_waitcnt lgkmcnt(0)
    s_barrier
    ds_read_u16 v224, v12 offset:0
    ds_read_u16 v225, v12 offset:52
    ds_read_u16 v226, v12 offset:104
    ds_read_u16 v227, v12 offset:156
    ds_read_u16 v228, v12 offset:208
    ds_read_u16 v229, v12 offset:260
    ds_read_u16 v230, v12 offset:312
    ds_read_u16 v231, v12 offset:364
    ds_read_u16 v232, v12 offset:832
    ds_read_u16 v233, v12 offset:884
    ds_read_u16 v234, v12 offset:936
    ds_read_u16 v235, v12 offset:988
    ds_read_u16 v236, v12 offset:1040
    ds_read_u16 v237, v12 offset:1092
    ds_read_u16 v238, v12 offset:1144
    s_waitcnt lgkmcnt(12)
    ds_read_u16 v239, v12 offset:1196
    ds_read_b32 v241, v240
    v_add_u32 v240, 16, v240
    ds_read_b32 v24, v4 offset:0
    s_waitcnt lgkmcnt(12)
    ds_read_b32 v25, v4 offset:64
    v_add_u32 v4, 104, v4
    ds_read_b32 v26, v4 offset:0
    ds_read_b32 v27, v4 offset:64
    v_add_u32 v4, 104, v4
    s_waitcnt lgkmcnt(12)
    ds_read_b64_tr_b16 a[192:193], v10 offset:0
    ds_read_b64_tr_b16 a[194:195], v10 offset:5408
    ds_read_b64_tr_b16 a[196:197], v10 offset:21632
    s_waitcnt lgkmcnt(12)
    ds_read_b64_tr_b16 a[198:199], v10 offset:27040
    v_lshl_or_b32 v32, v225, 16, v224
    v_lshl_or_b32 v33, v227, 16, v226
    v_lshl_or_b32 v34, v229, 16, v228
    v_lshl_or_b32 v35, v231, 16, v230
    v_lshl_or_b32 v36, v233, 16, v232
    v_lshl_or_b32 v37, v235, 16, v234
    s_waitcnt lgkmcnt(11)
    v_lshl_or_b32 v38, v237, 16, v236
    s_waitcnt lgkmcnt(9)
    v_lshl_or_b32 v39, v239, 16, v238
    ds_read_b64_tr_b16 a[200:201], v10 offset:256
    ds_read_b64_tr_b16 a[202:203], v10 offset:5664
    ds_read_b64_tr_b16 a[204:205], v10 offset:21888
    ds_read_b64_tr_b16 a[206:207], v10 offset:27296
    s_waitcnt lgkmcnt(4)
    v_mfma_f32_32x32x16_bf16 v[128:143], v[32:35], a[192:195], 0
    v_mfma_f32_32x32x16_bf16 v[128:143], v[36:39], a[196:199], v[128:143]
    ds_read_b64_tr_b16 a[208:209], v10 offset:512
    ds_read_b64_tr_b16 a[210:211], v10 offset:5920
    ds_read_b64_tr_b16 a[212:213], v10 offset:22144
    ds_read_b64_tr_b16 a[214:215], v10 offset:27552
    s_waitcnt lgkmcnt(4)
    v_mfma_f32_32x32x16_bf16 v[144:159], v[32:35], a[200:203], 0
    v_mfma_f32_32x32x16_bf16 v[144:159], v[36:39], a[204:207], v[144:159]
    ds_read_b64_tr_b16 a[216:217], v10 offset:768
    ds_read_b64_tr_b16 a[218:219], v10 offset:6176
    ds_read_b64_tr_b16 a[220:221], v10 offset:22400
    ds_read_b64_tr_b16 a[222:223], v10 offset:27808
    s_waitcnt lgkmcnt(4)
    v_mfma_f32_32x32x16_bf16 v[160:175], v[32:35], a[208:211], 0
    v_mfma_f32_32x32x16_bf16 v[160:175], v[36:39], a[212:215], v[160:175]
    ds_read_b64_tr_b16 a[224:225], v10 offset:1024
    ds_read_b64_tr_b16 a[226:227], v10 offset:6432
    ds_read_b64_tr_b16 a[228:229], v10 offset:22656
    ds_read_b64_tr_b16 a[230:231], v10 offset:28064
    s_waitcnt lgkmcnt(4)
    v_mfma_f32_32x32x16_bf16 v[176:191], v[32:35], a[216:219], 0
    v_mfma_f32_32x32x16_bf16 v[176:191], v[36:39], a[220:223], v[176:191]
    ds_read_b64_tr_b16 a[232:233], v10 offset:1280
    ds_read_b64_tr_b16 a[234:235], v10 offset:6688
    ds_read_b64_tr_b16 a[236:237], v10 offset:22912
    ds_read_b64_tr_b16 a[238:239], v10 offset:28320
    s_waitcnt lgkmcnt(4)
    v_mfma_f32_32x32x16_bf16 v[192:207], v[32:35], a[224:227], 0
    v_mfma_f32_32x32x16_bf16 v[192:207], v[36:39], a[228:231], v[192:207]
    s_waitcnt lgkmcnt(0)
    v_mfma_f32_32x32x16_bf16 v[208:223], v[32:35], a[232:235], 0
    v_mfma_f32_32x32x16_bf16 v[208:223], v[36:39], a[236:239], v[208:223]
    v_mov_b32 v40, 0
    v_mov_b32 v45, 0
    v_max3_f32 v45, |v128|, |v129|, v45
    v_max3_f32 v40, |v130|, |v131|, v40
    v_max3_f32 v45, |v132|, |v133|, v45
    v_max3_f32 v40, |v134|, |v135|, v40
    v_max3_f32 v45, |v136|, |v137|, v45
    v_max3_f32 v40, |v138|, |v139|, v40
    v_max3_f32 v45, |v140|, |v141|, v45
    v_cvt_pk_bf16_f32 v128, v128, v129
    v_cvt_pk_bf16_f32 v129, v130, v131
    ds_write2_b32 v11, v128, v129 offset0:0 offset1:1
    v_cvt_pk_bf16_f32 v132, v132, v133
    v_cvt_pk_bf16_f32 v133, v134, v135
    ds_write2_b32 v11, v132, v133 offset0:4 offset1:5
    v_cvt_pk_bf16_f32 v136, v136, v137
    v_cvt_pk_bf16_f32 v137, v138, v139
    ds_write2_b32 v11, v136, v137 offset0:8 offset1:9
    v_cvt_pk_bf16_f32 v140, v140, v141
    v_cvt_pk_bf16_f32 v141, v142, v143
    v_add_u32 v11, 6656, v11
    v_lshlrev_b32 v241, 8, v241
    buffer_load_dword v7, v241, s[32:35], s65 offen
    ds_read_b32 v241, v240
    v_add_u32 v240, 16, v240
    v_max3_f32 v40, |v144|, |v145|, v40
    v_max3_f32 v45, |v146|, |v147|, v45
    v_max3_f32 v40, |v148|, |v149|, v40
    v_max3_f32 v45, |v150|, |v151|, v45
    v_max3_f32 v40, |v152|, |v153|, v40
    v_max3_f32 v45, |v154|, |v155|, v45
    v_max3_f32 v40, |v156|, |v157|, v40
    v_cvt_pk_bf16_f32 v144, v144, v145
    v_cvt_pk_bf16_f32 v145, v146, v147
    ds_write2_b32 v11, v144, v145 offset0:0 offset1:1
    v_cvt_pk_bf16_f32 v148, v148, v149
    v_cvt_pk_bf16_f32 v149, v150, v151
    ds_write2_b32 v11, v148, v149 offset0:4 offset1:5
    v_cvt_pk_bf16_f32 v152, v152, v153
    v_cvt_pk_bf16_f32 v153, v154, v155
    ds_write2_b32 v11, v152, v153 offset0:8 offset1:9
    v_cvt_pk_bf16_f32 v156, v156, v157
    v_cvt_pk_bf16_f32 v157, v158, v159
    v_add_u32 v11, 6656, v11
    s_add_u32 m0, s78, 0
    v_lshl_add_u32 v24, v24, 8, v6
    buffer_load_dwordx4 v24, s[32:35], 0 offen lds
    s_add_u32 m0, s78, 1024
    v_lshl_add_u32 v25, v25, 8, v251
    buffer_load_dwordx4 v25, s[32:35], 0 offen lds
    s_add_u32 m0, s78, 2048
    v_lshl_add_u32 v26, v26, 8, v6
    buffer_load_dwordx4 v26, s[32:35], 0 offen lds
    s_add_u32 m0, s78, 3072
    v_lshl_add_u32 v27, v27, 8, v251
    buffer_load_dwordx4 v27, s[32:35], 0 offen lds
    ds_read_b32 v24, v4 offset:0
    ds_read_b32 v25, v4 offset:64
    v_add_u32 v4, 104, v4
    v_max3_f32 v45, |v160|, |v161|, v45
    v_max3_f32 v40, |v162|, |v163|, v40
    v_max3_f32 v45, |v164|, |v165|, v45
    v_max3_f32 v40, |v166|, |v167|, v40
    v_max3_f32 v45, |v168|, |v169|, v45
    v_max3_f32 v40, |v170|, |v171|, v40
    v_max3_f32 v45, |v172|, |v173|, v45
    v_cvt_pk_bf16_f32 v160, v160, v161
    v_cvt_pk_bf16_f32 v161, v162, v163
    ds_write2_b32 v11, v160, v161 offset0:0 offset1:1
    v_cvt_pk_bf16_f32 v164, v164, v165
    v_cvt_pk_bf16_f32 v165, v166, v167
    ds_write2_b32 v11, v164, v165 offset0:4 offset1:5
    v_cvt_pk_bf16_f32 v168, v168, v169
    v_cvt_pk_bf16_f32 v169, v170, v171
    ds_write2_b32 v11, v168, v169 offset0:8 offset1:9
    v_cvt_pk_bf16_f32 v172, v172, v173
    v_cvt_pk_bf16_f32 v173, v174, v175
    v_add_u32 v11, 6656, v11
    v_max3_f32 v40, |v176|, |v177|, v40
    v_max3_f32 v45, |v178|, |v179|, v45
    v_max3_f32 v40, |v180|, |v181|, v40
    v_max3_f32 v45, |v182|, |v183|, v45
    v_max3_f32 v40, |v184|, |v185|, v40
    v_max3_f32 v45, |v186|, |v187|, v45
    v_max3_f32 v40, |v188|, |v189|, v40
    v_cvt_pk_bf16_f32 v176, v176, v177
    v_cvt_pk_bf16_f32 v177, v178, v179
    ds_write2_b32 v11, v176, v177 offset0:0 offset1:1
    v_cvt_pk_bf16_f32 v180, v180, v181
    v_cvt_pk_bf16_f32 v181, v182, v183
    ds_write2_b32 v11, v180, v181 offset0:4 offset1:5
    v_cvt_pk_bf16_f32 v184, v184, v185
    v_cvt_pk_bf16_f32 v185, v186, v187
    ds_write2_b32 v11, v184, v185 offset0:8 offset1:9
    v_cvt_pk_bf16_f32 v188, v188, v189
    v_cvt_pk_bf16_f32 v189, v190, v191
    v_add_u32 v11, 6656, v11
    v_max3_f32 v45, |v192|, |v193|, v45
    v_max3_f32 v40, |v194|, |v195|, v40
    v_max3_f32 v45, |v196|, |v197|, v45
    v_max3_f32 v40, |v198|, |v199|, v40
    v_max3_f32 v45, |v200|, |v201|, v45
    v_max3_f32 v40, |v202|, |v203|, v40
    v_max3_f32 v45, |v204|, |v205|, v45
    v_cvt_pk_bf16_f32 v192, v192, v193
    v_cvt_pk_bf16_f32 v193, v194, v195
    s_waitcnt lgkmcnt(12)
    ds_write2_b32 v11, v192, v193 offset0:0 offset1:1
    v_cvt_pk_bf16_f32 v196, v196, v197
    v_cvt_pk_bf16_f32 v197, v198, v199
    ds_write2_b32 v11, v196, v197 offset0:4 offset1:5
    v_cvt_pk_bf16_f32 v200, v200, v201
    v_cvt_pk_bf16_f32 v201, v202, v203
    ds_write2_b32 v11, v200, v201 offset0:8 offset1:9
    v_cvt_pk_bf16_f32 v204, v204, v205
    v_cvt_pk_bf16_f32 v205, v206, v207
    v_add_u32 v11, 6656, v11
    v_max3_f32 v40, |v208|, |v209|, v40
    v_max3_f32 v45, |v210|, |v211|, v45
    v_max3_f32 v40, |v212|, |v213|, v40
    v_max3_f32 v45, |v214|, |v215|, v45
    v_max3_f32 v40, |v216|, |v217|, v40
    v_max3_f32 v45, |v218|, |v219|, v45
    v_max3_f32 v40, |v220|, |v221|, v40
    v_cvt_pk_bf16_f32 v208, v208, v209
    v_cvt_pk_bf16_f32 v209, v210, v211
    s_waitcnt lgkmcnt(12)
    ds_write2_b32 v11, v208, v209 offset0:0 offset1:1
    v_cvt_pk_bf16_f32 v212, v212, v213
    v_cvt_pk_bf16_f32 v213, v214, v215
    ds_write2_b32 v11, v212, v213 offset0:4 offset1:5
    v_cvt_pk_bf16_f32 v216, v216, v217
    v_cvt_pk_bf16_f32 v217, v218, v219
    ds_write2_b32 v11, v216, v217 offset0:8 offset1:9
    v_cvt_pk_bf16_f32 v220, v220, v221
    v_cvt_pk_bf16_f32 v221, v222, v223
    s_mov_b32 exec_hi, 0
    s_waitcnt lgkmcnt(12)
    ds_write_b32 v15, v140 offset:48
    ds_write_b32 v13, v141 offset:0
    ds_write_b32 v15, v156 offset:6704
    s_waitcnt lgkmcnt(12)
    ds_write_b32 v13, v157 offset:512
    ds_write_b32 v15, v172 offset:13360
    ds_write_b32 v13, v173 offset:1024
    s_waitcnt lgkmcnt(12)
    ds_write_b32 v15, v188 offset:20016
    ds_write_b32 v13, v189 offset:1536
    ds_write_b32 v15, v204 offset:26672
    s_waitcnt lgkmcnt(12)
    ds_write_b32 v13, v205 offset:2048
    ds_write_b32 v15, v220 offset:33328
    ds_write_b32 v13, v221 offset:2560
    s_mov_b64 exec, s[76:77]
    s_mov_b32 s70, 0
    buffer_store_dwordx2 v[28:29], v5, s[48:51], s70 offen sc1
    s_mov_b32 s70, 65536
    buffer_store_dwordx2 v[28:29], v5, s[48:51], s70 offen sc1
    s_mov_b32 s70, 131072
    buffer_store_dwordx2 v[28:29], v5, s[48:51], s70 offen sc1
    s_mov_b32 s70, 196608
    s_cmp_lg_u32 s2, 0
    s_cbranch_scc1 L_noctr
    s_lshl_b32 s17, s66, 12
    s_add_u32 s17, s17, 0x40000
    buffer_store_dword v28, v28, s[48:51], s17 offen sc1
L_noctr:
    buffer_store_dwordx2 v[28:29], v5, s[48:51], s70 offen sc1
    s_mov_b64 exec, -1
    v_max_f32 v45, v45, v40
    v_mov_b32 v40, 0
    v_mov_b32 v47, 0
    s_cmp_eq_u32 s66, 3
    s_cbranch_scc1 L_pw3
    s_waitcnt lgkmcnt(12)
    ds_read2_b32 v[128:129], v48 offset0:0 offset1:13
    ds_read2_b32 v[130:131], v61 offset0:0 offset1:13
    v_add_u32 v48, 81920, v48
    v_add_u32 v61, 81920, v61
    ds_read2_b32 v[132:133], v49 offset0:0 offset1:13
    s_waitcnt lgkmcnt(12)
    ds_read2_b32 v[134:135], v62 offset0:0 offset1:13
    v_add_u32 v49, 81920, v49
    v_add_u32 v62, 81920, v62
    ds_read2_b32 v[136:137], v50 offset0:0 offset1:13
    ds_read2_b32 v[138:139], v63 offset0:0 offset1:13
    v_add_u32 v50, 81920, v50
    v_add_u32 v63, 81920, v63
    s_waitcnt lgkmcnt(12)
    ds_read2_b32 v[140:141], v51 offset0:0 offset1:13
    ds_read2_b32 v[142:143], v64 offset0:0 offset1:13
    v_add_u32 v51, 81920, v51
    v_add_u32 v64, 81920, v64
    ds_read2_b32 v[144:145], v52 offset0:0 offset1:13
    s_waitcnt lgkmcnt(12)
    ds_read2_b32 v[146:147], v65 offset0:0 offset1:13
    v_add_u32 v52, 81920, v52
    v_add_u32 v65, 81920, v65
    ds_read2_b32 v[148:149], v53 offset0:0 offset1:13
    ds_read2_b32 v[150:151], v66 offset0:0 offset1:13
    v_add_u32 v53, 81920, v53
    v_add_u32 v66, 81920, v66
    s_waitcnt lgkmcnt(10)
    v_lshlrev_b32 v32, 16, v128
    v_lshlrev_b32 v33, 16, v129
    v_lshlrev_b32 v36, 16, v130
    v_and_b32 v37, s73, v130
    v_and_b32 v34, s73, v128
    v_and_b32 v35, s73, v129
    v_lshlrev_b32 v38, 16, v131
    v_and_b32 v39, s73, v131
    v_pk_add_f32 v[76:77], v[32:33], v[36:37]
    v_pk_add_f32 v[78:79], v[34:35], v[38:39]
    ds_read2_b32 v[152:153], v54 offset0:0 offset1:13
    ds_read2_b32 v[154:155], v67 offset0:0 offset1:13
    v_add_u32 v54, 81920, v54
    v_add_u32 v67, 81920, v67
    s_waitcnt lgkmcnt(10)
    v_lshlrev_b32 v32, 16, v132
    v_lshlrev_b32 v33, 16, v133
    v_lshlrev_b32 v36, 16, v134
    v_and_b32 v37, s73, v134
    v_and_b32 v34, s73, v132
    v_and_b32 v35, s73, v133
    v_lshlrev_b32 v38, 16, v135
    v_and_b32 v39, s73, v135
    v_pk_add_f32 v[80:81], v[32:33], v[36:37]
    v_pk_add_f32 v[82:83], v[34:35], v[38:39]
    v_max3_f32 v40, |v76|, |v77|, v40
    v_max3_f32 v47, |v78|, |v79|, v47
    ds_read2_b32 v[156:157], v55 offset0:0 offset1:13
    ds_read2_b32 v[158:159], v68 offset0:0 offset1:13
    v_add_u32 v55, 81920, v55
    v_add_u32 v68, 81920, v68
    s_waitcnt lgkmcnt(10)
    v_lshlrev_b32 v32, 16, v136
    v_lshlrev_b32 v33, 16, v137
    v_lshlrev_b32 v36, 16, v138
    v_and_b32 v37, s73, v138
    v_and_b32 v34, s73, v136
    v_and_b32 v35, s73, v137
    v_lshlrev_b32 v38, 16, v139
    v_and_b32 v39, s73, v139
    v_pk_add_f32 v[84:85], v[32:33], v[36:37]
    v_pk_add_f32 v[86:87], v[34:35], v[38:39]
    v_max3_f32 v40, |v80|, |v81|, v40
    v_max3_f32 v47, |v82|, |v83|, v47
    ds_read2_b32 v[160:161], v56 offset0:0 offset1:13
    ds_read2_b32 v[162:163], v69 offset0:0 offset1:13
    v_add_u32 v56, 81920, v56
    v_add_u32 v69, 81920, v69
    buffer_load_dword v7, v250, s[40:43], s64 offen
    s_add_u32 s64, s64, 1277952
    s_waitcnt lgkmcnt(10)
    v_lshlrev_b32 v32, 16, v140
    v_lshlrev_b32 v33, 16, v141
    v_lshlrev_b32 v36, 16, v142
    v_and_b32 v37, s73, v142
    v_and_b32 v34, s73, v140
    v_and_b32 v35, s73, v141
    v_lshlrev_b32 v38, 16, v143
    v_and_b32 v39, s73, v143
    v_pk_add_f32 v[88:89], v[32:33], v[36:37]
    v_pk_add_f32 v[90:91], v[34:35], v[38:39]
    v_max3_f32 v40, |v84|, |v85|, v40
    v_max3_f32 v47, |v86|, |v87|, v47
    ds_read2_b32 v[164:165], v57 offset0:0 offset1:13
    ds_read2_b32 v[166:167], v70 offset0:0 offset1:13
    v_add_u32 v57, 81920, v57
    v_add_u32 v70, 81920, v70
    s_waitcnt lgkmcnt(10)
    v_lshlrev_b32 v32, 16, v144
    v_lshlrev_b32 v33, 16, v145
    v_lshlrev_b32 v36, 16, v146
    v_and_b32 v37, s73, v146
    v_and_b32 v34, s73, v144
    v_and_b32 v35, s73, v145
    v_lshlrev_b32 v38, 16, v147
    v_and_b32 v39, s73, v147
    v_pk_add_f32 v[92:93], v[32:33], v[36:37]
    v_pk_add_f32 v[94:95], v[34:35], v[38:39]
    v_max3_f32 v40, |v88|, |v89|, v40
    v_max3_f32 v47, |v90|, |v91|, v47
    ds_read2_b32 v[168:169], v58 offset0:0 offset1:13
    ds_read2_b32 v[170:171], v71 offset0:0 offset1:13
    v_add_u32 v58, 81920, v58
    v_add_u32 v71, 81920, v71
    s_waitcnt lgkmcnt(10)
    v_lshlrev_b32 v32, 16, v148
    v_lshlrev_b32 v33, 16, v149
    v_lshlrev_b32 v36, 16, v150
    v_and_b32 v37, s73, v150
    v_and_b32 v34, s73, v148
    v_and_b32 v35, s73, v149
    v_lshlrev_b32 v38, 16, v151
    v_and_b32 v39, s73, v151
    v_pk_add_f32 v[96:97], v[32:33], v[36:37]
    v_pk_add_f32 v[98:99], v[34:35], v[38:39]
    v_max3_f32 v40, |v92|, |v93|, v40
    v_max3_f32 v47, |v94|, |v95|, v47
    ds_read2_b32 v[172:173], v59 offset0:0 offset1:13
    ds_read2_b32 v[174:175], v72 offset0:0 offset1:13
    v_add_u32 v59, 81920, v59
    v_add_u32 v72, 81920, v72
    s_waitcnt lgkmcnt(10)
    v_lshlrev_b32 v32, 16, v152
    v_lshlrev_b32 v33, 16, v153
    v_lshlrev_b32 v36, 16, v154
    v_and_b32 v37, s73, v154
    v_and_b32 v34, s73, v152
    v_and_b32 v35, s73, v153
    v_lshlrev_b32 v38, 16, v155
    v_and_b32 v39, s73, v155
    v_pk_add_f32 v[100:101], v[32:33], v[36:37]
    v_pk_add_f32 v[102:103], v[34:35], v[38:39]
    v_max3_f32 v40, |v96|, |v97|, v40
    v_max3_f32 v47, |v98|, |v99|, v47
    ds_read2_b32 v[176:177], v60 offset0:0 offset1:13
    ds_read2_b32 v[178:179], v73 offset0:0 offset1:13
    v_add_u32 v60, 81920, v60
    v_add_u32 v73, 81920, v73
    s_waitcnt lgkmcnt(10)
    v_lshlrev_b32 v32, 16, v156
    v_lshlrev_b32 v33, 16, v157
    v_lshlrev_b32 v36, 16, v158
    v_and_b32 v37, s73, v158
    v_and_b32 v34, s73, v156
    v_and_b32 v35, s73, v157
    v_lshlrev_b32 v38, 16, v159
    v_and_b32 v39, s73, v159
    v_pk_add_f32 v[104:105], v[32:33], v[36:37]
    v_pk_add_f32 v[106:107], v[34:35], v[38:39]
    v_max3_f32 v40, |v100|, |v101|, v40
    v_max3_f32 v47, |v102|, |v103|, v47
    s_waitcnt lgkmcnt(8)
    v_lshlrev_b32 v32, 16, v160
    v_lshlrev_b32 v33, 16, v161
    v_lshlrev_b32 v36, 16, v162
    v_and_b32 v37, s73, v162
    v_and_b32 v34, s73, v160
    v_and_b32 v35, s73, v161
    v_lshlrev_b32 v38, 16, v163
    v_and_b32 v39, s73, v163
    v_pk_add_f32 v[108:109], v[32:33], v[36:37]
    v_pk_add_f32 v[110:111], v[34:35], v[38:39]
    v_max3_f32 v40, |v104|, |v105|, v40
    v_max3_f32 v47, |v106|, |v107|, v47
    s_waitcnt lgkmcnt(6)
    v_lshlrev_b32 v32, 16, v164
    v_lshlrev_b32 v33, 16, v165
    v_lshlrev_b32 v36, 16, v166
    v_and_b32 v37, s73, v166
    v_and_b32 v34, s73, v164
    v_and_b32 v35, s73, v165
    v_lshlrev_b32 v38, 16, v167
    v_and_b32 v39, s73, v167
    v_pk_add_f32 v[112:113], v[32:33], v[36:37]
    v_pk_add_f32 v[114:115], v[34:35], v[38:39]
    v_max3_f32 v40, |v108|, |v109|, v40
    v_max3_f32 v47, |v110|, |v111|, v47
    s_waitcnt lgkmcnt(4)
    v_lshlrev_b32 v32, 16, v168
    v_lshlrev_b32 v33, 16, v169
    v_lshlrev_b32 v36, 16, v170
    v_and_b32 v37, s73, v170
    v_and_b32 v34, s73, v168
    v_and_b32 v35, s73, v169
    v_lshlrev_b32 v38, 16, v171
    v_and_b32 v39, s73, v171
    v_pk_add_f32 v[116:117], v[32:33], v[36:37]
    v_pk_add_f32 v[118:119], v[34:35], v[38:39]
    v_max3_f32 v40, |v112|, |v113|, v40
    v_max3_f32 v47, |v114|, |v115|, v47
    s_waitcnt lgkmcnt(2)
    v_lshlrev_b32 v32, 16, v172
    v_lshlrev_b32 v33, 16, v173
    v_lshlrev_b32 v36, 16, v174
    v_and_b32 v37, s73, v174
    v_and_b32 v34, s73, v172
    v_and_b32 v35, s73, v173
    v_lshlrev_b32 v38, 16, v175
    v_and_b32 v39, s73, v175
    v_pk_add_f32 v[120:121], v[32:33], v[36:37]
    v_pk_add_f32 v[122:123], v[34:35], v[38:39]
    v_max3_f32 v40, |v116|, |v117|, v40
    v_max3_f32 v47, |v118|, |v119|, v47
    s_waitcnt lgkmcnt(0)
    v_lshlrev_b32 v32, 16, v176
    v_lshlrev_b32 v33, 16, v177
    v_lshlrev_b32 v36, 16, v178
    v_and_b32 v37, s73, v178
    v_and_b32 v34, s73, v176
    v_and_b32 v35, s73, v177
    v_lshlrev_b32 v38, 16, v179
    v_and_b32 v39, s73, v179
    v_pk_add_f32 v[124:125], v[32:33], v[36:37]
    v_pk_add_f32 v[126:127], v[34:35], v[38:39]
    v_max3_f32 v40, |v120|, |v121|, v40
    v_max3_f32 v47, |v122|, |v123|, v47
    v_max3_f32 v40, |v124|, |v125|, v40
    v_max3_f32 v47, |v126|, |v127|, v47
    v_max_f32 v40, v40, v47
    s_nop 1
    v_max_u32_dpp v40, v40, v40 row_shr:1
    v_max_u32_dpp v45, v45, v45 row_shr:1
    s_nop 0
    v_max_u32_dpp v40, v40, v40 row_shr:2
    v_max_u32_dpp v45, v45, v45 row_shr:2
    s_nop 0
    v_max_u32_dpp v40, v40, v40 row_shr:4
    v_max_u32_dpp v45, v45, v45 row_shr:4
    s_nop 0
    v_max_u32_dpp v40, v40, v40 row_shr:8
    v_max_u32_dpp v45, v45, v45 row_shr:8
    s_nop 0
    v_max_u32_dpp v40, v40, v40 row_bcast:15 row_mask:0xa
    v_max_u32_dpp v45, v45, v45 row_bcast:15 row_mask:0xa
    s_nop 0
    v_max_u32_dpp v40, v40, v40 row_bcast:31 row_mask:0xc
    v_max_u32_dpp v45, v45, v45 row_bcast:31 row_mask:0xc
    s_nop 0
    s_mov_b32 exec_lo, 0
    s_mov_b32 exec_hi, 0x80000000
    ds_max_u32 v41, v40
    ds_max_u32 v41, v45 offset:4
    s_mov_b64 exec, -1
    s_waitcnt lgkmcnt(0)
    s_barrier
    ds_read_b64 v[42:43], v41
    ds_read2_b32 v[128:129], v48 offset0:0 offset1:13
    ds_read2_b32 v[130:131], v61 offset0:0 offset1:13
    ds_read2_b32 v[132:133], v49 offset0:0 offset1:13
    ds_read2_b32 v[134:135], v62 offset0:0 offset1:13
    ds_read2_b32 v[136:137], v50 offset0:0 offset1:13
    ds_read2_b32 v[138:139], v63 offset0:0 offset1:13
    ds_read2_b32 v[140:141], v51 offset0:0 offset1:13
    ds_read2_b32 v[142:143], v64 offset0:0 offset1:13
    ds_read2_b32 v[144:145], v52 offset0:0 offset1:13
    ds_read2_b32 v[146:147], v65 offset0:0 offset1:13
    s_waitcnt lgkmcnt(10)
    v_and_b32 v42, 0x7f800000, v42
    v_and_b32 v43, 0x7f800000, v43
    v_max_u32 v42, 0x7800000, v42
    v_max_u32 v43, 0x7800000, v43
    v_sub_u32 v44, 0x86000000, v42
    v_sub_u32 v46, 0x85800000, v43
    v_subrev_u32 v30, 0x7000000, v42
    v_subrev_u32 v31, 0x6800000, v43
    v_mul_f32 v44, v44, v21
    v_mul_f32 v46, v46, v21
    ds_read2_b32 v[148:149], v53 offset0:0 offset1:13
    ds_read2_b32 v[150:151], v66 offset0:0 offset1:13
    buffer_load_dword v7, v250, s[40:43], s64 offen
    s_add_u32 s64, s64, 1277952
    s_waitcnt lgkmcnt(10)
    v_lshlrev_b32 v32, 16, v128
    v_lshlrev_b32 v33, 16, v129
    v_lshlrev_b32 v36, 16, v130
    v_and_b32 v37, s73, v130
    v_and_b32 v34, s73, v128
    v_and_b32 v35, s73, v129
    v_lshlrev_b32 v38, 16, v131
    v_and_b32 v39, s73, v131
    v_pk_add_f32 v[180:181], v[32:33], v[36:37]
    v_pk_add_f32 v[182:183], v[34:35], v[38:39]
    v_pk_mul_f32 v[76:77], v[76:77], v[44:45] op_sel_hi:[1,0]
    v_pk_mul_f32 v[78:79], v[78:79], v[44:45] op_sel_hi:[1,0]
    v_cvt_pk_f16_f32 v76, v76, v77
    v_cvt_pk_f16_f32 v77, v78, v79
    ds_write_b64 v74, v[76:77] offset:0
    v_pk_mul_f32 v[180:181], v[180:181], v[46:47] op_sel_hi:[1,0]
    v_pk_mul_f32 v[182:183], v[182:183], v[46:47] op_sel_hi:[1,0]
    v_cvt_pk_f16_f32 v180, v180, v181
    v_cvt_pk_f16_f32 v181, v182, v183
    ds_write_b64 v74, v[180:181] offset:22528
    ds_read2_b32 v[152:153], v54 offset0:0 offset1:13
    ds_read2_b32 v[154:155], v67 offset0:0 offset1:13
    s_waitcnt lgkmcnt(12)
    v_lshlrev_b32 v32, 16, v132
    v_lshlrev_b32 v33, 16, v133
    v_lshlrev_b32 v36, 16, v134
    v_and_b32 v37, s73, v134
    v_and_b32 v34, s73, v132
    v_and_b32 v35, s73, v133
    v_lshlrev_b32 v38, 16, v135
    v_and_b32 v39, s73, v135
    v_pk_add_f32 v[184:185], v[32:33], v[36:37]
    v_pk_add_f32 v[186:187], v[34:35], v[38:39]
    v_pk_mul_f32 v[80:81], v[80:81], v[44:45] op_sel_hi:[1,0]
    v_pk_mul_f32 v[82:83], v[82:83], v[44:45] op_sel_hi:[1,0]
    v_cvt_pk_f16_f32 v80, v80, v81
    v_cvt_pk_f16_f32 v81, v82, v83
    ds_write_b64 v75, v[80:81] offset:0
    v_pk_mul_f32 v[184:185], v[184:185], v[46:47] op_sel_hi:[1,0]
    v_pk_mul_f32 v[186:187], v[186:187], v[46:47] op_sel_hi:[1,0]
    v_cvt_pk_f16_f32 v184, v184, v185
    v_cvt_pk_f16_f32 v185, v186, v187
    ds_write_b64 v75, v[184:185] offset:22528
    ds_read2_b32 v[156:157], v55 offset0:0 offset1:13
    s_waitcnt lgkmcnt(12)
    ds_read2_b32 v[158:159], v68 offset0:0 offset1:13
    v_lshlrev_b32 v32, 16, v136
    v_lshlrev_b32 v33, 16, v137
    v_lshlrev_b32 v36, 16, v138
    v_and_b32 v37, s73, v138
    v_and_b32 v34, s73, v136
    v_and_b32 v35, s73, v137
    v_lshlrev_b32 v38, 16, v139
    v_and_b32 v39, s73, v139
    v_pk_add_f32 v[188:189], v[32:33], v[36:37]
    v_pk_add_f32 v[190:191], v[34:35], v[38:39]
    v_pk_mul_f32 v[84:85], v[84:85], v[44:45] op_sel_hi:[1,0]
    v_pk_mul_f32 v[86:87], v[86:87], v[44:45] op_sel_hi:[1,0]
    v_cvt_pk_f16_f32 v84, v84, v85
    v_cvt_pk_f16_f32 v85, v86, v87
    ds_write_b64 v74, v[84:85] offset:1024
    v_pk_mul_f32 v[188:189], v[188:189], v[46:47] op_sel_hi:[1,0]
    v_pk_mul_f32 v[190:191], v[190:191], v[46:47] op_sel_hi:[1,0]
    v_cvt_pk_f16_f32 v188, v188, v189
    v_cvt_pk_f16_f32 v189, v190, v191
    ds_write_b64 v74, v[188:189] offset:23552
    s_waitcnt lgkmcnt(12)
    ds_read2_b32 v[160:161], v56 offset0:0 offset1:13
    ds_read2_b32 v[162:163], v69 offset0:0 offset1:13
    v_lshlrev_b32 v32, 16, v140
    v_lshlrev_b32 v33, 16, v141
    v_lshlrev_b32 v36, 16, v142
    v_and_b32 v37, s73, v142
    v_and_b32 v34, s73, v140
    v_and_b32 v35, s73, v141
    v_lshlrev_b32 v38, 16, v143
    v_and_b32 v39, s73, v143
    v_pk_add_f32 v[192:193], v[32:33], v[36:37]
    v_pk_add_f32 v[194:195], v[34:35], v[38:39]
    v_pk_mul_f32 v[88:89], v[88:89], v[44:45] op_sel_hi:[1,0]
    v_pk_mul_f32 v[90:91], v[90:91], v[44:45] op_sel_hi:[1,0]
    v_cvt_pk_f16_f32 v88, v88, v89
    v_cvt_pk_f16_f32 v89, v90, v91
    ds_write_b64 v75, v[88:89] offset:1024
    v_pk_mul_f32 v[192:193], v[192:193], v[46:47] op_sel_hi:[1,0]
    v_pk_mul_f32 v[194:195], v[194:195], v[46:47] op_sel_hi:[1,0]
    v_cvt_pk_f16_f32 v192, v192, v193
    v_cvt_pk_f16_f32 v193, v194, v195
    s_waitcnt lgkmcnt(12)
    ds_write_b64 v75, v[192:193] offset:23552
    ds_read2_b32 v[164:165], v57 offset0:0 offset1:13
    ds_read2_b32 v[166:167], v70 offset0:0 offset1:13
    v_lshlrev_b32 v32, 16, v144
    v_lshlrev_b32 v33, 16, v145
    v_lshlrev_b32 v36, 16, v146
    v_and_b32 v37, s73, v146
    v_and_b32 v34, s73, v144
    v_and_b32 v35, s73, v145
    v_lshlrev_b32 v38, 16, v147
    v_and_b32 v39, s73, v147
    v_pk_add_f32 v[196:197], v[32:33], v[36:37]
    v_pk_add_f32 v[198:199], v[34:35], v[38:39]
    v_pk_mul_f32 v[92:93], v[92:93], v[44:45] op_sel_hi:[1,0]
    v_pk_mul_f32 v[94:95], v[94:95], v[44:45] op_sel_hi:[1,0]
    v_cvt_pk_f16_f32 v92, v92, v93
    v_cvt_pk_f16_f32 v93, v94, v95
    s_waitcnt lgkmcnt(12)
    ds_write_b64 v74, v[92:93] offset:2048
    v_pk_mul_f32 v[196:197], v[196:197], v[46:47] op_sel_hi:[1,0]
    v_pk_mul_f32 v[198:199], v[198:199], v[46:47] op_sel_hi:[1,0]
    v_cvt_pk_f16_f32 v196, v196, v197
    v_cvt_pk_f16_f32 v197, v198, v199
    ds_write_b64 v74, v[196:197] offset:24576
    ds_read2_b32 v[168:169], v58 offset0:0 offset1:13
    s_waitcnt lgkmcnt(12)
    ds_read2_b32 v[170:171], v71 offset0:0 offset1:13
    v_lshlrev_b32 v32, 16, v148
    v_lshlrev_b32 v33, 16, v149
    v_lshlrev_b32 v36, 16, v150
    v_and_b32 v37, s73, v150
    v_and_b32 v34, s73, v148
    v_and_b32 v35, s73, v149
    v_lshlrev_b32 v38, 16, v151
    v_and_b32 v39, s73, v151
    v_pk_add_f32 v[200:201], v[32:33], v[36:37]
    v_pk_add_f32 v[202:203], v[34:35], v[38:39]
    v_pk_mul_f32 v[96:97], v[96:97], v[44:45] op_sel_hi:[1,0]
    v_pk_mul_f32 v[98:99], v[98:99], v[44:45] op_sel_hi:[1,0]
    v_cvt_pk_f16_f32 v96, v96, v97
    v_cvt_pk_f16_f32 v97, v98, v99
    ds_write_b64 v75, v[96:97] offset:2048
    v_pk_mul_f32 v[200:201], v[200:201], v[46:47] op_sel_hi:[1,0]
    v_pk_mul_f32 v[202:203], v[202:203], v[46:47] op_sel_hi:[1,0]
    v_cvt_pk_f16_f32 v200, v200, v201
    v_cvt_pk_f16_f32 v201, v202, v203
    ds_write_b64 v75, v[200:201] offset:24576
    s_waitcnt lgkmcnt(12)
    ds_read2_b32 v[172:173], v59 offset0:0 offset1:13
    ds_read2_b32 v[174:175], v72 offset0:0 offset1:13
    v_lshlrev_b32 v32, 16, v152
    v_lshlrev_b32 v33, 16, v153
    v_lshlrev_b32 v36, 16, v154
    v_and_b32 v37, s73, v154
    v_and_b32 v34, s73, v152
    v_and_b32 v35, s73, v153
    v_lshlrev_b32 v38, 16, v155
    v_and_b32 v39, s73, v155
    v_pk_add_f32 v[204:205], v[32:33], v[36:37]
    v_pk_add_f32 v[206:207], v[34:35], v[38:39]
    v_pk_mul_f32 v[100:101], v[100:101], v[44:45] op_sel_hi:[1,0]
    v_pk_mul_f32 v[102:103], v[102:103], v[44:45] op_sel_hi:[1,0]
    v_cvt_pk_f16_f32 v100, v100, v101
    v_cvt_pk_f16_f32 v101, v102, v103
    ds_write_b64 v74, v[100:101] offset:3072
    v_pk_mul_f32 v[204:205], v[204:205], v[46:47] op_sel_hi:[1,0]
    v_pk_mul_f32 v[206:207], v[206:207], v[46:47] op_sel_hi:[1,0]
    v_cvt_pk_f16_f32 v204, v204, v205
    v_cvt_pk_f16_f32 v205, v206, v207
    s_waitcnt lgkmcnt(12)
    ds_write_b64 v74, v[204:205] offset:25600
    ds_read2_b32 v[176:177], v60 offset0:0 offset1:13
    ds_read2_b32 v[178:179], v73 offset0:0 offset1:13
    v_lshlrev_b32 v32, 16, v156
    v_lshlrev_b32 v33, 16, v157
    v_lshlrev_b32 v36, 16, v158
    v_and_b32 v37, s73, v158
    v_and_b32 v34, s73, v156
    v_and_b32 v35, s73, v157
    v_lshlrev_b32 v38, 16, v159
    v_and_b32 v39, s73, v159
    v_pk_add_f32 v[208:209], v[32:33], v[36:37]
    v_pk_add_f32 v[210:211], v[34:35], v[38:39]
    v_pk_mul_f32 v[104:105], v[104:105], v[44:45] op_sel_hi:[1,0]
    v_pk_mul_f32 v[106:107], v[106:107], v[44:45] op_sel_hi:[1,0]
    v_cvt_pk_f16_f32 v104, v104, v105
    v_cvt_pk_f16_f32 v105, v106, v107
    s_waitcnt lgkmcnt(12)
    ds_write_b64 v75, v[104:105] offset:3072
    v_pk_mul_f32 v[208:209], v[208:209], v[46:47] op_sel_hi:[1,0]
    v_pk_mul_f32 v[210:211], v[210:211], v[46:47] op_sel_hi:[1,0]
    v_cvt_pk_f16_f32 v208, v208, v209
    v_cvt_pk_f16_f32 v209, v210, v211
    ds_write_b64 v75, v[208:209] offset:25600
    v_lshlrev_b32 v241, 8, v241
    buffer_load_dword v7, v241, s[32:35], s65 offen
    ds_read_b32 v241, v240
    v_add_u32 v240, 16, v240
    v_lshlrev_b32 v32, 16, v160
    v_lshlrev_b32 v33, 16, v161
    v_lshlrev_b32 v36, 16, v162
    v_and_b32 v37, s73, v162
    v_and_b32 v34, s73, v160
    v_and_b32 v35, s73, v161
    v_lshlrev_b32 v38, 16, v163
    v_and_b32 v39, s73, v163
    v_pk_add_f32 v[212:213], v[32:33], v[36:37]
    v_pk_add_f32 v[214:215], v[34:35], v[38:39]
    v_pk_mul_f32 v[108:109], v[108:109], v[44:45] op_sel_hi:[1,0]
    v_pk_mul_f32 v[110:111], v[110:111], v[44:45] op_sel_hi:[1,0]
    v_cvt_pk_f16_f32 v108, v108, v109
    v_cvt_pk_f16_f32 v109, v110, v111
    s_waitcnt lgkmcnt(12)
    ds_write_b64 v74, v[108:109] offset:4096
    v_pk_mul_f32 v[212:213], v[212:213], v[46:47] op_sel_hi:[1,0]
    v_pk_mul_f32 v[214:215], v[214:215], v[46:47] op_sel_hi:[1,0]
    v_cvt_pk_f16_f32 v212, v212, v213
    v_cvt_pk_f16_f32 v213, v214, v215
    ds_write_b64 v74, v[212:213] offset:26624
    v_lshlrev_b32 v32, 16, v164
    v_lshlrev_b32 v33, 16, v165
    v_lshlrev_b32 v36, 16, v166
    v_and_b32 v37, s73, v166
    v_and_b32 v34, s73, v164
    v_and_b32 v35, s73, v165
    v_lshlrev_b32 v38, 16, v167
    v_and_b32 v39, s73, v167
    v_pk_add_f32 v[216:217], v[32:33], v[36:37]
    v_pk_add_f32 v[218:219], v[34:35], v[38:39]
    v_pk_mul_f32 v[112:113], v[112:113], v[44:45] op_sel_hi:[1,0]
    v_pk_mul_f32 v[114:115], v[114:115], v[44:45] op_sel_hi:[1,0]
    v_cvt_pk_f16_f32 v112, v112, v113
    v_cvt_pk_f16_f32 v113, v114, v115
    ds_write_b64 v75, v[112:113] offset:4096
    v_pk_mul_f32 v[216:217], v[216:217], v[46:47] op_sel_hi:[1,0]
    v_pk_mul_f32 v[218:219], v[218:219], v[46:47] op_sel_hi:[1,0]
    v_cvt_pk_f16_f32 v216, v216, v217
    v_cvt_pk_f16_f32 v217, v218, v219
    s_waitcnt lgkmcnt(12)
    ds_write_b64 v75, v[216:217] offset:26624
    v_lshlrev_b32 v32, 16, v168
    v_lshlrev_b32 v33, 16, v169
    v_lshlrev_b32 v36, 16, v170
    v_and_b32 v37, s73, v170
    v_and_b32 v34, s73, v168
    v_and_b32 v35, s73, v169
    v_lshlrev_b32 v38, 16, v171
    v_and_b32 v39, s73, v171
    v_pk_add_f32 v[220:221], v[32:33], v[36:37]
    v_pk_add_f32 v[222:223], v[34:35], v[38:39]
    v_pk_mul_f32 v[116:117], v[116:117], v[44:45] op_sel_hi:[1,0]
    v_pk_mul_f32 v[118:119], v[118:119], v[44:45] op_sel_hi:[1,0]
    v_cvt_pk_f16_f32 v116, v116, v117
    v_cvt_pk_f16_f32 v117, v118, v119
    ds_write_b64 v74, v[116:117] offset:5120
    v_pk_mul_f32 v[220:221], v[220:221], v[46:47] op_sel_hi:[1,0]
    v_pk_mul_f32 v[222:223], v[222:223], v[46:47] op_sel_hi:[1,0]
    v_cvt_pk_f16_f32 v220, v220, v221
    v_cvt_pk_f16_f32 v221, v222, v223
    ds_write_b64 v74, v[220:221] offset:27648
    s_waitcnt lgkmcnt(13)
    v_lshlrev_b32 v32, 16, v172
    v_lshlrev_b32 v33, 16, v173
    v_lshlrev_b32 v36, 16, v174
    v_and_b32 v37, s73, v174
    v_and_b32 v34, s73, v172
    v_and_b32 v35, s73, v173
    v_lshlrev_b32 v38, 16, v175
    v_and_b32 v39, s73, v175
    v_pk_add_f32 v[224:225], v[32:33], v[36:37]
    v_pk_add_f32 v[226:227], v[34:35], v[38:39]
    v_pk_mul_f32 v[120:121], v[120:121], v[44:45] op_sel_hi:[1,0]
    v_pk_mul_f32 v[122:123], v[122:123], v[44:45] op_sel_hi:[1,0]
    v_cvt_pk_f16_f32 v120, v120, v121
    v_cvt_pk_f16_f32 v121, v122, v123
    ds_write_b64 v75, v[120:121] offset:5120
    v_pk_mul_f32 v[224:225], v[224:225], v[46:47] op_sel_hi:[1,0]
    v_pk_mul_f32 v[226:227], v[226:227], v[46:47] op_sel_hi:[1,0]
    v_cvt_pk_f16_f32 v224, v224, v225
    v_cvt_pk_f16_f32 v225, v226, v227
    ds_write_b64 v75, v[224:225] offset:27648
    s_waitcnt lgkmcnt(11)
    v_lshlrev_b32 v32, 16, v176
    v_lshlrev_b32 v33, 16, v177
    v_lshlrev_b32 v36, 16, v178
    v_and_b32 v37, s73, v178
    v_and_b32 v34, s73, v176
    v_and_b32 v35, s73, v177
    v_lshlrev_b32 v38, 16, v179
    v_and_b32 v39, s73, v179
    v_pk_add_f32 v[228:229], v[32:33], v[36:37]
    v_pk_add_f32 v[230:231], v[34:35], v[38:39]
    v_pk_mul_f32 v[124:125], v[124:125], v[44:45] op_sel_hi:[1,0]
    v_pk_mul_f32 v[126:127], v[126:127], v[44:45] op_sel_hi:[1,0]
    v_cvt_pk_f16_f32 v124, v124, v125
    v_cvt_pk_f16_f32 v125, v126, v127
    ds_write_b64 v74, v[124:125] offset:6144
    v_pk_mul_f32 v[228:229], v[228:229], v[46:47] op_sel_hi:[1,0]
    v_pk_mul_f32 v[230:231], v[230:231], v[46:47] op_sel_hi:[1,0]
    v_cvt_pk_f16_f32 v228, v228, v229
    v_cvt_pk_f16_f32 v229, v230, v231
    ds_write_b64 v74, v[228:229] offset:28672
    s_waitcnt lgkmcnt(0)
    v_lshlrev_b32 v2, 4, v0
    v_add_u32 v2, 34816, v2
    v_lshlrev_b32 v12, 1, v8
    v_add_u32 v12, s78, v12
    v_mul_i32_i24 v10, 128, v9
    v_add_u32 v10, v10, v12
    v_mul_i32_i24 v11, -384, v9
    v_add_u32 v11, v11, v12
    v_mov_b32 v32, 0
    v_mov_b32 v33, 0
    v_mov_b32 v34, 0
    v_mov_b32 v35, 0
    v_mov_b32 v36, 0
    v_mov_b32 v37, 0
    v_mov_b32 v38, 0
    v_mov_b32 v39, 0
    v_mov_b32 v40, 0
    v_mov_b32 v41, 0
    v_mov_b32 v42, 0
    v_mov_b32 v43, 0
    v_mov_b32 v44, 0
    v_mov_b32 v45, 0
    v_mov_b32 v46, 0
    v_mov_b32 v47, 0
    v_mov_b32 v48, 0
    v_mov_b32 v49, 0
    v_mov_b32 v50, 0
    v_mov_b32 v51, 0
    v_mov_b32 v52, 0
    v_mov_b32 v53, 0
    v_mov_b32 v54, 0
    v_mov_b32 v55, 0
    v_mov_b32 v56, 0
    v_mov_b32 v57, 0
    s_waitcnt vmcnt(7)
    ds_read_u16_d16_hi v32, v10 offset:0
    ds_read_u16_d16_hi v33, v10 offset:64
    ds_read_u16_d16_hi v34, v10 offset:128
    ds_read_u16_d16_hi v35, v10 offset:192
    ds_read_u16_d16_hi v36, v10 offset:256
    ds_read_u16_d16_hi v37, v10 offset:320
    ds_read_u16_d16_hi v38, v11 offset:384
    ds_read_u16_d16_hi v39, v11 offset:448
    ds_read_u16_d16_hi v40, v10 offset:512
    ds_read_u16_d16_hi v41, v10 offset:576
    ds_read_u16_d16_hi v42, v10 offset:640
    ds_read_u16_d16_hi v43, v10 offset:704
    ds_read_u16_d16_hi v44, v10 offset:768
    s_lshl_b32 s70, s66, 8
    v_lshlrev_b32 v14, 2, v0
    v_add_u32 v14, s70, v14
    s_mov_b32 s72, 0
    s_mov_b32 s73, -1
    v_mov_b32 v13, 0x03020100
    v_mov_b32 v3, 0x01000302
    v_cndmask_b32 v13, v13, v3, s[72:73]
    s_mov_b32 s70, 0x43000000
    s_mov_b32 s71, 0x3d800000
    v_mov_b32 v111, 0x3f80
    s_waitcnt lgkmcnt(0)
    ds_read_u16_d16_hi v45, v10 offset:832
    ds_read_u16_d16_hi v46, v11 offset:896
    ds_read_u16_d16_hi v47, v11 offset:960
    ds_read_u16_d16_hi v48, v10 offset:1024
    ds_read_u16_d16_hi v49, v10 offset:1088
    ds_read_u16_d16_hi v50, v10 offset:1152
    ds_read_u16_d16_hi v51, v10 offset:1216
    ds_read_u16_d16_hi v52, v10 offset:1280
    ds_read_u16_d16_hi v53, v10 offset:1344
    ds_read_u16_d16_hi v54, v11 offset:1408
    ds_read_u16_d16_hi v55, v11 offset:1472
    ds_read_u16_d16_hi v56, v12 offset:1536
    ds_read_u16_d16_hi v57, v12 offset:1600
    s_waitcnt vmcnt(3)
    s_waitcnt lgkmcnt(0)
    s_barrier
    s_branch L_p3done
L_pw3:
    v_mul_u32_u24 v48, 108, v9
    v_add_u32 v48, v48, v14
    v_add_u32 v49, 648, v48
    v_add_u32 v50, 1296, v14
    s_mov_b32 s72, 0
    s_mov_b32 s73, -1
    s_mov_b32 s71, 0xffff0000
    s_waitcnt lgkmcnt(12)
    ds_read2_b32 v[128:129], v48 offset0:0 offset1:13
    ds_read2_b32 v[130:131], v48 offset0:54 offset1:67
    ds_read2_b32 v[132:133], v48 offset0:108 offset1:121
    s_waitcnt lgkmcnt(12)
    ds_read2_b32 v[134:135], v49 offset0:0 offset1:13
    ds_read2_b32 v[136:137], v49 offset0:54 offset1:67
    ds_read2_b32 v[138:139], v49 offset0:108 offset1:121
    s_waitcnt lgkmcnt(12)
    ds_read2_b32 v[140:141], v50 offset0:0 offset1:13
    s_waitcnt lgkmcnt(6)
    v_lshlrev_b32 v76, 16, v128
    v_and_b32 v77, s71, v129
    v_and_b32 v32, s71, v128
    v_lshlrev_b32 v33, 16, v129
    v_add_f32 v90, v32, v33
    s_waitcnt lgkmcnt(5)
    v_lshlrev_b32 v78, 16, v130
    v_and_b32 v79, s71, v131
    v_and_b32 v32, s71, v130
    v_lshlrev_b32 v33, 16, v131
    v_add_f32 v91, v32, v33
    s_waitcnt lgkmcnt(4)
    v_lshlrev_b32 v80, 16, v132
    v_and_b32 v81, s71, v133
    v_and_b32 v32, s71, v132
    v_lshlrev_b32 v33, 16, v133
    v_add_f32 v92, v32, v33
    s_waitcnt lgkmcnt(3)
    v_lshlrev_b32 v82, 16, v134
    v_and_b32 v83, s71, v135
    v_and_b32 v32, s71, v134
    v_lshlrev_b32 v33, 16, v135
    v_add_f32 v93, v32, v33
    s_waitcnt lgkmcnt(2)
    v_lshlrev_b32 v84, 16, v136
    v_and_b32 v85, s71, v137
    v_and_b32 v32, s71, v136
    v_lshlrev_b32 v33, 16, v137
    v_add_f32 v94, v32, v33
    s_waitcnt lgkmcnt(1)
    v_lshlrev_b32 v86, 16, v138
    v_and_b32 v87, s71, v139
    v_and_b32 v32, s71, v138
    v_lshlrev_b32 v33, 16, v139
    v_add_f32 v95, v32, v33
    s_waitcnt lgkmcnt(0)
    v_lshlrev_b32 v32, 16, v140
    v_and_b32 v33, s71, v141
    v_cndmask_b32 v88, v32, v33, s[72:73]
    v_and_b32 v32, s71, v140
    v_lshlrev_b32 v33, 16, v141
    v_cndmask_b32 v89, v32, v33, s[72:73]
    v_max3_f32 v40, |v76|, |v77|, v40
    v_max3_f32 v40, |v78|, |v79|, v40
    v_max3_f32 v40, |v80|, |v81|, v40
    v_max3_f32 v40, |v82|, |v83|, v40
    v_max3_f32 v40, |v84|, |v85|, v40
    v_max3_f32 v40, |v86|, |v87|, v40
    v_max3_f32 v40, |v88|, |v89|, v40
    v_max3_f32 v40, |v90|, |v91|, v40
    v_max3_f32 v40, |v92|, |v93|, v40
    v_max3_f32 v40, |v94|, |v95|, v40
    v_max_f32 v40, v40, v47
    s_nop 1
    v_max_u32_dpp v40, v40, v40 row_shr:1
    v_max_u32_dpp v45, v45, v45 row_shr:1
    s_nop 0
    v_max_u32_dpp v40, v40, v40 row_shr:2
    v_max_u32_dpp v45, v45, v45 row_shr:2
    s_nop 0
    v_max_u32_dpp v40, v40, v40 row_shr:4
    v_max_u32_dpp v45, v45, v45 row_shr:4
    s_nop 0
    v_max_u32_dpp v40, v40, v40 row_shr:8
    v_max_u32_dpp v45, v45, v45 row_shr:8
    s_nop 0
    v_max_u32_dpp v40, v40, v40 row_bcast:15 row_mask:0xa
    v_max_u32_dpp v45, v45, v45 row_bcast:15 row_mask:0xa
    s_nop 0
    v_max_u32_dpp v40, v40, v40 row_bcast:31 row_mask:0xc
    v_max_u32_dpp v45, v45, v45 row_bcast:31 row_mask:0xc
    s_nop 0
    s_mov_b32 exec_lo, 0
    s_mov_b32 exec_hi, 0x80000000
    ds_max_u32 v41, v40
    ds_max_u32 v41, v45 offset:4
    s_mov_b64 exec, -1
    buffer_load_dword v7, v250, s[40:43], s64 offen
    s_add_u32 s64, s64, 1277952
    v_add_u32 v48, 81920, v48
    v_add_u32 v49, 81920, v49
    v_add_u32 v50, 81920, v50
    v_mul_u32_u24 v51, 104, v20
    v_add_u32 v51, 121856, v51
    v_lshl_add_u32 v52, v9, 2, v51
    v_lshl_add_u32 v51, v9, 3, v51
    s_waitcnt lgkmcnt(0)
    s_barrier
    ds_read_b64 v[42:43], v41
    s_waitcnt lgkmcnt(0)
    v_and_b32 v42, 0x7f800000, v42
    v_and_b32 v43, 0x7f800000, v43
    v_max_u32 v42, 0x7800000, v42
    v_max_u32 v43, 0x7800000, v43
    v_sub_u32 v44, 0x86000000, v42
    v_sub_u32 v46, 0x85800000, v43
    v_subrev_u32 v30, 0x7000000, v42
    v_subrev_u32 v31, 0x6800000, v43
    v_mul_f32 v44, v44, v21
    v_mul_f32 v46, v46, v21
    buffer_load_dword v7, v250, s[40:43], s64 offen
    s_add_u32 s64, s64, 1277952
    ds_read2_b32 v[128:129], v48 offset0:0 offset1:13
    ds_read2_b32 v[130:131], v48 offset0:54 offset1:67
    ds_read2_b32 v[132:133], v48 offset0:108 offset1:121
    ds_read2_b32 v[134:135], v49 offset0:0 offset1:13
    ds_read2_b32 v[136:137], v49 offset0:54 offset1:67
    ds_read2_b32 v[138:139], v49 offset0:108 offset1:121
    ds_read2_b32 v[140:141], v50 offset0:0 offset1:13
    s_waitcnt lgkmcnt(6)
    v_lshlrev_b32 v180, 16, v128
    v_and_b32 v181, s71, v129
    v_and_b32 v32, s71, v128
    v_lshlrev_b32 v33, 16, v129
    v_add_f32 v194, v32, v33
    s_waitcnt lgkmcnt(5)
    v_lshlrev_b32 v182, 16, v130
    v_and_b32 v183, s71, v131
    v_and_b32 v32, s71, v130
    v_lshlrev_b32 v33, 16, v131
    v_add_f32 v195, v32, v33
    s_waitcnt lgkmcnt(4)
    v_lshlrev_b32 v184, 16, v132
    v_and_b32 v185, s71, v133
    v_and_b32 v32, s71, v132
    v_lshlrev_b32 v33, 16, v133
    v_add_f32 v196, v32, v33
    s_waitcnt lgkmcnt(3)
    v_lshlrev_b32 v186, 16, v134
    v_and_b32 v187, s71, v135
    v_and_b32 v32, s71, v134
    v_lshlrev_b32 v33, 16, v135
    v_add_f32 v197, v32, v33
    s_waitcnt lgkmcnt(2)
    v_lshlrev_b32 v188, 16, v136
    v_and_b32 v189, s71, v137
    v_and_b32 v32, s71, v136
    v_lshlrev_b32 v33, 16, v137
    v_add_f32 v198, v32, v33
    s_waitcnt lgkmcnt(1)
    v_lshlrev_b32 v190, 16, v138
    v_and_b32 v191, s71, v139
    v_and_b32 v32, s71, v138
    v_lshlrev_b32 v33, 16, v139
    v_add_f32 v199, v32, v33
    s_waitcnt lgkmcnt(0)
    v_lshlrev_b32 v32, 16, v140
    v_and_b32 v33, s71, v141
    v_cndmask_b32 v192, v32, v33, s[72:73]
    v_and_b32 v32, s71, v140
    v_lshlrev_b32 v33, 16, v141
    v_cndmask_b32 v193, v32, v33, s[72:73]
    v_pk_mul_f32 v[76:77], v[76:77], v[44:45] op_sel_hi:[1,0]
    v_pk_mul_f32 v[78:79], v[78:79], v[44:45] op_sel_hi:[1,0]
    v_cvt_pk_f16_f32 v76, v76, v77
    v_cvt_pk_f16_f32 v77, v78, v79
    ds_write_b64 v74, v[76:77] offset:0
    v_pk_mul_f32 v[80:81], v[80:81], v[44:45] op_sel_hi:[1,0]
    v_pk_mul_f32 v[82:83], v[82:83], v[44:45] op_sel_hi:[1,0]
    v_cvt_pk_f16_f32 v80, v80, v81
    v_cvt_pk_f16_f32 v81, v82, v83
    ds_write_b64 v75, v[80:81] offset:0
    v_pk_mul_f32 v[84:85], v[84:85], v[44:45] op_sel_hi:[1,0]
    v_pk_mul_f32 v[86:87], v[86:87], v[44:45] op_sel_hi:[1,0]
    v_cvt_pk_f16_f32 v84, v84, v85
    v_cvt_pk_f16_f32 v85, v86, v87
    ds_write_b64 v74, v[84:85] offset:1024
    v_pk_mul_f32 v[88:89], v[88:89], v[44:45] op_sel_hi:[1,0]
    v_pk_mul_f32 v[90:91], v[90:91], v[44:45] op_sel_hi:[1,0]
    v_cvt_pk_f16_f32 v88, v88, v89
    v_cvt_pk_f16_f32 v89, v90, v91
    ds_write_b64 v75, v[88:89] offset:1024
    v_pk_mul_f32 v[92:93], v[92:93], v[44:45] op_sel_hi:[1,0]
    v_pk_mul_f32 v[94:95], v[94:95], v[44:45] op_sel_hi:[1,0]
    v_cvt_pk_f16_f32 v92, v92, v93
    v_cvt_pk_f16_f32 v93, v94, v95
    ds_write_b64 v74, v[92:93] offset:2048
    v_pk_mul_f32 v[180:181], v[180:181], v[46:47] op_sel_hi:[1,0]
    v_pk_mul_f32 v[182:183], v[182:183], v[46:47] op_sel_hi:[1,0]
    v_cvt_pk_f16_f32 v180, v180, v181
    v_cvt_pk_f16_f32 v181, v182, v183
    ds_write_b64 v74, v[180:181] offset:22528
    v_pk_mul_f32 v[184:185], v[184:185], v[46:47] op_sel_hi:[1,0]
    v_pk_mul_f32 v[186:187], v[186:187], v[46:47] op_sel_hi:[1,0]
    v_cvt_pk_f16_f32 v184, v184, v185
    v_cvt_pk_f16_f32 v185, v186, v187
    ds_write_b64 v75, v[184:185] offset:22528
    v_pk_mul_f32 v[188:189], v[188:189], v[46:47] op_sel_hi:[1,0]
    v_pk_mul_f32 v[190:191], v[190:191], v[46:47] op_sel_hi:[1,0]
    v_cvt_pk_f16_f32 v188, v188, v189
    v_cvt_pk_f16_f32 v189, v190, v191
    ds_write_b64 v74, v[188:189] offset:23552
    v_pk_mul_f32 v[192:193], v[192:193], v[46:47] op_sel_hi:[1,0]
    v_pk_mul_f32 v[194:195], v[194:195], v[46:47] op_sel_hi:[1,0]
    v_cvt_pk_f16_f32 v192, v192, v193
    v_cvt_pk_f16_f32 v193, v194, v195
    ds_write_b64 v75, v[192:193] offset:23552
    v_pk_mul_f32 v[196:197], v[196:197], v[46:47] op_sel_hi:[1,0]
    v_pk_mul_f32 v[198:199], v[198:199], v[46:47] op_sel_hi:[1,0]
    v_cvt_pk_f16_f32 v196, v196, v197
    v_cvt_pk_f16_f32 v197, v198, v199
    ds_write_b64 v74, v[196:197] offset:24576
    ds_read2_b32 v[56:57], v51 offset0:0 offset1:1
    ds_read2_b32 v[58:59], v51 offset0:4 offset1:5
    ds_read2_b32 v[60:61], v51 offset0:8 offset1:9
    ds_read2_b32 v[62:63], v51 offset0:12 offset1:13
    ds_read2_b32 v[64:65], v51 offset0:16 offset1:17
    s_waitcnt lgkmcnt(12)
    ds_read2_b32 v[66:67], v51 offset0:20 offset1:21
    ds_read_b32 v68, v52 offset:96
    v_lshlrev_b32 v241, 8, v241
    buffer_load_dword v7, v241, s[32:35], s65 offen
    ds_read_b32 v241, v240
    v_add_u32 v240, 16, v240
    s_mov_b32 s70, 0x05040100
    v_cmp_neq_f32 vcc, 0, v21
    s_waitcnt lgkmcnt(1)
    v_perm_b32 v144, v57, v56, s70
    v_perm_b32 v145, v59, v58, s70
    v_perm_b32 v146, v61, v60, s70
    v_perm_b32 v147, v63, v62, s70
    v_perm_b32 v148, v65, v64, s70
    v_perm_b32 v149, v67, v66, s70
    v_and_b32 v150, 0xffff, v68
    v_mov_b32 v151, v23
    v_cndmask_b32 v144, 0, v144, vcc
    v_cndmask_b32 v145, 0, v145, vcc
    v_cndmask_b32 v146, 0, v146, vcc
    v_cndmask_b32 v147, 0, v147, vcc
    v_cndmask_b32 v148, 0, v148, vcc
    v_cndmask_b32 v149, 0, v149, vcc
    v_cndmask_b32 v150, 0, v150, vcc
    v_lshlrev_b32 v3, 4, v0
    v_add_u32 v3, 79872, v3
    ds_write_b128 v3, v[144:147]
    ds_write_b128 v3, v[148:151] offset:1024
    s_waitcnt lgkmcnt(0)
    v_lshlrev_b32 v2, 4, v0
    v_add_u32 v2, 34816, v2
    v_lshlrev_b32 v12, 1, v8
    v_add_u32 v12, s78, v12
    v_mul_i32_i24 v10, 128, v9
    v_add_u32 v10, v10, v12
    v_mul_i32_i24 v11, -384, v9
    v_add_u32 v11, v11, v12
    v_mov_b32 v32, 0
    v_mov_b32 v33, 0
    v_mov_b32 v34, 0
    v_mov_b32 v35, 0
    v_mov_b32 v36, 0
    v_mov_b32 v37, 0
    v_mov_b32 v38, 0
    v_mov_b32 v39, 0
    v_mov_b32 v40, 0
    v_mov_b32 v41, 0
    v_mov_b32 v42, 0
    v_mov_b32 v43, 0
    v_mov_b32 v44, 0
    v_mov_b32 v45, 0
    v_mov_b32 v46, 0
    v_mov_b32 v47, 0
    v_mov_b32 v48, 0
    v_mov_b32 v49, 0
    v_mov_b32 v50, 0
    v_mov_b32 v51, 0
    v_mov_b32 v52, 0
    v_mov_b32 v53, 0
    v_mov_b32 v54, 0
    v_mov_b32 v55, 0
    v_mov_b32 v56, 0
    v_mov_b32 v57, 0
    s_waitcnt vmcnt(7)
    ds_read_u16_d16_hi v32, v10 offset:0
    ds_read_u16_d16_hi v33, v10 offset:64
    ds_read_u16_d16_hi v34, v10 offset:128
    ds_read_u16_d16_hi v35, v10 offset:192
    ds_read_u16_d16_hi v36, v10 offset:256
    ds_read_u16_d16_hi v37, v10 offset:320
    ds_read_u16_d16_hi v38, v11 offset:384
    ds_read_u16_d16_hi v39, v11 offset:448
    ds_read_u16_d16_hi v40, v10 offset:512
    ds_read_u16_d16_hi v41, v10 offset:576
    ds_read_u16_d16_hi v42, v10 offset:640
    ds_read_u16_d16_hi v43, v10 offset:704
    ds_read_u16_d16_hi v44, v10 offset:768
    s_lshl_b32 s70, s66, 8
    v_lshlrev_b32 v14, 2, v0
    v_add_u32 v14, s70, v14
    s_mov_b32 s72, 0
    s_mov_b32 s73, -1
    v_mov_b32 v13, 0x03020100
    v_mov_b32 v3, 0x01000302
    v_cndmask_b32 v13, v13, v3, s[72:73]
    s_mov_b32 s70, 0x43000000
    s_mov_b32 s71, 0x3d800000
    v_mov_b32 v111, 0x3f80
    s_waitcnt lgkmcnt(0)
    ds_read_u16_d16_hi v45, v10 offset:832
    ds_read_u16_d16_hi v46, v11 offset:896
    ds_read_u16_d16_hi v47, v11 offset:960
    ds_read_u16_d16_hi v48, v10 offset:1024
    ds_read_u16_d16_hi v49, v10 offset:1088
    ds_read_u16_d16_hi v50, v10 offset:1152
    ds_read_u16_d16_hi v51, v10 offset:1216
    ds_read_u16_d16_hi v52, v10 offset:1280
    ds_read_u16_d16_hi v53, v10 offset:1344
    ds_read_u16_d16_hi v54, v11 offset:1408
    ds_read_u16_d16_hi v55, v11 offset:1472
    ds_read_u16_d16_hi v56, v12 offset:1536
    ds_read_u16_d16_hi v57, v12 offset:1600
    s_lshl_b32 s17, s2, 2
    v_mov_b32 v124, s17
    v_mov_b32 v125, 1
    s_waitcnt vmcnt(3)
    s_waitcnt lgkmcnt(0)
    s_barrier
    s_mov_b64 exec, 1
    buffer_store_dword v125, v124, s[52:55], 0 offen offset:64 sc1
    s_mov_b64 exec, -1
L_p3done:
    ds_read_b128 a[176:179], v2 offset:45056
    v_max3_f32 v116, |v32|, |v33|, |v34|
    ds_read_b128 a[180:183], v2 offset:46080
    v_max3_f32 v117, |v35|, |v36|, |v37|
    ds_read_b128 a[0:3], v2 offset:0
    v_max3_f32 v116, |v38|, |v39|, v116
    ds_read_b128 a[88:91], v2 offset:22528
    v_max3_f32 v117, |v40|, |v41|, v117
    ds_read_b128 a[4:7], v2 offset:1024
    v_max3_f32 v116, |v42|, |v43|, v116
    ds_read_b128 a[92:95], v2 offset:23552
    v_max3_f32 v117, |v44|, |v45|, v117
    ds_read_b128 a[8:11], v2 offset:2048
    v_max3_f32 v116, |v46|, |v47|, v116
    ds_read_b128 a[96:99], v2 offset:24576
    v_max3_f32 v117, |v48|, |v49|, v117
    ds_read_b128 a[12:15], v2 offset:3072
    v_max3_f32 v116, |v50|, |v51|, v116
    ds_read_b128 a[100:103], v2 offset:25600
    v_max3_f32 v117, |v52|, |v53|, v117
    ds_read_b128 a[16:19], v2 offset:4096
    v_max3_f32 v116, |v54|, |v55|, v116
    ds_read_b128 a[104:107], v2 offset:26624
    v_max3_f32 v117, |v56|, |v57|, v117
    ds_read_b128 a[20:23], v2 offset:5120
    v_max_f32 v116, v116, v117
    ds_read_b128 a[108:111], v2 offset:27648
    v_cmp_nlt_f32 s[26:27], v116, s70
    ds_read_b128 a[24:27], v2 offset:6144
    v_cmp_le_f32 vcc, s71, v116
    s_waitcnt lgkmcnt(12)
    ds_read_b128 a[112:115], v2 offset:28672
    v_cvt_pk_bf16_f32 v104, v32, v33
    ds_read_b128 a[28:31], v2 offset:7168
    v_cvt_pk_bf16_f32 v105, v36, v37
    ds_read_b128 a[116:119], v2 offset:29696
    v_cvt_pk_bf16_f32 v106, v40, v41
    s_waitcnt lgkmcnt(12)
    ds_read_b128 a[32:35], v2 offset:8192
    v_cvt_pk_bf16_f32 v107, v44, v45
    ds_read_b128 a[120:123], v2 offset:30720
    v_cvt_pk_bf16_f32 v108, v48, v49
    ds_read_b128 a[36:39], v2 offset:9216
    v_cvt_pk_bf16_f32 v109, v52, v53
    buffer_load_dword v7, v250, s[40:43], s64 offen
    s_add_u32 s64, s64, 1277952
    s_waitcnt lgkmcnt(12)
    ds_read_b128 a[124:127], v2 offset:31744
    v_cndmask_b32 v117, v56, v57, s[72:73]
    ds_read_b128 a[40:43], v2 offset:10240
    v_lshrrev_b32 v110, 16, v117
    ds_read_b128 a[128:131], v2 offset:32768
    v_mov_b32 v112, v30
    s_waitcnt lgkmcnt(12)
    ds_read_b128 a[44:47], v2 offset:11264
    v_mov_b32 v113, v31
    ds_read_b128 a[132:135], v2 offset:33792
    s_cmp_lg_u64 s[26:27], 0
    s_cbranch_scc1 L_slowp
    s_cbranch_vccz L_slowp
L_backp:
    ds_read_b128 a[48:51], v2 offset:12288
    v_cvt_pk_f16_f32 v64, v32, v33
    s_waitcnt lgkmcnt(12)
    ds_read_b128 a[136:139], v2 offset:34816
    v_cvt_pk_f16_f32 v65, v34, v35
    ds_read_b128 a[52:55], v2 offset:13312
    v_cvt_pk_f16_f32 v66, v36, v37
    ds_read_b128 a[140:143], v2 offset:35840
    v_cvt_pk_f16_f32 v67, v38, v39
    s_waitcnt lgkmcnt(12)
    ds_read_b128 a[56:59], v2 offset:14336
    v_cvt_pk_f16_f32 v68, v40, v41
    ds_read_b128 a[144:147], v2 offset:36864
    v_cvt_pk_f16_f32 v69, v42, v43
    ds_read_b128 a[60:63], v2 offset:15360
    v_cvt_pk_f16_f32 v70, v44, v45
    s_waitcnt lgkmcnt(12)
    ds_read_b128 a[148:151], v2 offset:37888
    v_cvt_pk_f16_f32 v71, v46, v47
    ds_read_b128 a[64:67], v2 offset:16384
    v_cvt_pk_f16_f32 v72, v48, v49
    ds_read_b128 a[152:155], v2 offset:38912
    v_cvt_pk_f16_f32 v73, v50, v51
    s_waitcnt lgkmcnt(12)
    ds_read_b128 a[68:71], v2 offset:17408
    v_cvt_pk_f16_f32 v74, v52, v53
    ds_read_b128 a[156:159], v2 offset:39936
    v_cvt_pk_f16_f32 v75, v54, v55
    ds_read_b128 a[72:75], v2 offset:18432
    v_cvt_pk_f16_f32 v76, v56, v57
    s_waitcnt lgkmcnt(12)
    ds_read_b128 a[160:163], v2 offset:40960
    v_perm_b32 v77, v76, v76, v13
    ds_read_b128 a[76:79], v2 offset:19456
    ds_read_b128 a[164:167], v2 offset:41984
    s_waitcnt lgkmcnt(12)
    ds_read_b128 a[80:83], v2 offset:20480
    ds_read_b128 a[168:171], v2 offset:43008
    ds_read_b128 a[84:87], v2 offset:21504
    s_waitcnt lgkmcnt(12)
    ds_read_b128 a[172:175], v2 offset:44032
    v_pk_mul_f16 v96, v64, v65 op_sel:[0,0] op_sel_hi:[1,0]
    v_pk_mul_f16 v97, v64, v65 op_sel:[0,1] op_sel_hi:[1,1]
    s_waitcnt lgkmcnt(0)
    s_mov_b32 s28, s6
    s_mov_b32 s29, s7
    s_mov_b32 s30, 25600000
    s_mov_b32 s31, 0x00020000
    s_mov_b32 s63, 85
    s_mov_b32 s62, 16
    v_subrev_u32 v240, 16, v240
    s_mov_b32 s79, 0
    s_mov_b32 s56, 99
    s_mov_b32 s57, 0
    v_lshlrev_b32 v245, 2, v0
    v_add_u32 v245, 64, v245
L_cloop:
    v_mfma_f32_32x32x16_bf16 v[160:175], a[176:179], v[104:107], 0
    v_pk_mul_f16 v98, v66, v67 op_sel:[0,0] op_sel_hi:[1,0]
    v_pk_mul_f16 v99, v66, v67 op_sel:[0,1] op_sel_hi:[1,1]
    ds_read_b32 v26, v4 offset:0
    ds_read_b32 v27, v4 offset:64
    v_mfma_f32_32x32x16_bf16 v[160:175], a[180:183], v[108:111], v[160:175]
    v_pk_mul_f16 v100, v64, v66 op_sel:[0,0] op_sel_hi:[1,0]
    v_pk_mul_f16 v101, v64, v66 op_sel:[0,1] op_sel_hi:[1,1]
    v_add_u32 v4, 104, v4
    s_add_u32 m0, s78, 0
    v_lshl_add_u32 v24, v24, 8, v6
    v_mfma_f32_32x32x16_f16 v[128:143], a[0:3], v[96:99], 0
    v_pk_mul_f16 v102, v64, v68 op_sel:[0,0] op_sel_hi:[1,0]
    v_pk_mul_f16 v103, v64, v68 op_sel:[0,1] op_sel_hi:[1,1]
    buffer_load_dwordx4 v24, s[32:35], 0 offen lds
    s_add_u32 m0, s78, 1024
    v_lshl_add_u32 v25, v25, 8, v251
    v_mfma_f32_32x32x16_f16 v[144:159], a[88:91], v[96:99], 0
    v_pk_mul_f16 v96, v66, v70 op_sel:[0,0] op_sel_hi:[1,0]
    v_pk_mul_f16 v97, v66, v70 op_sel:[0,1] op_sel_hi:[1,1]
    buffer_load_dwordx4 v25, s[32:35], 0 offen lds
    v_fmac_f32 v208, v192, v115
    v_mfma_f32_32x32x16_f16 v[128:143], a[4:7], v[100:103], v[128:143]
    v_pk_mul_f16 v98, v64, v69 op_sel:[0,0] op_sel_hi:[1,0]
    v_pk_mul_f16 v99, v64, v69 op_sel:[0,1] op_sel_hi:[1,1]
    v_pk_mul_f16 v120, v77, v77 op_sel:[0,0] op_sel_hi:[0,1]
    v_fmac_f32 v209, v193, v115
    v_fma_mixlo_f16 v121, v64, v64, 0 op_sel:[0,1,0] op_sel_hi:[1,1,0]
    v_mfma_f32_32x32x16_f16 v[144:159], a[92:95], v[100:103], v[144:159]
    v_pk_mul_f16 v100, v66, v71 op_sel:[0,0] op_sel_hi:[1,0]
    v_pk_mul_f16 v101, v66, v71 op_sel:[0,1] op_sel_hi:[1,1]
    v_mul_f32 v15, v176, v208
    v_fma_mixlo_f16 v122, v68, v68, 0 op_sel:[0,1,0] op_sel_hi:[1,1,0]
    v_mfma_f32_32x32x16_f16 v[128:143], a[8:11], v[96:99], v[128:143]
    v_pk_mul_f16 v102, v64, v70 op_sel:[0,0] op_sel_hi:[1,0]
    v_pk_mul_f16 v103, v64, v70 op_sel:[0,1] op_sel_hi:[1,1]
    v_fmac_f32 v210, v194, v115
    v_fma_mixlo_f16 v123, v72, v72, 0 op_sel:[0,1,0] op_sel_hi:[1,1,0]
    v_mfma_f32_32x32x16_f16 v[144:159], a[96:99], v[96:99], v[144:159]
    v_pk_mul_f16 v96, v66, v68 op_sel:[0,0] op_sel_hi:[1,0]
    v_pk_mul_f16 v97, v66, v68 op_sel:[0,1] op_sel_hi:[1,1]
    v_fmac_f32 v15, v177, v209
    v_fma_mixhi_f16 v121, v66, v66, 0 op_sel:[0,1,0] op_sel_hi:[1,1,0]
    v_mfma_f32_32x32x16_f16 v[128:143], a[12:15], v[100:103], v[128:143]
    v_pk_mul_f16 v98, v64, v71 op_sel:[0,0] op_sel_hi:[1,0]
    v_pk_mul_f16 v99, v64, v71 op_sel:[0,1] op_sel_hi:[1,1]
    v_fmac_f32 v211, v195, v115
    v_fma_mixhi_f16 v122, v70, v70, 0 op_sel:[0,1,0] op_sel_hi:[1,1,0]
    v_mfma_f32_32x32x16_f16 v[144:159], a[100:103], v[100:103], v[144:159]
    v_pk_mul_f16 v100, v66, v69 op_sel:[0,0] op_sel_hi:[1,0]
    v_pk_mul_f16 v101, v66, v69 op_sel:[0,1] op_sel_hi:[1,1]
    v_fmac_f32 v15, v178, v210
    v_fma_mixhi_f16 v123, v74, v74, 0 op_sel:[0,1,0] op_sel_hi:[1,1,0]
    v_mfma_f32_32x32x16_f16 v[128:143], a[16:19], v[96:99], v[128:143]
    v_pk_mul_f16 v102, v64, v72 op_sel:[0,0] op_sel_hi:[1,0]
    v_pk_mul_f16 v103, v64, v72 op_sel:[0,1] op_sel_hi:[1,1]
    v_fmac_f32 v212, v196, v115
    v_fmac_f32 v15, v179, v211
    v_mfma_f32_32x32x16_f16 v[144:159], a[104:107], v[96:99], v[144:159]
    v_pk_mul_f16 v96, v66, v74 op_sel:[0,0] op_sel_hi:[1,0]
    v_pk_mul_f16 v97, v66, v74 op_sel:[0,1] op_sel_hi:[1,1]
    v_fmac_f32 v213, v197, v115
    v_fmac_f32 v15, v180, v212
    v_fmac_f32 v214, v198, v115
    v_mfma_f32_32x32x16_f16 v[128:143], a[20:23], v[100:103], v[128:143]
    v_pk_mul_f16 v98, v64, v73 op_sel:[0,0] op_sel_hi:[1,0]
    v_pk_mul_f16 v99, v64, v73 op_sel:[0,1] op_sel_hi:[1,1]
    s_waitcnt vmcnt(4)
    buffer_load_dword v7, v250, s[40:43], s64 offen
    s_add_u32 s64, s64, 1277952
    v_mfma_f32_32x32x16_f16 v[144:159], a[108:111], v[100:103], v[144:159]
    v_pk_mul_f16 v100, v66, v75 op_sel:[0,0] op_sel_hi:[1,0]
    v_pk_mul_f16 v101, v66, v75 op_sel:[0,1] op_sel_hi:[1,1]
    ds_read_u16_d16_hi v32, v10 offset:2048
    ds_read_u16_d16_hi v33, v10 offset:2112
    v_mfma_f32_32x32x16_f16 v[128:143], a[24:27], v[96:99], v[128:143]
    v_pk_mul_f16 v102, v64, v74 op_sel:[0,0] op_sel_hi:[1,0]
    v_pk_mul_f16 v103, v64, v74 op_sel:[0,1] op_sel_hi:[1,1]
    ds_read_u16_d16_hi v34, v10 offset:2176
    ds_read_u16_d16_hi v35, v10 offset:2240
    ds_read_u16_d16_hi v36, v10 offset:2304
    v_mfma_f32_32x32x16_f16 v[144:159], a[112:115], v[96:99], v[144:159]
    v_pk_mul_f16 v96, v66, v72 op_sel:[0,0] op_sel_hi:[1,0]
    v_pk_mul_f16 v97, v66, v72 op_sel:[0,1] op_sel_hi:[1,1]
    ds_read_u16_d16_hi v37, v10 offset:2368
    ds_read_u16_d16_hi v38, v11 offset:2432
    v_mfma_f32_32x32x16_f16 v[128:143], a[28:31], v[100:103], v[128:143]
    v_pk_mul_f16 v98, v64, v75 op_sel:[0,0] op_sel_hi:[1,0]
    v_pk_mul_f16 v99, v64, v75 op_sel:[0,1] op_sel_hi:[1,1]
    ds_read_u16_d16_hi v39, v11 offset:2496
    ds_read_u16_d16_hi v40, v10 offset:2560
    v_mfma_f32_32x32x16_f16 v[144:159], a[116:119], v[100:103], v[144:159]
    v_pk_mul_f16 v100, v66, v73 op_sel:[0,0] op_sel_hi:[1,0]
    v_pk_mul_f16 v101, v66, v73 op_sel:[0,1] op_sel_hi:[1,1]
    ds_read_u16_d16_hi v41, v10 offset:2624
    ds_read_u16_d16_hi v42, v10 offset:2688
    ds_read_u16_d16_hi v43, v10 offset:2752
    v_mfma_f32_32x32x16_f16 v[128:143], a[32:35], v[96:99], v[128:143]
    v_pk_mul_f16 v102, v64, v76 op_sel:[0,0] op_sel_hi:[1,0]
    v_pk_mul_f16 v103, v64, v76 op_sel:[0,1] op_sel_hi:[1,1]
    s_waitcnt lgkmcnt(4)
    ds_read_u16_d16_hi v44, v10 offset:2816
    v_mfma_f32_32x32x16_f16 v[144:159], a[120:123], v[96:99], v[144:159]
    v_pk_mul_f16 v96, v66, v76 op_sel:[0,0] op_sel_hi:[1,0]
    v_pk_mul_f16 v97, v66, v76 op_sel:[0,1] op_sel_hi:[1,1]
    ds_read_u16_d16_hi v45, v10 offset:2880
    ds_read_u16_d16_hi v46, v11 offset:2944
    ds_read_u16_d16_hi v47, v11 offset:3008
    v_mfma_f32_32x32x16_f16 v[128:143], a[36:39], v[100:103], v[128:143]
    v_pk_mul_f16 v98, v68, v69 op_sel:[0,0] op_sel_hi:[1,0]
    v_pk_mul_f16 v99, v68, v69 op_sel:[0,1] op_sel_hi:[1,1]
    ds_read_u16_d16_hi v48, v10 offset:3072
    ds_read_u16_d16_hi v49, v10 offset:3136
    v_mfma_f32_32x32x16_f16 v[144:159], a[124:127], v[100:103], v[144:159]
    v_pk_mul_f16 v100, v70, v71 op_sel:[0,0] op_sel_hi:[1,0]
    v_pk_mul_f16 v101, v70, v71 op_sel:[0,1] op_sel_hi:[1,1]
    ds_read_u16_d16_hi v50, v10 offset:3200
    ds_read_u16_d16_hi v51, v10 offset:3264
    ds_read_u16_d16_hi v52, v10 offset:3328
    v_mfma_f32_32x32x16_f16 v[128:143], a[40:43], v[96:99], v[128:143]
    v_pk_mul_f16 v102, v68, v70 op_sel:[0,0] op_sel_hi:[1,0]
    v_pk_mul_f16 v103, v68, v70 op_sel:[0,1] op_sel_hi:[1,1]
    s_waitcnt lgkmcnt(4)
    ds_read_u16_d16_hi v53, v10 offset:3392
    v_mfma_f32_32x32x16_f16 v[144:159], a[128:131], v[96:99], v[144:159]
    v_pk_mul_f16 v96, v68, v72 op_sel:[0,0] op_sel_hi:[1,0]
    v_pk_mul_f16 v97, v68, v72 op_sel:[0,1] op_sel_hi:[1,1]
    ds_read_u16_d16_hi v54, v11 offset:3456
    ds_read_u16_d16_hi v55, v11 offset:3520
    ds_read_u16_d16_hi v56, v12 offset:3584
    v_mfma_f32_32x32x16_f16 v[128:143], a[44:47], v[100:103], v[128:143]
    v_pk_mul_f16 v98, v70, v74 op_sel:[0,0] op_sel_hi:[1,0]
    v_pk_mul_f16 v99, v70, v74 op_sel:[0,1] op_sel_hi:[1,1]
    ds_read_u16_d16_hi v57, v12 offset:3648
    v_fmac_f32 v15, v181, v213
    v_mfma_f32_32x32x16_f16 v[144:159], a[132:135], v[100:103], v[144:159]
    v_pk_mul_f16 v100, v68, v73 op_sel:[0,0] op_sel_hi:[1,0]
    v_pk_mul_f16 v101, v68, v73 op_sel:[0,1] op_sel_hi:[1,1]
    v_fmac_f32 v215, v199, v115
    v_fmac_f32 v15, v182, v214
    v_fmac_f32 v216, v200, v115
    v_mfma_f32_32x32x16_f16 v[128:143], a[48:51], v[96:99], v[128:143]
    v_pk_mul_f16 v102, v70, v75 op_sel:[0,0] op_sel_hi:[1,0]
    v_pk_mul_f16 v103, v70, v75 op_sel:[0,1] op_sel_hi:[1,1]
    v_fmac_f32 v15, v183, v215
    v_fmac_f32 v217, v201, v115
    v_fmac_f32 v15, v184, v216
    v_mfma_f32_32x32x16_f16 v[144:159], a[136:139], v[96:99], v[144:159]
    v_pk_mul_f16 v96, v68, v74 op_sel:[0,0] op_sel_hi:[1,0]
    v_pk_mul_f16 v97, v68, v74 op_sel:[0,1] op_sel_hi:[1,1]
    v_fmac_f32 v218, v202, v115
    v_fmac_f32 v15, v185, v217
    v_fmac_f32 v219, v203, v115
    v_mfma_f32_32x32x16_f16 v[128:143], a[52:55], v[100:103], v[128:143]
    v_pk_mul_f16 v98, v70, v72 op_sel:[0,0] op_sel_hi:[1,0]
    v_pk_mul_f16 v99, v70, v72 op_sel:[0,1] op_sel_hi:[1,1]
    v_fmac_f32 v15, v186, v218
    v_fmac_f32 v220, v204, v115
    v_fmac_f32 v15, v187, v219
    v_mfma_f32_32x32x16_f16 v[144:159], a[140:143], v[100:103], v[144:159]
    v_pk_mul_f16 v100, v68, v75 op_sel:[0,0] op_sel_hi:[1,0]
    v_pk_mul_f16 v101, v68, v75 op_sel:[0,1] op_sel_hi:[1,1]
    v_fmac_f32 v15, v188, v220
    v_mul_f32 v15, v15, v114
    s_waitcnt lgkmcnt(0)
    v_mfma_f32_32x32x16_f16 v[128:143], a[56:59], v[96:99], v[128:143]
    v_pk_mul_f16 v102, v70, v73 op_sel:[0,0] op_sel_hi:[1,0]
    v_pk_mul_f16 v103, v70, v73 op_sel:[0,1] op_sel_hi:[1,1]
    ds_write_b32 v14, v15
    v_add_u32 v14, 1040, v14
    v_max3_f32 v116, |v32|, |v33|, |v34|
    v_mfma_f32_32x32x16_f16 v[144:159], a[144:147], v[96:99], v[144:159]
    v_pk_mul_f16 v96, v68, v76 op_sel:[0,0] op_sel_hi:[1,0]
    v_pk_mul_f16 v97, v68, v76 op_sel:[0,1] op_sel_hi:[1,1]
    v_max3_f32 v117, |v35|, |v36|, |v37|
    v_max3_f32 v116, |v38|, |v39|, v116
    v_mfma_f32_32x32x16_f16 v[128:143], a[60:63], v[100:103], v[128:143]
    v_pk_mul_f16 v98, v70, v76 op_sel:[0,0] op_sel_hi:[1,0]
    v_pk_mul_f16 v99, v70, v76 op_sel:[0,1] op_sel_hi:[1,1]
    v_max3_f32 v117, |v40|, |v41|, v117
    v_max3_f32 v116, |v42|, |v43|, v116
    v_mfma_f32_32x32x16_f16 v[144:159], a[148:151], v[100:103], v[144:159]
    v_pk_mul_f16 v100, v72, v73 op_sel:[0,0] op_sel_hi:[1,0]
    v_pk_mul_f16 v101, v72, v73 op_sel:[0,1] op_sel_hi:[1,1]
    v_max3_f32 v117, |v44|, |v45|, v117
    v_max3_f32 v116, |v46|, |v47|, v116
    v_max3_f32 v117, |v48|, |v49|, v117
    v_mfma_f32_32x32x16_f16 v[128:143], a[64:67], v[96:99], v[128:143]
    v_pk_mul_f16 v102, v74, v75 op_sel:[0,0] op_sel_hi:[1,0]
    v_pk_mul_f16 v103, v74, v75 op_sel:[0,1] op_sel_hi:[1,1]
    v_max3_f32 v116, |v50|, |v51|, v116
    v_max3_f32 v117, |v52|, |v53|, v117
    v_mfma_f32_32x32x16_f16 v[144:159], a[152:155], v[96:99], v[144:159]
    v_pk_mul_f16 v96, v72, v74 op_sel:[0,0] op_sel_hi:[1,0]
    v_pk_mul_f16 v97, v72, v74 op_sel:[0,1] op_sel_hi:[1,1]
    v_max3_f32 v116, |v54|, |v55|, v116
    v_max3_f32 v117, |v56|, |v57|, v117
    v_max_f32 v116, v116, v117
    v_mfma_f32_32x32x16_f16 v[128:143], a[68:71], v[100:103], v[128:143]
    v_pk_mul_f16 v98, v72, v76 op_sel:[0,0] op_sel_hi:[1,0]
    v_pk_mul_f16 v99, v72, v76 op_sel:[0,1] op_sel_hi:[1,1]
    v_cmp_nlt_f32 s[26:27], v116, s70
    v_cmp_le_f32 vcc, s71, v116
    v_mfma_f32_32x32x16_f16 v[144:159], a[156:159], v[100:103], v[144:159]
    v_pk_mul_f16 v100, v74, v76 op_sel:[0,0] op_sel_hi:[1,0]
    v_pk_mul_f16 v101, v74, v76 op_sel:[0,1] op_sel_hi:[1,1]
    v_cvt_pk_bf16_f32 v104, v32, v33
    v_cvt_pk_bf16_f32 v105, v36, v37
    v_cvt_pk_bf16_f32 v106, v40, v41
    v_mfma_f32_32x32x16_f16 v[128:143], a[72:75], v[96:99], v[128:143]
    v_pk_mul_f16 v102, v64, v64 op_sel:[0,0] op_sel_hi:[1,1]
    v_pk_mul_f16 v103, v66, v66 op_sel:[0,0] op_sel_hi:[1,1]
    v_cvt_pk_bf16_f32 v107, v44, v45
    v_cvt_pk_bf16_f32 v108, v48, v49
    v_mfma_f32_32x32x16_f16 v[144:159], a[160:163], v[96:99], v[144:159]
    v_pk_mul_f16 v96, v68, v68 op_sel:[0,0] op_sel_hi:[1,1]
    v_pk_mul_f16 v97, v70, v70 op_sel:[0,0] op_sel_hi:[1,1]
    v_cvt_pk_bf16_f32 v109, v52, v53
    v_cndmask_b32 v117, v56, v57, s[72:73]
    v_lshrrev_b32 v110, 16, v117
    v_mfma_f32_32x32x16_f16 v[128:143], a[76:79], v[100:103], v[128:143]
    v_pk_mul_f16 v98, v72, v72 op_sel:[0,0] op_sel_hi:[1,1]
    v_pk_mul_f16 v99, v74, v74 op_sel:[0,0] op_sel_hi:[1,1]
    v_mov_b32 v114, v30
    v_mov_b32 v115, v31
    v_mfma_f32_32x32x16_f16 v[144:159], a[164:167], v[100:103], v[144:159]
    s_cmp_lg_u64 s[26:27], 0
    s_cbranch_scc1 L_slow0
    s_cbranch_vccz L_slow0
L_back0:
    v_cvt_pk_f16_f32 v80, v32, v33
    v_cvt_pk_f16_f32 v81, v34, v35
    v_mfma_f32_32x32x16_f16 v[128:143], a[80:83], v[96:99], v[128:143]
    v_cvt_pk_f16_f32 v82, v36, v37
    v_cvt_pk_f16_f32 v83, v38, v39
    v_cvt_pk_f16_f32 v84, v40, v41
    v_cvt_pk_f16_f32 v85, v42, v43
    v_mfma_f32_32x32x16_f16 v[144:159], a[168:171], v[96:99], v[144:159]
    v_cvt_pk_f16_f32 v86, v44, v45
    v_cvt_pk_f16_f32 v87, v46, v47
    v_cvt_pk_f16_f32 v88, v48, v49
    v_cvt_pk_f16_f32 v89, v50, v51
    v_mfma_f32_32x32x16_f16 v[128:143], a[84:87], v[120:123], v[128:143]
    v_cvt_pk_f16_f32 v90, v52, v53
    v_cvt_pk_f16_f32 v91, v54, v55
    v_cvt_pk_f16_f32 v92, v56, v57
    v_perm_b32 v93, v92, v92, v13
    v_mfma_f32_32x32x16_f16 v[144:159], a[172:175], v[120:123], v[144:159]
    v_pk_mul_f16 v96, v80, v81 op_sel:[0,0] op_sel_hi:[1,0]
    v_pk_mul_f16 v97, v80, v81 op_sel:[0,1] op_sel_hi:[1,1]
    s_cmp_eq_u32 s79, s56
    s_cbranch_scc1 L_exit0
    v_mfma_f32_32x32x16_bf16 v[208:223], a[176:179], v[104:107], 0
    v_pk_mul_f16 v98, v82, v83 op_sel:[0,0] op_sel_hi:[1,0]
    v_pk_mul_f16 v99, v82, v83 op_sel:[0,1] op_sel_hi:[1,1]
    ds_read_b32 v24, v4 offset:0
    ds_read_b32 v25, v4 offset:64
    v_mfma_f32_32x32x16_bf16 v[208:223], a[180:183], v[108:111], v[208:223]
    v_pk_mul_f16 v100, v80, v82 op_sel:[0,0] op_sel_hi:[1,0]
    v_pk_mul_f16 v101, v80, v82 op_sel:[0,1] op_sel_hi:[1,1]
    v_add_u32 v4, 104, v4
    ds_read_b32 v241, v240
    s_add_u32 m0, s78, 2048
    v_mfma_f32_32x32x16_f16 v[176:191], a[0:3], v[96:99], 0
    v_pk_mul_f16 v102, v80, v84 op_sel:[0,0] op_sel_hi:[1,0]
    v_pk_mul_f16 v103, v80, v84 op_sel:[0,1] op_sel_hi:[1,1]
    v_lshl_add_u32 v26, v26, 8, v6
    buffer_load_dwordx4 v26, s[32:35], 0 offen lds
    s_add_u32 m0, s78, 3072
    v_mfma_f32_32x32x16_f16 v[192:207], a[88:91], v[96:99], 0
    v_pk_mul_f16 v96, v82, v86 op_sel:[0,0] op_sel_hi:[1,0]
    v_pk_mul_f16 v97, v82, v86 op_sel:[0,1] op_sel_hi:[1,1]
    v_lshl_add_u32 v27, v27, 8, v251
    buffer_load_dwordx4 v27, s[32:35], 0 offen lds
    v_mfma_f32_32x32x16_f16 v[176:191], a[4:7], v[100:103], v[176:191]
    v_pk_mul_f16 v98, v80, v85 op_sel:[0,0] op_sel_hi:[1,0]
    v_pk_mul_f16 v99, v80, v85 op_sel:[0,1] op_sel_hi:[1,1]
    v_fmac_f32 v160, v144, v113
    v_pk_mul_f16 v120, v93, v93 op_sel:[0,0] op_sel_hi:[0,1]
    v_fmac_f32 v161, v145, v113
    v_mfma_f32_32x32x16_f16 v[192:207], a[92:95], v[100:103], v[192:207]
    v_pk_mul_f16 v100, v82, v87 op_sel:[0,0] op_sel_hi:[1,0]
    v_pk_mul_f16 v101, v82, v87 op_sel:[0,1] op_sel_hi:[1,1]
    v_fma_mixlo_f16 v121, v80, v80, 0 op_sel:[0,1,0] op_sel_hi:[1,1,0]
    v_mul_f32 v15, v128, v160
    v_mfma_f32_32x32x16_f16 v[176:191], a[8:11], v[96:99], v[176:191]
    v_pk_mul_f16 v102, v80, v86 op_sel:[0,0] op_sel_hi:[1,0]
    v_pk_mul_f16 v103, v80, v86 op_sel:[0,1] op_sel_hi:[1,1]
    v_fma_mixlo_f16 v122, v84, v84, 0 op_sel:[0,1,0] op_sel_hi:[1,1,0]
    v_fmac_f32 v162, v146, v113
    v_mfma_f32_32x32x16_f16 v[192:207], a[96:99], v[96:99], v[192:207]
    v_pk_mul_f16 v96, v82, v84 op_sel:[0,0] op_sel_hi:[1,0]
    v_pk_mul_f16 v97, v82, v84 op_sel:[0,1] op_sel_hi:[1,1]
    v_fma_mixlo_f16 v123, v88, v88, 0 op_sel:[0,1,0] op_sel_hi:[1,1,0]
    v_fmac_f32 v15, v129, v161
    v_mfma_f32_32x32x16_f16 v[176:191], a[12:15], v[100:103], v[176:191]
    v_pk_mul_f16 v98, v80, v87 op_sel:[0,0] op_sel_hi:[1,0]
    v_pk_mul_f16 v99, v80, v87 op_sel:[0,1] op_sel_hi:[1,1]
    v_fma_mixhi_f16 v121, v82, v82, 0 op_sel:[0,1,0] op_sel_hi:[1,1,0]
    v_fmac_f32 v163, v147, v113
    v_mfma_f32_32x32x16_f16 v[192:207], a[100:103], v[100:103], v[192:207]
    v_pk_mul_f16 v100, v82, v85 op_sel:[0,0] op_sel_hi:[1,0]
    v_pk_mul_f16 v101, v82, v85 op_sel:[0,1] op_sel_hi:[1,1]
    v_fma_mixhi_f16 v122, v86, v86, 0 op_sel:[0,1,0] op_sel_hi:[1,1,0]
    v_fmac_f32 v15, v130, v162
    v_mfma_f32_32x32x16_f16 v[176:191], a[16:19], v[96:99], v[176:191]
    v_pk_mul_f16 v102, v80, v88 op_sel:[0,0] op_sel_hi:[1,0]
    v_pk_mul_f16 v103, v80, v88 op_sel:[0,1] op_sel_hi:[1,1]
    v_fma_mixhi_f16 v123, v90, v90, 0 op_sel:[0,1,0] op_sel_hi:[1,1,0]
    v_fmac_f32 v164, v148, v113
    v_fmac_f32 v15, v131, v163
    v_mfma_f32_32x32x16_f16 v[192:207], a[104:107], v[96:99], v[192:207]
    v_pk_mul_f16 v96, v82, v90 op_sel:[0,0] op_sel_hi:[1,0]
    v_pk_mul_f16 v97, v82, v90 op_sel:[0,1] op_sel_hi:[1,1]
    v_fmac_f32 v165, v149, v113
    v_fmac_f32 v15, v132, v164
    v_fmac_f32 v166, v150, v113
    v_mfma_f32_32x32x16_f16 v[176:191], a[20:23], v[100:103], v[176:191]
    v_pk_mul_f16 v98, v80, v89 op_sel:[0,0] op_sel_hi:[1,0]
    v_pk_mul_f16 v99, v80, v89 op_sel:[0,1] op_sel_hi:[1,1]
    s_waitcnt vmcnt(3)
    buffer_load_dword v7, v250, s[40:43], s64 offen
    s_add_u32 s64, s64, 1277952
    v_mfma_f32_32x32x16_f16 v[192:207], a[108:111], v[100:103], v[192:207]
    v_pk_mul_f16 v100, v82, v91 op_sel:[0,0] op_sel_hi:[1,0]
    v_pk_mul_f16 v101, v82, v91 op_sel:[0,1] op_sel_hi:[1,1]
    ds_read_u16_d16_hi v32, v10 offset:0
    ds_read_u16_d16_hi v33, v10 offset:64
    v_mfma_f32_32x32x16_f16 v[176:191], a[24:27], v[96:99], v[176:191]
    v_pk_mul_f16 v102, v80, v90 op_sel:[0,0] op_sel_hi:[1,0]
    v_pk_mul_f16 v103, v80, v90 op_sel:[0,1] op_sel_hi:[1,1]
    ds_read_u16_d16_hi v34, v10 offset:128
    ds_read_u16_d16_hi v35, v10 offset:192
    ds_read_u16_d16_hi v36, v10 offset:256
    v_mfma_f32_32x32x16_f16 v[192:207], a[112:115], v[96:99], v[192:207]
    v_pk_mul_f16 v96, v82, v88 op_sel:[0,0] op_sel_hi:[1,0]
    v_pk_mul_f16 v97, v82, v88 op_sel:[0,1] op_sel_hi:[1,1]
    ds_read_u16_d16_hi v37, v10 offset:320
    ds_read_u16_d16_hi v38, v11 offset:384
    v_mfma_f32_32x32x16_f16 v[176:191], a[28:31], v[100:103], v[176:191]
    v_pk_mul_f16 v98, v80, v91 op_sel:[0,0] op_sel_hi:[1,0]
    v_pk_mul_f16 v99, v80, v91 op_sel:[0,1] op_sel_hi:[1,1]
    ds_read_u16_d16_hi v39, v11 offset:448
    ds_read_u16_d16_hi v40, v10 offset:512
    ds_read_u16_d16_hi v41, v10 offset:576
    v_mfma_f32_32x32x16_f16 v[192:207], a[116:119], v[100:103], v[192:207]
    v_pk_mul_f16 v100, v82, v89 op_sel:[0,0] op_sel_hi:[1,0]
    v_pk_mul_f16 v101, v82, v89 op_sel:[0,1] op_sel_hi:[1,1]
    ds_read_u16_d16_hi v42, v10 offset:640
    ds_read_u16_d16_hi v43, v10 offset:704
    v_mfma_f32_32x32x16_f16 v[176:191], a[32:35], v[96:99], v[176:191]
    v_pk_mul_f16 v102, v80, v92 op_sel:[0,0] op_sel_hi:[1,0]
    v_pk_mul_f16 v103, v80, v92 op_sel:[0,1] op_sel_hi:[1,1]
    s_waitcnt lgkmcnt(4)
    ds_read_u16_d16_hi v44, v10 offset:768
    ds_read_u16_d16_hi v45, v10 offset:832
    v_mfma_f32_32x32x16_f16 v[192:207], a[120:123], v[96:99], v[192:207]
    v_pk_mul_f16 v96, v82, v92 op_sel:[0,0] op_sel_hi:[1,0]
    v_pk_mul_f16 v97, v82, v92 op_sel:[0,1] op_sel_hi:[1,1]
    ds_read_u16_d16_hi v46, v11 offset:896
    ds_read_u16_d16_hi v47, v11 offset:960
    ds_read_u16_d16_hi v48, v10 offset:1024
    v_mfma_f32_32x32x16_f16 v[176:191], a[36:39], v[100:103], v[176:191]
    v_pk_mul_f16 v98, v84, v85 op_sel:[0,0] op_sel_hi:[1,0]
    v_pk_mul_f16 v99, v84, v85 op_sel:[0,1] op_sel_hi:[1,1]
    ds_read_u16_d16_hi v49, v10 offset:1088
    ds_read_u16_d16_hi v50, v10 offset:1152
    v_mfma_f32_32x32x16_f16 v[192:207], a[124:127], v[100:103], v[192:207]
    v_pk_mul_f16 v100, v86, v87 op_sel:[0,0] op_sel_hi:[1,0]
    v_pk_mul_f16 v101, v86, v87 op_sel:[0,1] op_sel_hi:[1,1]
    ds_read_u16_d16_hi v51, v10 offset:1216
    ds_read_u16_d16_hi v52, v10 offset:1280
    s_waitcnt lgkmcnt(4)
    v_mfma_f32_32x32x16_f16 v[176:191], a[40:43], v[96:99], v[176:191]
    v_pk_mul_f16 v102, v84, v86 op_sel:[0,0] op_sel_hi:[1,0]
    v_pk_mul_f16 v103, v84, v86 op_sel:[0,1] op_sel_hi:[1,1]
    ds_read_u16_d16_hi v53, v10 offset:1344
    ds_read_u16_d16_hi v54, v11 offset:1408
    v_mfma_f32_32x32x16_f16 v[192:207], a[128:131], v[96:99], v[192:207]
    v_pk_mul_f16 v96, v84, v88 op_sel:[0,0] op_sel_hi:[1,0]
    v_pk_mul_f16 v97, v84, v88 op_sel:[0,1] op_sel_hi:[1,1]
    ds_read_u16_d16_hi v55, v11 offset:1472
    ds_read_u16_d16_hi v56, v12 offset:1536
    ds_read_u16_d16_hi v57, v12 offset:1600
    v_mfma_f32_32x32x16_f16 v[176:191], a[44:47], v[100:103], v[176:191]
    v_pk_mul_f16 v98, v86, v90 op_sel:[0,0] op_sel_hi:[1,0]
    v_pk_mul_f16 v99, v86, v90 op_sel:[0,1] op_sel_hi:[1,1]
    v_fmac_f32 v15, v133, v165
    v_fmac_f32 v167, v151, v113
    v_fmac_f32 v15, v134, v166
    v_mfma_f32_32x32x16_f16 v[192:207], a[132:135], v[100:103], v[192:207]
    v_pk_mul_f16 v100, v84, v89 op_sel:[0,0] op_sel_hi:[1,0]
    v_pk_mul_f16 v101, v84, v89 op_sel:[0,1] op_sel_hi:[1,1]
    v_fmac_f32 v168, v152, v113
    v_fmac_f32 v15, v135, v167
    v_fmac_f32 v169, v153, v113
    v_mfma_f32_32x32x16_f16 v[176:191], a[48:51], v[96:99], v[176:191]
    v_pk_mul_f16 v102, v86, v91 op_sel:[0,0] op_sel_hi:[1,0]
    v_pk_mul_f16 v103, v86, v91 op_sel:[0,1] op_sel_hi:[1,1]
    v_fmac_f32 v15, v136, v168
    v_fmac_f32 v170, v154, v113
    v_fmac_f32 v15, v137, v169
    v_mfma_f32_32x32x16_f16 v[192:207], a[136:139], v[96:99], v[192:207]
    v_pk_mul_f16 v96, v84, v90 op_sel:[0,0] op_sel_hi:[1,0]
    v_pk_mul_f16 v97, v84, v90 op_sel:[0,1] op_sel_hi:[1,1]
    v_fmac_f32 v171, v155, v113
    v_fmac_f32 v15, v138, v170
    v_fmac_f32 v172, v156, v113
    v_mfma_f32_32x32x16_f16 v[176:191], a[52:55], v[100:103], v[176:191]
    v_pk_mul_f16 v98, v86, v88 op_sel:[0,0] op_sel_hi:[1,0]
    v_pk_mul_f16 v99, v86, v88 op_sel:[0,1] op_sel_hi:[1,1]
    v_fmac_f32 v15, v139, v171
    v_fmac_f32 v15, v140, v172
    v_mul_f32 v15, v15, v112
    v_mfma_f32_32x32x16_f16 v[192:207], a[140:143], v[100:103], v[192:207]
    v_pk_mul_f16 v100, v84, v91 op_sel:[0,0] op_sel_hi:[1,0]
    v_pk_mul_f16 v101, v84, v91 op_sel:[0,1] op_sel_hi:[1,1]
    s_waitcnt lgkmcnt(0)
    ds_write_b32 v14, v15
    v_add_u32 v14, 1040, v14
    v_mfma_f32_32x32x16_f16 v[176:191], a[56:59], v[96:99], v[176:191]
    v_pk_mul_f16 v102, v86, v89 op_sel:[0,0] op_sel_hi:[1,0]
    v_pk_mul_f16 v103, v86, v89 op_sel:[0,1] op_sel_hi:[1,1]
    v_max3_f32 v116, |v32|, |v33|, |v34|
    v_max3_f32 v117, |v35|, |v36|, |v37|
    v_mfma_f32_32x32x16_f16 v[192:207], a[144:147], v[96:99], v[192:207]
    v_pk_mul_f16 v96, v84, v92 op_sel:[0,0] op_sel_hi:[1,0]
    v_pk_mul_f16 v97, v84, v92 op_sel:[0,1] op_sel_hi:[1,1]
    v_max3_f32 v116, |v38|, |v39|, v116
    v_max3_f32 v117, |v40|, |v41|, v117
    v_max3_f32 v116, |v42|, |v43|, v116
    v_mfma_f32_32x32x16_f16 v[176:191], a[60:63], v[100:103], v[176:191]
    v_pk_mul_f16 v98, v86, v92 op_sel:[0,0] op_sel_hi:[1,0]
    v_pk_mul_f16 v99, v86, v92 op_sel:[0,1] op_sel_hi:[1,1]
    v_max3_f32 v117, |v44|, |v45|, v117
    v_max3_f32 v116, |v46|, |v47|, v116
    v_mfma_f32_32x32x16_f16 v[192:207], a[148:151], v[100:103], v[192:207]
    v_pk_mul_f16 v100, v88, v89 op_sel:[0,0] op_sel_hi:[1,0]
    v_pk_mul_f16 v101, v88, v89 op_sel:[0,1] op_sel_hi:[1,1]
    v_max3_f32 v117, |v48|, |v49|, v117
    v_max3_f32 v116, |v50|, |v51|, v116
    v_max3_f32 v117, |v52|, |v53|, v117
    v_mfma_f32_32x32x16_f16 v[176:191], a[64:67], v[96:99], v[176:191]
    v_pk_mul_f16 v102, v90, v91 op_sel:[0,0] op_sel_hi:[1,0]
    v_pk_mul_f16 v103, v90, v91 op_sel:[0,1] op_sel_hi:[1,1]
    v_lshlrev_b32 v241, 8, v241
    buffer_load_dword v7, v241, s[28:31], s65 offen
    v_mfma_f32_32x32x16_f16 v[192:207], a[152:155], v[96:99], v[192:207]
    v_pk_mul_f16 v96, v88, v90 op_sel:[0,0] op_sel_hi:[1,0]
    v_pk_mul_f16 v97, v88, v90 op_sel:[0,1] op_sel_hi:[1,1]
    v_add_u32 v240, s62, v240
    v_max3_f32 v116, |v54|, |v55|, v116
    v_max3_f32 v117, |v56|, |v57|, v117
    v_mfma_f32_32x32x16_f16 v[176:191], a[68:71], v[100:103], v[176:191]
    v_pk_mul_f16 v98, v88, v92 op_sel:[0,0] op_sel_hi:[1,0]
    v_pk_mul_f16 v99, v88, v92 op_sel:[0,1] op_sel_hi:[1,1]
    v_max_f32 v116, v116, v117
    v_cmp_nlt_f32 s[26:27], v116, s70
    v_mfma_f32_32x32x16_f16 v[192:207], a[156:159], v[100:103], v[192:207]
    v_pk_mul_f16 v100, v90, v92 op_sel:[0,0] op_sel_hi:[1,0]
    v_pk_mul_f16 v101, v90, v92 op_sel:[0,1] op_sel_hi:[1,1]
    v_cmp_le_f32 vcc, s71, v116
    v_cvt_pk_bf16_f32 v104, v32, v33
    v_cvt_pk_bf16_f32 v105, v36, v37
    v_mfma_f32_32x32x16_f16 v[176:191], a[72:75], v[96:99], v[176:191]
    v_pk_mul_f16 v102, v80, v80 op_sel:[0,0] op_sel_hi:[1,1]
    v_pk_mul_f16 v103, v82, v82 op_sel:[0,0] op_sel_hi:[1,1]
    v_cvt_pk_bf16_f32 v106, v40, v41
    v_cvt_pk_bf16_f32 v107, v44, v45
    v_mfma_f32_32x32x16_f16 v[192:207], a[160:163], v[96:99], v[192:207]
    v_pk_mul_f16 v96, v84, v84 op_sel:[0,0] op_sel_hi:[1,1]
    v_pk_mul_f16 v97, v86, v86 op_sel:[0,0] op_sel_hi:[1,1]
    v_cvt_pk_bf16_f32 v108, v48, v49
    v_cvt_pk_bf16_f32 v109, v52, v53
    v_cndmask_b32 v117, v56, v57, s[72:73]
    v_mfma_f32_32x32x16_f16 v[176:191], a[76:79], v[100:103], v[176:191]
    v_pk_mul_f16 v98, v88, v88 op_sel:[0,0] op_sel_hi:[1,1]
    v_pk_mul_f16 v99, v90, v90 op_sel:[0,0] op_sel_hi:[1,1]
    v_lshrrev_b32 v110, 16, v117
    v_mov_b32 v112, v30
    v_mov_b32 v113, v31
    v_mfma_f32_32x32x16_f16 v[192:207], a[164:167], v[100:103], v[192:207]
    s_cmp_lg_u64 s[26:27], 0
    s_cbranch_scc1 L_slow1
    s_cbranch_vccz L_slow1
L_back1:
    v_cvt_pk_f16_f32 v64, v32, v33
    v_mfma_f32_32x32x16_f16 v[176:191], a[80:83], v[96:99], v[176:191]
    v_cvt_pk_f16_f32 v65, v34, v35
    v_cvt_pk_f16_f32 v66, v36, v37
    v_cvt_pk_f16_f32 v67, v38, v39
    v_cvt_pk_f16_f32 v68, v40, v41
    v_cvt_pk_f16_f32 v69, v42, v43
    v_mfma_f32_32x32x16_f16 v[192:207], a[168:171], v[96:99], v[192:207]
    v_cvt_pk_f16_f32 v70, v44, v45
    v_cvt_pk_f16_f32 v71, v46, v47
    v_cvt_pk_f16_f32 v72, v48, v49
    v_cvt_pk_f16_f32 v73, v50, v51
    v_mfma_f32_32x32x16_f16 v[176:191], a[84:87], v[120:123], v[176:191]
    v_cvt_pk_f16_f32 v74, v52, v53
    v_cvt_pk_f16_f32 v75, v54, v55
    v_cvt_pk_f16_f32 v76, v56, v57
    v_perm_b32 v77, v76, v76, v13
    v_mfma_f32_32x32x16_f16 v[192:207], a[172:175], v[120:123], v[192:207]
    v_pk_mul_f16 v96, v64, v65 op_sel:[0,0] op_sel_hi:[1,0]
    v_pk_mul_f16 v97, v64, v65 op_sel:[0,1] op_sel_hi:[1,1]
    s_add_u32 s79, s79, 1
    s_bitcmp1_b32 s63, s79
    s_cselect_b32 s30, s34, 0
    s_cselect_b32 s62, 16, 0
    s_cmp_lt_u32 s79, 7
    s_cbranch_scc1 L_cloop
    s_cmp_eq_u32 s79, 11
    s_cbranch_scc1 L_pooldone
    s_cmp_eq_u32 s79, 7
    s_cbranch_scc0 L_grab1
    buffer_load_dword v244, v245, s[52:55], 0 offen sc1
    s_getpc_b64 s[74:75]
    v_min_u32 v246, 15, v0
    v_lshlrev_b32 v246, 7, v246
    global_load_dword v7, v246, s[74:75]
    s_branch L_cloop
L_grab1:
    s_cmp_eq_u32 s79, 8
    s_cbranch_scc0 L_grab2
    s_mov_b32 exec_hi, 0xffff
    s_mov_b32 s17, 0
L_gchk:
    v_cmp_ne_u32 vcc, 1, v244
    s_cbranch_vccz L_gok
    buffer_load_dword v244, v245, s[52:55], 0 offen sc1
    s_waitcnt vmcnt(0)
    s_add_u32 s17, s17, 1
    s_cmp_lt_u32 s17, 40000
    s_cbranch_scc1 L_gchk
L_gok:
    s_mov_b64 exec, 1
    v_mov_b32 v246, 1
    s_lshl_b32 s17, s66, 12
    s_add_u32 s17, s17, 0x40000
    buffer_atomic_add v246, v28, s[48:51], s17 offen sc0 sc1
    s_mov_b64 exec, -1
    s_branch L_cloop
L_grab2:
    s_cmp_eq_u32 s79, 9
    s_cbranch_scc0 L_cloop
    s_waitcnt vmcnt(4)
    v_readfirstlane_b32 s57, v246
    v_and_b32 v245, 0xfc, v0
    s_cmp_lt_u32 s57, 16
    s_cselect_b32 s56, 99, 10
    s_min_u32 s57, s57, 15
    s_lshl_b32 s17, s57, 7
    s_add_u32 s17, s17, 130048
    v_add_u32 v4, s17, v245
    s_branch L_cloop
L_pooldone:
    s_lshr_b32 s17, s57, 3
    s_lshl_b32 s17, s17, 9
    s_and_b32 s57, s57, 7
    s_mul_i32 s57, s57, 22
    s_add_u32 s17, s17, s57
    s_lshl_b32 s57, s66, 10
    s_add_u32 s17, s17, s57
    s_add_u32 s17, s17, 26645
    s_lshl_b32 s17, s17, 3
    s_nop 2
    v_fmac_f32 v208, v192, v115
    v_fmac_f32 v209, v193, v115
    v_mul_f32 v15, v176, v208
    v_fmac_f32 v210, v194, v115
    v_fmac_f32 v15, v177, v209
    v_fmac_f32 v211, v195, v115
    v_fmac_f32 v15, v178, v210
    v_fmac_f32 v212, v196, v115
    v_fmac_f32 v15, v179, v211
    v_fmac_f32 v213, v197, v115
    v_fmac_f32 v15, v180, v212
    v_fmac_f32 v214, v198, v115
    v_fmac_f32 v15, v181, v213
    v_fmac_f32 v215, v199, v115
    v_fmac_f32 v15, v182, v214
    v_fmac_f32 v216, v200, v115
    v_fmac_f32 v15, v183, v215
    v_fmac_f32 v217, v201, v115
    v_fmac_f32 v15, v184, v216
    v_fmac_f32 v218, v202, v115
    v_fmac_f32 v15, v185, v217
    v_fmac_f32 v219, v203, v115
    v_fmac_f32 v15, v186, v218
    v_fmac_f32 v220, v204, v115
    v_fmac_f32 v15, v187, v219
    v_fmac_f32 v15, v188, v220
    v_mul_f32 v15, v15, v114
    v_mov_b32 v17, 1
    s_nop 0
    v_add_f32_dpp v15, v15, v15 row_shr:1
    s_nop 1
    v_add_f32_dpp v15, v15, v15 row_shr:2
    s_nop 1
    v_add_f32_dpp v15, v15, v15 row_shr:4
    s_nop 1
    v_add_f32_dpp v15, v15, v15 row_shr:8
    s_nop 1
    v_add_f32_dpp v15, v15, v15 row_bcast:15 row_mask:0xa
    s_nop 1
    v_add_f32_dpp v15, v15, v15 row_bcast:31 row_mask:0xc
    s_nop 1
    v_mov_b32 v16, v15
    s_mov_b32 exec_lo, 0
    s_mov_b32 exec_hi, 0x80000000
    buffer_store_dwordx2 v[16:17], v28, s[48:51], s17 offen sc1
    s_mov_b64 exec, -1
    s_branch L_tail
L_exit0:
    s_nop 7
    s_nop 1
    v_fmac_f32 v160, v144, v113
    v_fmac_f32 v161, v145, v113
    v_mul_f32 v15, v128, v160
    v_fmac_f32 v162, v146, v113
    v_fmac_f32 v15, v129, v161
    v_fmac_f32 v163, v147, v113
    v_fmac_f32 v15, v130, v162
    v_fmac_f32 v164, v148, v113
    v_fmac_f32 v15, v131, v163
    v_fmac_f32 v165, v149, v113
    v_fmac_f32 v15, v132, v164
    v_fmac_f32 v166, v150, v113
    v_fmac_f32 v15, v133, v165
    v_fmac_f32 v167, v151, v113
    v_fmac_f32 v15, v134, v166
    v_fmac_f32 v168, v152, v113
    v_fmac_f32 v15, v135, v167
    v_fmac_f32 v169, v153, v113
    v_fmac_f32 v15, v136, v168
    v_fmac_f32 v170, v154, v113
    v_fmac_f32 v15, v137, v169
    v_fmac_f32 v171, v155, v113
    v_fmac_f32 v15, v138, v170
    v_fmac_f32 v172, v156, v113
    v_fmac_f32 v15, v139, v171
    v_fmac_f32 v15, v140, v172
    v_mul_f32 v15, v15, v112
    ds_write_b32 v14, v15
    v_add_u32 v14, 1040, v14
L_tail:
    s_and_b32 s58, s76, 0x200000
    s_cmp_eq_u32 s66, 0
    s_cselect_b32 s58, s76, s58
    s_cmp_eq_u32 s66, 3
    s_cselect_b32 s58, 0, s58
    s_mov_b32 s59, s58
    v_mov_b32 v74, 0x7ff00000
    v_cndmask_b32 v74, v74, v5, s[58:59]
    v_cndmask_b32 v75, 1, 0, s[58:59]
    s_mov_b32 s79, 0
    s_mov_b32 s60, 0
    s_mov_b32 s61, 65536
    s_mov_b32 s62, 131072
    s_mov_b32 s63, 196608
    s_mov_b64 exec, s[76:77]
    buffer_load_dwordx2 v[64:65], v5, s[48:51], s60 offen sc1
    buffer_load_dwordx2 v[66:67], v5, s[48:51], s61 offen sc1
    buffer_load_dwordx2 v[68:69], v5, s[48:51], s62 offen sc1
    buffer_load_dwordx2 v[70:71], v74, s[48:51], s63 offen sc1
    s_mov_b64 exec, -1
    s_load_dword s17, s[18:19], 0
    s_mov_b32 s36, s20
    s_mov_b32 s37, s21
    s_mov_b32 s38, 2048
    s_mov_b32 s39, 0x00020000
    v_and_b32 v2, 31, v1
    v_lshrrev_b32 v3, 5, v1
    v_min_u32 v8, 20, v2
    v_mul_u32_u24 v8, 1040, v8
    v_lshl_add_u32 v8, v3, 7, v8
    v_cmp_gt_u32 s[58:59], 21, v2
    s_waitcnt lgkmcnt(0)
    s_barrier
    ds_read_b128 v[32:35], v8 offset:1040
    ds_read_b128 v[36:39], v8 offset:1056
    ds_read_b128 v[40:43], v8 offset:1072
    ds_read_b128 v[44:47], v8 offset:1088
    ds_read_b128 v[48:51], v8 offset:1104
    ds_read_b128 v[52:55], v8 offset:1120
    ds_read_b128 v[56:59], v8 offset:1136
    ds_read_b128 v[60:63], v8 offset:1152
    v_lshlrev_b32 v9, 2, v1
    v_lshlrev_b32 v10, 2, v2
    v_add_u32 v11, s67, v0
    v_lshlrev_b32 v11, 1, v11
    v_cmp_gt_u32 s[72:73], s68, v0
    s_lshl_b32 s17, s17, 16
    s_waitcnt lgkmcnt(0)
    v_pk_add_f32 v[32:33], v[32:33], v[48:49]
    v_pk_add_f32 v[34:35], v[34:35], v[50:51]
    v_pk_add_f32 v[36:37], v[36:37], v[52:53]
    v_pk_add_f32 v[38:39], v[38:39], v[54:55]
    v_pk_add_f32 v[40:41], v[40:41], v[56:57]
    v_pk_add_f32 v[42:43], v[42:43], v[58:59]
    v_pk_add_f32 v[44:45], v[44:45], v[60:61]
    v_pk_add_f32 v[46:47], v[46:47], v[62:63]
    v_pk_add_f32 v[32:33], v[32:33], v[40:41]
    v_pk_add_f32 v[34:35], v[34:35], v[42:43]
    v_pk_add_f32 v[36:37], v[36:37], v[44:45]
    v_pk_add_f32 v[38:39], v[38:39], v[46:47]
    v_pk_add_f32 v[32:33], v[32:33], v[36:37]
    v_pk_add_f32 v[34:35], v[34:35], v[38:39]
    v_pk_add_f32 v[32:33], v[32:33], v[34:35]
    v_add_f32 v32, v32, v33
    v_cndmask_b32 v32, 0, v32, s[58:59]
    s_mov_b64 exec, s[76:77]
    buffer_load_dwordx2 v[80:81], v5, s[48:51], s60 offen sc1
    buffer_load_dwordx2 v[82:83], v5, s[48:51], s61 offen sc1
    buffer_load_dwordx2 v[84:85], v5, s[48:51], s62 offen sc1
    buffer_load_dwordx2 v[86:87], v74, s[48:51], s63 offen sc1
L_poll:
    s_waitcnt vmcnt(4)
    v_or_b32 v73, v71, v75
    v_and_b32 v72, v65, v67
    v_and_b32 v73, v69, v73
    v_and_b32 v72, v72, v73
    v_cmp_ne_u32 vcc, 1, v72
    s_cbranch_vccz L_pdA
    buffer_load_dwordx2 v[64:65], v5, s[48:51], s60 offen sc1
    buffer_load_dwordx2 v[66:67], v5, s[48:51], s61 offen sc1
    buffer_load_dwordx2 v[68:69], v5, s[48:51], s62 offen sc1
    buffer_load_dwordx2 v[70:71], v74, s[48:51], s63 offen sc1
    s_waitcnt vmcnt(4)
    v_or_b32 v73, v87, v75
    v_and_b32 v72, v81, v83
    v_and_b32 v73, v85, v73
    v_and_b32 v72, v72, v73
    v_cmp_ne_u32 vcc, 1, v72
    s_cbranch_vccz L_pdB
    buffer_load_dwordx2 v[80:81], v5, s[48:51], s60 offen sc1
    buffer_load_dwordx2 v[82:83], v5, s[48:51], s61 offen sc1
    buffer_load_dwordx2 v[84:85], v5, s[48:51], s62 offen sc1
    buffer_load_dwordx2 v[86:87], v74, s[48:51], s63 offen sc1
    s_add_u32 s79, s79, 1
    s_cmp_lt_u32 s79, 40000
    s_cbranch_scc1 L_poll
    s_waitcnt vmcnt(0)
L_pdB:
    v_add_f32 v76, v80, v82
    v_add_f32 v77, v84, v86
    s_branch L_polldone
L_pdA:
    v_add_f32 v76, v64, v66
    v_add_f32 v77, v68, v70
L_polldone:
    v_add_f32 v32, v32, v76
    v_add_f32 v32, v32, v77
    s_mov_b64 exec, -1
    ds_write_b32 v9, v32 offset:32768
    s_waitcnt lgkmcnt(0)
    s_barrier
    s_cmp_lg_u32 s66, 0
    s_cbranch_scc1 L_cend
    ds_read_b32 v32, v10 offset:32768
    ds_read_b32 v33, v10 offset:32896
    ds_read_b32 v34, v10 offset:33024
    ds_read_b32 v35, v10 offset:33152
    ds_read_b32 v36, v10 offset:33280
    ds_read_b32 v37, v10 offset:33408
    ds_read_b32 v38, v10 offset:33536
    ds_read_b32 v39, v10 offset:33664
    s_waitcnt lgkmcnt(0)
    v_add_f32 v32, v32, v36
    v_add_f32 v33, v33, v37
    v_add_f32 v34, v34, v38
    v_add_f32 v35, v35, v39
    v_add_f32 v32, v32, v34
    v_add_f32 v33, v33, v35
    v_add_f32 v32, v32, v33
    v_add_f32 v32, s17, v32
    v_cvt_pk_bf16_f32 v32, v32, v32
    s_mov_b64 exec, s[72:73]
    buffer_store_short v32, v11, s[36:39], 0 offen
    s_mov_b64 exec, -1
L_cend:
    s_mov_b32 s50, 0x1000000
L_end:
    s_endpgm
L_slowp:
    v_and_b32 v116, 0x7f800000, v116
    v_max_u32 v116, 0x3800000, v116
    v_sub_u32 v117, 0x82000000, v116
    v_subrev_u32 v116, 0x3000000, v116
    v_mul_f32 v116, v116, v116
    v_mul_f32 v112, v116, v30
    v_mul_f32 v113, v116, v31
    v_mul_f32 v32, v117, v32
    v_mul_f32 v33, v117, v33
    v_mul_f32 v34, v117, v34
    v_mul_f32 v35, v117, v35
    v_mul_f32 v36, v117, v36
    v_mul_f32 v37, v117, v37
    v_mul_f32 v38, v117, v38
    v_mul_f32 v39, v117, v39
    v_mul_f32 v40, v117, v40
    v_mul_f32 v41, v117, v41
    v_mul_f32 v42, v117, v42
    v_mul_f32 v43, v117, v43
    v_mul_f32 v44, v117, v44
    v_mul_f32 v45, v117, v45
    v_mul_f32 v46, v117, v46
    v_mul_f32 v47, v117, v47
    v_mul_f32 v48, v117, v48
    v_mul_f32 v49, v117, v49
    v_mul_f32 v50, v117, v50
    v_mul_f32 v51, v117, v51
    v_mul_f32 v52, v117, v52
    v_mul_f32 v53, v117, v53
    v_mul_f32 v54, v117, v54
    v_mul_f32 v55, v117, v55
    v_mul_f32 v56, v117, v56
    v_mul_f32 v57, v117, v57
    s_branch L_backp
L_slow0:
    v_and_b32 v116, 0x7f800000, v116
    v_max_u32 v116, 0x3800000, v116
    v_sub_u32 v117, 0x82000000, v116
    v_subrev_u32 v116, 0x3000000, v116
    v_mul_f32 v116, v116, v116
    v_mul_f32 v114, v116, v30
    v_mul_f32 v115, v116, v31
    v_mul_f32 v32, v117, v32
    v_mul_f32 v33, v117, v33
    v_mul_f32 v34, v117, v34
    v_mul_f32 v35, v117, v35
    v_mul_f32 v36, v117, v36
    v_mul_f32 v37, v117, v37
    v_mul_f32 v38, v117, v38
    v_mul_f32 v39, v117, v39
    v_mul_f32 v40, v117, v40
    v_mul_f32 v41, v117, v41
    v_mul_f32 v42, v117, v42
    v_mul_f32 v43, v117, v43
    v_mul_f32 v44, v117, v44
    v_mul_f32 v45, v117, v45
    v_mul_f32 v46, v117, v46
    v_mul_f32 v47, v117, v47
    v_mul_f32 v48, v117, v48
    v_mul_f32 v49, v117, v49
    v_mul_f32 v50, v117, v50
    v_mul_f32 v51, v117, v51
    v_mul_f32 v52, v117, v52
    v_mul_f32 v53, v117, v53
    v_mul_f32 v54, v117, v54
    v_mul_f32 v55, v117, v55
    v_mul_f32 v56, v117, v56
    v_mul_f32 v57, v117, v57
    s_branch L_back0
L_slow1:
    v_and_b32 v116, 0x7f800000, v116
    v_max_u32 v116, 0x3800000, v116
    v_sub_u32 v117, 0x82000000, v116
    v_subrev_u32 v116, 0x3000000, v116
    v_mul_f32 v116, v116, v116
    v_mul_f32 v112, v116, v30
    v_mul_f32 v113, v116, v31
    v_mul_f32 v32, v117, v32
    v_mul_f32 v33, v117, v33
    v_mul_f32 v34, v117, v34
    v_mul_f32 v35, v117, v35
    v_mul_f32 v36, v117, v36
    v_mul_f32 v37, v117, v37
    v_mul_f32 v38, v117, v38
    v_mul_f32 v39, v117, v39
    v_mul_f32 v40, v117, v40
    v_mul_f32 v41, v117, v41
    v_mul_f32 v42, v117, v42
    v_mul_f32 v43, v117, v43
    v_mul_f32 v44, v117, v44
    v_mul_f32 v45, v117, v45
    v_mul_f32 v46, v117, v46
    v_mul_f32 v47, v117, v47
    v_mul_f32 v48, v117, v48
    v_mul_f32 v49, v117, v49
    v_mul_f32 v50, v117, v50
    v_mul_f32 v51, v117, v51
    v_mul_f32 v52, v117, v52
    v_mul_f32 v53, v117, v53
    v_mul_f32 v54, v117, v54
    v_mul_f32 v55, v117, v55
    v_mul_f32 v56, v117, v56
    v_mul_f32 v57, v117, v57
    s_branch L_back1
.p2align 6
.type L_tab,@object
L_tab:
    .long 0x680004, 0x14000dc, 0xd00008, 0x1a00010, 0x27800e8, 0x2080014, 0x2e000ec, 0x2700018, 0x1a800e0, 0x2d8001c, 0x21000e4, 0x3400020, 0x41800f8, 0x0, 0x0, 0x0
    .long 0xd40070, 0xc0138, 0x13c0074, 0x20c007c, 0x2e40154, 0x2740080, 0x1ac0148, 0x2dc0084, 0x214014c, 0x1a40078, 0x27c0150, 0x3ac008c, 0x4840164, 0x0, 0x0, 0x0
    .long 0x3a80024, 0x48000fc, 0x4100028, 0x34800f0, 0x478002c, 0x3b000f4, 0x4e00030, 0x4e80100, 0x21801b4, 0x2f0028c, 0x28001b8, 0x35001c0, 0x4280298, 0x0, 0x0, 0x0
    .long 0x4140090, 0x34c0158, 0x47c0094, 0x3b4015c, 0x3440088, 0x41c0160, 0x4e40098, 0x4ec0168, 0x2840220, 0x1bc02e8, 0x2ec0224, 0x3bc022c, 0x4940304, 0x0, 0x0, 0x0
    .long 0x3b801c4, 0x490029c, 0x42001c8, 0x3580290, 0x48801cc, 0x3c00294, 0x4f001d0, 0x4f802a0, 0x3c80364, 0x4a0043c, 0x4300368, 0x5000370, 0x5080440, 0x0, 0x0, 0x0
    .long 0x4240230, 0x35c02f8, 0x48c0234, 0x3c402fc, 0x3540228, 0x42c0300, 0x4f40238, 0x4fc0308, 0x43403d0, 0x36c0498, 0x49c03d4, 0x50403d8, 0x50c04a8, 0x0, 0x0, 0x0
    .long 0x0, 0x0, 0x0, 0x0, 0x0, 0x0, 0x0, 0x0, 0x0, 0x0, 0x0, 0x0, 0x0, 0x0, 0x0, 0x0
    .long 0x0, 0x0, 0x0, 0x0, 0x0, 0x0, 0x0, 0x0, 0x0, 0x0, 0x0, 0x0, 0x0, 0x0, 0x0, 0x0
.fill 2200, 4, 0
.section .rodata,"a"
.p2align 6
.amdhsa_kernel standalone__deep_cross_xdeepfm__recsys_kernel
  .amdhsa_next_free_vgpr 512
  .amdhsa_next_free_sgpr 102
  .amdhsa_accum_offset 256
  .amdhsa_group_segment_fixed_size 0
  .amdhsa_kernarg_size 88
  .amdhsa_user_sgpr_count 2
  .amdhsa_user_sgpr_kernarg_segment_ptr 1
  .amdhsa_system_sgpr_workgroup_id_x 1
.end_amdhsa_kernel
```
